```python
import torch

def _softmax(x, axis=-1):
    return torch.softmax(x, dim=axis)

def _gelu(x):
    return torch.nn.functional.gelu(x, approximate='tanh')

def _silu(x):
    return torch.nn.functional.silu(x)

def _sigmoid(x):
    return torch.sigmoid(x)

def _layernorm(x, axis=-1, eps=1e-05):
    m = x.mean(dim=axis, keepdim=True)
    v = x.var(dim=axis, keepdim=True, unbiased=False)
    return (x - m) / torch.sqrt(v + eps)

def _scatter_add(tgt, idx, src, axis=0):
    return tgt.clone().index_add_(axis, idx, src)

def _segment_sum(src, seg, n):
    out = torch.zeros((n,) + src.shape[1:], dtype=src.dtype)
    return out.index_add_(0, seg, src)

def _pad(x, pw):
    flat = tuple((v for pair in reversed(pw) for v in pair))
    return torch.nn.functional.pad(x, flat)
kernel_name = 'gated_mix__memory_aug_recurrent_mem_tr__geglu_ffn__prompt'

def setup_inputs():

    _w = lambda a: (lambda t: t.to(torch.bfloat16) if t.is_floating_point() else t)(torch.as_tensor(a))

    def _A_setup():
        B, S, Dm = (1, 2048, 1024)
        H, Dh = (32, 128)
        M, seg = (8, 32)
        seg = min(seg, S)
        S = S // seg * seg
        return {'x': _w((lambda *s: torch.randn(*s, dtype=torch.bfloat16) * 0.05)(B, S, Dm)), 'mem0': _w((lambda *s: torch.randn(*s, dtype=torch.bfloat16) * 0.4)(B, M, Dm)), 'Wq': _w((lambda *s: torch.randn(*s, dtype=torch.bfloat16) * 6.4)(Dm, H, Dh) * Dm ** (-0.5)), 'Wk': _w((lambda *s: torch.randn(*s, dtype=torch.bfloat16) * 6.4)(Dm, H, Dh) * Dm ** (-0.5)), 'Wv': _w((lambda *s: torch.randn(*s, dtype=torch.bfloat16) * 0.4)(Dm, H, Dh) * Dm ** (-0.5)), 'Wo': _w((lambda *s: torch.randn(*s, dtype=torch.bfloat16) * 0.4)(H, Dh, Dm) * (H * Dh) ** (-0.5)), 'seg_len': seg}
    _A_in = _A_setup()

    def _B_setup():
        B, S, D, F = (1, 2048, 1024, 3584)
        return {'x': _w((lambda *s: torch.randn(*s, dtype=torch.bfloat16) * 0.05)(B, S, D)), 'w_gate': _w((lambda *s: torch.randn(*s, dtype=torch.bfloat16) * 0.05)(D, F)), 'w_up': _w((lambda *s: torch.randn(*s, dtype=torch.bfloat16) * 0.05)(D, F)), 'w_down': _w((lambda *s: torch.randn(*s, dtype=torch.bfloat16) * 0.05)(F, D))}
    _B_in = _B_setup()
    return {'A_x': _A_in['x'], 'A_mem0': _A_in['mem0'], 'A_Wq': _A_in['Wq'], 'A_Wk': _A_in['Wk'], 'A_Wv': _A_in['Wv'], 'A_Wo': _A_in['Wo'], 'A_seg_len': _A_in['seg_len'], 'B_x': _B_in['x'], 'B_w_gate': _B_in['w_gate'], 'B_w_up': _B_in['w_up'], 'B_w_down': _B_in['w_down'], 'gate_w': _w((lambda *s: torch.randn(*s, dtype=torch.bfloat16) * 0.05)(1024) * 16.0)}

def reference(A_x, A_mem0, A_Wq, A_Wk, A_Wv, A_Wo, A_seg_len, B_x, B_w_gate, B_w_up, B_w_down, gate_w):

    def _A_ref(x, mem0, Wq, Wk, Wv, Wo, seg_len):
        B, S, Dm = x.shape
        H, Dh = (Wq.shape[1], Wq.shape[2])
        M = mem0.shape[1]
        scale = Dh ** (-0.5)
        n_seg = S // seg_len
        L = M + seg_len
        idx = torch.arange(L)
        mask = (idx[:, None] < M) | (idx[:, None] >= idx[None, :])
        mem = mem0
        outs = []
        for s in range(n_seg):
            xs = x[:, s * seg_len:(s + 1) * seg_len, :].clone()
            h = torch.concatenate([mem, xs], axis=1)
            q = torch.einsum('btd,dhe->bhte', h, Wq)
            k = torch.einsum('btd,dhe->bhte', h, Wk)
            v = torch.einsum('btd,dhe->bhte', h, Wv)
            scores = torch.einsum('bhqe,bhke->bhqk', q, k) * scale
            scores = torch.where(mask[None, None], scores, -1000000000.0)
            p = _softmax(scores, axis=-1)
            o = torch.einsum('bhqk,bhke->bhqe', p, v)
            o = torch.einsum('bhte,hed->btd', o, Wo)
            mem = o[:, :M, :].clone()
            outs.append(o[:, M:, :])
        return torch.concatenate(outs, axis=1)

    def _B_ref(x, w_gate, w_up, w_down):
        return _gelu(x @ w_gate) * (x @ w_up) @ w_down
    x = A_x
    g = _sigmoid((x * gate_w).sum(-1, keepdims=True))
    a = _A_ref(x, A_mem0, A_Wq, A_Wk, A_Wv, A_Wo, A_seg_len)
    b = _B_ref(x, B_w_gate, B_w_up, B_w_down)
    return g * a + (1 - g) * b
```

```asm
; @launch grid=(256,1,1) block=(256,1,1) lds=163840
.amdgcn_target "amdgcn-amd-amdhsa--gfx950"
.text
.globl gated_mix__memory_aug_recurrent_mem_tr__geglu_ffn__prompt_kernel
.p2align 8
.type gated_mix__memory_aug_recurrent_mem_tr__geglu_ffn__prompt_kernel,@function
gated_mix__memory_aug_recurrent_mem_tr__geglu_ffn__prompt_kernel:
    s_cmp_ge_u32 s2, 256
    s_cbranch_scc1 L_end
    s_load_dwordx16 s[32:47], s[0:1], 0
    s_load_dwordx8 s[48:55], s[0:1], 64
    s_load_dwordx4 s[56:59], s[0:1], 96
    s_load_dwordx2 s[60:61], s[0:1], 112
    v_lshrrev_b32 v1, 6, v0
    v_and_b32 v0, 63, v0
    v_readfirstlane_b32 s63, v1
    v_lshlrev_b32 v1, 4, v0
    v_mov_b32 v2, 268435456
    v_cmp_eq_u32 vcc, 0, v0
    s_nop 1
    v_cndmask_b32 v15, v2, v0, vcc
    s_mov_b32 s65, 0x100000
    s_getreg_b32 s4, hwreg(HW_REG_XCC_ID, 0, 3)
    s_waitcnt lgkmcnt(0)
    s_mov_b32 s8, s60
    s_and_b32 s9, s61, 0xffff
    s_mov_b32 s10, 268435456
    s_mov_b32 s11, 0x20000
    s_mov_b32 s12, s32
    s_and_b32 s13, s33, 0xffff
    s_mov_b32 s14, 4194304
    s_mov_b32 s15, 0x20000
    s_mov_b32 s20, s56
    s_and_b32 s21, s57, 0xffff
    s_mov_b32 s22, 4194304
    s_mov_b32 s23, 0x20000
    s_mov_b32 s24, s58
    s_and_b32 s25, s59, 0xffff
    s_mov_b32 s26, 256
    s_mov_b32 s27, 0x20000
    s_mov_b32 s16, s36
    s_and_b32 s17, s37, 0xffff
    s_mov_b32 s18, 8388608
    s_mov_b32 s19, 0x20000
    s_mov_b32 s28, s34
    s_and_b32 s29, s35, 0xffff
    s_mov_b32 s30, 16384
    s_mov_b32 s31, 0x20000
    s_cmp_lg_u32 s63, 0
    s_cbranch_scc1 L_tick_done
    s_mov_b32 s5, s4
L_tick:
    v_mov_b32 v2, 1
    s_lshl_b32 s6, s5, 5
    buffer_atomic_add v2, v15, s[24:27], s6 offen sc0 sc1
    s_waitcnt vmcnt(0)
    v_readfirstlane_b32 s7, v2
    s_nop 0
    s_cmp_lt_u32 s7, 32
    s_cbranch_scc1 L_tick_got
    s_add_u32 s5, s5, 1
    s_and_b32 s5, s5, 7
    s_cmp_lg_u32 s5, s4
    s_cbranch_scc1 L_tick
L_tick_got:
    s_and_b32 s7, s7, 31
    s_add_u32 s7, s7, s6
    s_cmp_eq_u32 s5, s4
    s_cbranch_scc1 L_tick_own
    v_mov_b32 v2, 1
    buffer_atomic_add v2, v15, s[24:27], 0 offen offset:136 sc1
L_tick_own:
    v_mov_b32 v2, s7
    v_mov_b32 v3, 0
    ds_write_b32 v3, v2
    s_waitcnt lgkmcnt(0)
L_tick_done:
    s_barrier
    v_mov_b32 v3, 0
    ds_read_b32 v2, v3
    s_waitcnt lgkmcnt(0)
    v_readfirstlane_b32 s62, v2
    s_nop 0
    s_and_b32 s62, s62, 255
    s_barrier
    v_mov_b32 v4, 0
    v_mov_b32 v5, 0
    v_mov_b32 v6, 0
    v_mov_b32 v7, 0
    v_mov_b32 v2, 268435456
    v_cmp_gt_u32 vcc, 8, v0
    s_nop 1
    v_cndmask_b32 v2, v2, v1, vcc
    s_lshl_b32 s4, s62, 7
    s_add_u32 s5, s4, 104923136
    s_add_u32 s6, s4, 104988672
    buffer_store_dwordx4 v[4:7], v2, s[8:11], s5 offen sc1
    buffer_store_dwordx4 v[4:7], v2, s[8:11], s6 offen sc1
    s_cmp_lt_u32 s62, 64
    s_cbranch_scc1 L_rec
    s_branch L_nonrec
L_rec:
    s_lshr_b32 s66, s62, 5
    s_and_b32 s68, s62, 15
    s_lshl_b32 s69, s66, 4
    s_add_u32 s69, s69, s68
    s_lshl_b32 s4, s62, 2
    s_add_u32 s4, s4, s63
    s_lshl_b32 s4, s4, 11
    s_add_u32 s4, s4, 106430464
    buffer_store_dwordx4 v[4:7], v1, s[8:11], s4 offen sc1
    buffer_store_dwordx4 v[4:7], v1, s[8:11], s4 offen offset:1024 sc1
    s_lshl_b32 s4, s66, 16
    s_lshl_b32 s5, s63, 10
    s_add_u32 s4, s4, s5
    s_add_u32 s71, s4, 105119744
    s_xor_b32 s4, s66, 1
    s_lshl_b32 s4, s4, 17
    s_add_u32 s4, s4, s5
    s_xor_b32 s4, s4, 0
    s_add_u32 s72, s4, 105381888
    s_lshl_b32 s74, s69, 13
    s_add_u32 s74, s74, 105906176
    s_lshl_b32 s73, s66, 17
    s_add_u32 s73, s73, 105644032
    s_lshl_b32 s84, s66, 12
    s_add_u32 s84, s84, 104925184
    s_lshl_b32 s4, s63, 13
    v_add_u32 v3, s4, v1
    v_add_u32 v4, 0x10000, v3
    v_mov_b32 v16, -1
    v_mov_b32 v17, -1
    v_mov_b32 v18, -1
    v_mov_b32 v19, -1
    v_lshrrev_b32 v5, 3, v0
    v_and_b32 v6, 7, v0
    v_lshlrev_b32 v6, 4, v6
    v_lshl_add_u32 v9, v5, 11, v6
    s_lshl_b32 s4, s63, 6
    v_add_u32 v5, s4, v5
    v_lshl_add_u32 v8, v5, 13, v6
    v_lshrrev_b32 v5, 5, v0
    v_bfe_u32 v6, v0, 4, 1
    v_bfe_u32 v7, v0, 3, 1
    v_bfe_u32 v14, v0, 2, 1
    v_lshl_add_u32 v10, v5, 4, v14
    v_lshl_add_u32 v10, v6, 2, v10
    v_lshl_add_u32 v10, v7, 3, v10
    v_lshl_add_u32 v12, v6, 4, v14
    v_lshl_add_u32 v12, v5, 3, v12
    v_lshl_add_u32 v12, v7, 2, v12
    v_and_b32 v5, 3, v0
    v_lshlrev_b32 v5, 3, v5
    v_lshl_add_u32 v10, v10, 7, v5
    v_lshl_add_u32 v12, v12, 7, v5
    s_lshl_b32 s4, s63, 5
    v_add_u32 v10, s4, v10
    s_lshl_b32 s80, s63, 13
    v_add_u32 v12, s80, v12
    v_add_u32 v13, 0x10000, v12
    s_lshl_b32 s81, s69, 8
    s_xor_b32 s4, s80, 0
    v_add_u32 v24, s4, v10
    v_add_u32 v28, 0x10000, v24
    s_xor_b32 s4, s80, 8192
    v_add_u32 v25, s4, v10
    v_add_u32 v29, 0x10000, v25
    s_xor_b32 s4, s80, 16384
    v_add_u32 v26, s4, v10
    v_add_u32 v30, 0x10000, v26
    s_xor_b32 s4, s80, 24576
    v_add_u32 v27, s4, v10
    v_add_u32 v31, 0x10000, v27
    s_bitcmp1_b32 s62, 4
    s_cbranch_scc1 L_vo
    s_and_b32 s4, s68, 3
    s_lshl_b32 s4, s4, 13
    s_add_u32 s73, s73, s4
    s_lshr_b32 s4, s68, 2
    s_lshl_b32 s4, s4, 10
    s_add_u32 s73, s73, s4
    s_lshl_b32 s4, s63, 15
    s_add_u32 s4, s4, s73
    s_add_u32 s5, s4, 4096
    buffer_store_dwordx4 v[16:19], v1, s[8:11], s4 offen sc1
    buffer_store_dwordx4 v[16:19], v1, s[8:11], s5 offen sc1
    s_lshr_b32 s4, s63, 1
    s_mul_i32 s4, s4, 3072
    s_add_u32 s73, s73, s4
    s_mov_b32 s28, s38
    s_and_b32 s29, s39, 0xffff
    s_mov_b32 s30, 8388608
    s_mov_b32 s31, 0x20000
    s_add_u32 m0, s80, 0
    s_add_u32 s4, s81, 0
    buffer_load_dwordx4 v8, s[16:19], s4 offen offset:0 lds
    s_add_u32 m0, s80, 1024
    s_add_u32 s4, s81, 65536
    buffer_load_dwordx4 v8, s[16:19], s4 offen offset:0 lds
    s_add_u32 m0, s80, 2048
    s_add_u32 s4, s81, 131072
    buffer_load_dwordx4 v8, s[16:19], s4 offen offset:0 lds
    s_add_u32 m0, s80, 3072
    s_add_u32 s4, s81, 196608
    buffer_load_dwordx4 v8, s[16:19], s4 offen offset:0 lds
    s_add_u32 m0, s80, 4096
    s_add_u32 s4, s81, 262144
    buffer_load_dwordx4 v8, s[16:19], s4 offen offset:0 lds
    s_add_u32 m0, s80, 5120
    s_add_u32 s4, s81, 327680
    buffer_load_dwordx4 v8, s[16:19], s4 offen offset:0 lds
    s_add_u32 m0, s80, 6144
    s_add_u32 s4, s81, 393216
    buffer_load_dwordx4 v8, s[16:19], s4 offen offset:0 lds
    s_add_u32 m0, s80, 7168
    s_add_u32 s4, s81, 458752
    buffer_load_dwordx4 v8, s[16:19], s4 offen offset:0 lds
    s_add_u32 m0, s80, 32768
    s_add_u32 s4, s81, 2097152
    buffer_load_dwordx4 v8, s[16:19], s4 offen offset:0 lds
    s_add_u32 m0, s80, 33792
    s_add_u32 s4, s81, 2162688
    buffer_load_dwordx4 v8, s[16:19], s4 offen offset:0 lds
    s_add_u32 m0, s80, 34816
    s_add_u32 s4, s81, 2228224
    buffer_load_dwordx4 v8, s[16:19], s4 offen offset:0 lds
    s_add_u32 m0, s80, 35840
    s_add_u32 s4, s81, 2293760
    buffer_load_dwordx4 v8, s[16:19], s4 offen offset:0 lds
    s_add_u32 m0, s80, 36864
    s_add_u32 s4, s81, 2359296
    buffer_load_dwordx4 v8, s[16:19], s4 offen offset:0 lds
    s_add_u32 m0, s80, 37888
    s_add_u32 s4, s81, 2424832
    buffer_load_dwordx4 v8, s[16:19], s4 offen offset:0 lds
    s_add_u32 m0, s80, 38912
    s_add_u32 s4, s81, 2490368
    buffer_load_dwordx4 v8, s[16:19], s4 offen offset:0 lds
    s_add_u32 m0, s80, 39936
    s_add_u32 s4, s81, 2555904
    buffer_load_dwordx4 v8, s[16:19], s4 offen offset:0 lds
    s_add_u32 m0, s80, 65536
    s_add_u32 s4, s81, 4194304
    buffer_load_dwordx4 v8, s[16:19], s4 offen offset:0 lds
    s_add_u32 m0, s80, 66560
    s_add_u32 s4, s81, 4259840
    buffer_load_dwordx4 v8, s[16:19], s4 offen offset:0 lds
    s_add_u32 m0, s80, 67584
    s_add_u32 s4, s81, 4325376
    buffer_load_dwordx4 v8, s[16:19], s4 offen offset:0 lds
    s_add_u32 m0, s80, 68608
    s_add_u32 s4, s81, 4390912
    buffer_load_dwordx4 v8, s[16:19], s4 offen offset:0 lds
    s_add_u32 m0, s80, 69632
    s_add_u32 s4, s81, 4456448
    buffer_load_dwordx4 v8, s[16:19], s4 offen offset:0 lds
    s_add_u32 m0, s80, 70656
    s_add_u32 s4, s81, 4521984
    buffer_load_dwordx4 v8, s[16:19], s4 offen offset:0 lds
    s_add_u32 m0, s80, 71680
    s_add_u32 s4, s81, 4587520
    buffer_load_dwordx4 v8, s[16:19], s4 offen offset:0 lds
    s_add_u32 m0, s80, 72704
    s_add_u32 s4, s81, 4653056
    buffer_load_dwordx4 v8, s[16:19], s4 offen offset:0 lds
    s_waitcnt vmcnt(16)
    s_barrier
    s_add_u32 m0, s80, 98304
    s_add_u32 s4, s81, 6291456
    buffer_load_dwordx4 v8, s[16:19], s4 offen offset:0 lds
    s_add_u32 m0, s80, 99328
    s_add_u32 s4, s81, 6356992
    buffer_load_dwordx4 v8, s[16:19], s4 offen offset:0 lds
    s_add_u32 m0, s80, 100352
    s_add_u32 s4, s81, 6422528
    buffer_load_dwordx4 v8, s[16:19], s4 offen offset:0 lds
    s_add_u32 m0, s80, 101376
    s_add_u32 s4, s81, 6488064
    buffer_load_dwordx4 v8, s[16:19], s4 offen offset:0 lds
    s_add_u32 m0, s80, 102400
    s_add_u32 s4, s81, 6553600
    buffer_load_dwordx4 v8, s[16:19], s4 offen offset:0 lds
    s_add_u32 m0, s80, 103424
    s_add_u32 s4, s81, 6619136
    buffer_load_dwordx4 v8, s[16:19], s4 offen offset:0 lds
    s_add_u32 m0, s80, 104448
    s_add_u32 s4, s81, 6684672
    buffer_load_dwordx4 v8, s[16:19], s4 offen offset:0 lds
    s_add_u32 m0, s80, 105472
    s_add_u32 s4, s81, 6750208
    buffer_load_dwordx4 v8, s[16:19], s4 offen offset:0 lds
    ds_read_b64_tr_b16 a[0:1], v24 offset:0
    ds_read_b64_tr_b16 a[2:3], v24 offset:256
    ds_read_b64_tr_b16 a[4:5], v24 offset:4096
    ds_read_b64_tr_b16 a[6:7], v24 offset:4352
    ds_read_b64_tr_b16 a[8:9], v25 offset:0
    ds_read_b64_tr_b16 a[10:11], v25 offset:256
    ds_read_b64_tr_b16 a[12:13], v25 offset:4096
    ds_read_b64_tr_b16 a[14:15], v25 offset:4352
    ds_read_b64_tr_b16 a[16:17], v26 offset:0
    ds_read_b64_tr_b16 a[18:19], v26 offset:256
    ds_read_b64_tr_b16 a[20:21], v26 offset:4096
    ds_read_b64_tr_b16 a[22:23], v26 offset:4352
    ds_read_b64_tr_b16 a[24:25], v27 offset:0
    ds_read_b64_tr_b16 a[26:27], v27 offset:256
    ds_read_b64_tr_b16 a[28:29], v27 offset:4096
    ds_read_b64_tr_b16 a[30:31], v27 offset:4352
    s_waitcnt lgkmcnt(0)
    s_waitcnt vmcnt(16)
    s_barrier
    s_add_u32 m0, s80, 0
    s_add_u32 s4, s81, 128
    buffer_load_dwordx4 v8, s[16:19], s4 offen offset:0 lds
    s_add_u32 m0, s80, 1024
    s_add_u32 s4, s81, 65664
    buffer_load_dwordx4 v8, s[16:19], s4 offen offset:0 lds
    s_add_u32 m0, s80, 2048
    s_add_u32 s4, s81, 131200
    buffer_load_dwordx4 v8, s[16:19], s4 offen offset:0 lds
    s_add_u32 m0, s80, 3072
    s_add_u32 s4, s81, 196736
    buffer_load_dwordx4 v8, s[16:19], s4 offen offset:0 lds
    s_add_u32 m0, s80, 4096
    s_add_u32 s4, s81, 262272
    buffer_load_dwordx4 v8, s[16:19], s4 offen offset:0 lds
    s_add_u32 m0, s80, 5120
    s_add_u32 s4, s81, 327808
    buffer_load_dwordx4 v8, s[16:19], s4 offen offset:0 lds
    s_add_u32 m0, s80, 6144
    s_add_u32 s4, s81, 393344
    buffer_load_dwordx4 v8, s[16:19], s4 offen offset:0 lds
    s_add_u32 m0, s80, 7168
    s_add_u32 s4, s81, 458880
    buffer_load_dwordx4 v8, s[16:19], s4 offen offset:0 lds
    ds_read_b64_tr_b16 a[32:33], v24 offset:32768
    ds_read_b64_tr_b16 a[34:35], v24 offset:33024
    ds_read_b64_tr_b16 a[36:37], v24 offset:36864
    ds_read_b64_tr_b16 a[38:39], v24 offset:37120
    ds_read_b64_tr_b16 a[40:41], v25 offset:32768
    ds_read_b64_tr_b16 a[42:43], v25 offset:33024
    ds_read_b64_tr_b16 a[44:45], v25 offset:36864
    ds_read_b64_tr_b16 a[46:47], v25 offset:37120
    ds_read_b64_tr_b16 a[48:49], v26 offset:32768
    ds_read_b64_tr_b16 a[50:51], v26 offset:33024
    ds_read_b64_tr_b16 a[52:53], v26 offset:36864
    ds_read_b64_tr_b16 a[54:55], v26 offset:37120
    ds_read_b64_tr_b16 a[56:57], v27 offset:32768
    ds_read_b64_tr_b16 a[58:59], v27 offset:33024
    ds_read_b64_tr_b16 a[60:61], v27 offset:36864
    ds_read_b64_tr_b16 a[62:63], v27 offset:37120
    s_waitcnt lgkmcnt(0)
    s_waitcnt vmcnt(16)
    s_barrier
    s_add_u32 m0, s80, 32768
    s_add_u32 s4, s81, 2097280
    buffer_load_dwordx4 v8, s[16:19], s4 offen offset:0 lds
    s_add_u32 m0, s80, 33792
    s_add_u32 s4, s81, 2162816
    buffer_load_dwordx4 v8, s[16:19], s4 offen offset:0 lds
    s_add_u32 m0, s80, 34816
    s_add_u32 s4, s81, 2228352
    buffer_load_dwordx4 v8, s[16:19], s4 offen offset:0 lds
    s_add_u32 m0, s80, 35840
    s_add_u32 s4, s81, 2293888
    buffer_load_dwordx4 v8, s[16:19], s4 offen offset:0 lds
    s_add_u32 m0, s80, 36864
    s_add_u32 s4, s81, 2359424
    buffer_load_dwordx4 v8, s[16:19], s4 offen offset:0 lds
    s_add_u32 m0, s80, 37888
    s_add_u32 s4, s81, 2424960
    buffer_load_dwordx4 v8, s[16:19], s4 offen offset:0 lds
    s_add_u32 m0, s80, 38912
    s_add_u32 s4, s81, 2490496
    buffer_load_dwordx4 v8, s[16:19], s4 offen offset:0 lds
    s_add_u32 m0, s80, 39936
    s_add_u32 s4, s81, 2556032
    buffer_load_dwordx4 v8, s[16:19], s4 offen offset:0 lds
    ds_read_b64_tr_b16 a[64:65], v28 offset:0
    ds_read_b64_tr_b16 a[66:67], v28 offset:256
    ds_read_b64_tr_b16 a[68:69], v28 offset:4096
    ds_read_b64_tr_b16 a[70:71], v28 offset:4352
    ds_read_b64_tr_b16 a[72:73], v29 offset:0
    ds_read_b64_tr_b16 a[74:75], v29 offset:256
    ds_read_b64_tr_b16 a[76:77], v29 offset:4096
    ds_read_b64_tr_b16 a[78:79], v29 offset:4352
    ds_read_b64_tr_b16 a[80:81], v30 offset:0
    ds_read_b64_tr_b16 a[82:83], v30 offset:256
    ds_read_b64_tr_b16 a[84:85], v30 offset:4096
    ds_read_b64_tr_b16 a[86:87], v30 offset:4352
    ds_read_b64_tr_b16 a[88:89], v31 offset:0
    ds_read_b64_tr_b16 a[90:91], v31 offset:256
    ds_read_b64_tr_b16 a[92:93], v31 offset:4096
    ds_read_b64_tr_b16 a[94:95], v31 offset:4352
    s_waitcnt lgkmcnt(0)
    s_waitcnt vmcnt(16)
    s_barrier
    s_add_u32 m0, s80, 65536
    s_add_u32 s4, s81, 4194432
    buffer_load_dwordx4 v8, s[16:19], s4 offen offset:0 lds
    s_add_u32 m0, s80, 66560
    s_add_u32 s4, s81, 4259968
    buffer_load_dwordx4 v8, s[16:19], s4 offen offset:0 lds
    s_add_u32 m0, s80, 67584
    s_add_u32 s4, s81, 4325504
    buffer_load_dwordx4 v8, s[16:19], s4 offen offset:0 lds
    s_add_u32 m0, s80, 68608
    s_add_u32 s4, s81, 4391040
    buffer_load_dwordx4 v8, s[16:19], s4 offen offset:0 lds
    s_add_u32 m0, s80, 69632
    s_add_u32 s4, s81, 4456576
    buffer_load_dwordx4 v8, s[16:19], s4 offen offset:0 lds
    s_add_u32 m0, s80, 70656
    s_add_u32 s4, s81, 4522112
    buffer_load_dwordx4 v8, s[16:19], s4 offen offset:0 lds
    s_add_u32 m0, s80, 71680
    s_add_u32 s4, s81, 4587648
    buffer_load_dwordx4 v8, s[16:19], s4 offen offset:0 lds
    s_add_u32 m0, s80, 72704
    s_add_u32 s4, s81, 4653184
    buffer_load_dwordx4 v8, s[16:19], s4 offen offset:0 lds
    ds_read_b64_tr_b16 a[96:97], v28 offset:32768
    ds_read_b64_tr_b16 a[98:99], v28 offset:33024
    ds_read_b64_tr_b16 a[100:101], v28 offset:36864
    ds_read_b64_tr_b16 a[102:103], v28 offset:37120
    ds_read_b64_tr_b16 a[104:105], v29 offset:32768
    ds_read_b64_tr_b16 a[106:107], v29 offset:33024
    ds_read_b64_tr_b16 a[108:109], v29 offset:36864
    ds_read_b64_tr_b16 a[110:111], v29 offset:37120
    ds_read_b64_tr_b16 a[112:113], v30 offset:32768
    ds_read_b64_tr_b16 a[114:115], v30 offset:33024
    ds_read_b64_tr_b16 a[116:117], v30 offset:36864
    ds_read_b64_tr_b16 a[118:119], v30 offset:37120
    ds_read_b64_tr_b16 a[120:121], v31 offset:32768
    ds_read_b64_tr_b16 a[122:123], v31 offset:33024
    ds_read_b64_tr_b16 a[124:125], v31 offset:36864
    ds_read_b64_tr_b16 a[126:127], v31 offset:37120
    s_waitcnt lgkmcnt(0)
    s_waitcnt vmcnt(16)
    s_barrier
    s_add_u32 m0, s80, 98304
    s_add_u32 s4, s81, 6291584
    buffer_load_dwordx4 v8, s[16:19], s4 offen offset:0 lds
    s_add_u32 m0, s80, 99328
    s_add_u32 s4, s81, 6357120
    buffer_load_dwordx4 v8, s[16:19], s4 offen offset:0 lds
    s_add_u32 m0, s80, 100352
    s_add_u32 s4, s81, 6422656
    buffer_load_dwordx4 v8, s[16:19], s4 offen offset:0 lds
    s_add_u32 m0, s80, 101376
    s_add_u32 s4, s81, 6488192
    buffer_load_dwordx4 v8, s[16:19], s4 offen offset:0 lds
    s_add_u32 m0, s80, 102400
    s_add_u32 s4, s81, 6553728
    buffer_load_dwordx4 v8, s[16:19], s4 offen offset:0 lds
    s_add_u32 m0, s80, 103424
    s_add_u32 s4, s81, 6619264
    buffer_load_dwordx4 v8, s[16:19], s4 offen offset:0 lds
    s_add_u32 m0, s80, 104448
    s_add_u32 s4, s81, 6684800
    buffer_load_dwordx4 v8, s[16:19], s4 offen offset:0 lds
    s_add_u32 m0, s80, 105472
    s_add_u32 s4, s81, 6750336
    buffer_load_dwordx4 v8, s[16:19], s4 offen offset:0 lds
    ds_read_b64_tr_b16 a[128:129], v24 offset:0
    ds_read_b64_tr_b16 a[130:131], v24 offset:256
    ds_read_b64_tr_b16 a[132:133], v24 offset:4096
    ds_read_b64_tr_b16 a[134:135], v24 offset:4352
    ds_read_b64_tr_b16 a[136:137], v25 offset:0
    ds_read_b64_tr_b16 a[138:139], v25 offset:256
    ds_read_b64_tr_b16 a[140:141], v25 offset:4096
    ds_read_b64_tr_b16 a[142:143], v25 offset:4352
    ds_read_b64_tr_b16 a[144:145], v26 offset:0
    ds_read_b64_tr_b16 a[146:147], v26 offset:256
    ds_read_b64_tr_b16 a[148:149], v26 offset:4096
    ds_read_b64_tr_b16 a[150:151], v26 offset:4352
    ds_read_b64_tr_b16 a[152:153], v27 offset:0
    ds_read_b64_tr_b16 a[154:155], v27 offset:256
    ds_read_b64_tr_b16 a[156:157], v27 offset:4096
    ds_read_b64_tr_b16 a[158:159], v27 offset:4352
    s_waitcnt lgkmcnt(0)
    s_waitcnt vmcnt(16)
    s_barrier
    s_cmp_lg_u32 s63, 0
    s_cbranch_scc1 L_arr_1
    v_mov_b32 v2, 1
    buffer_atomic_add v2, v15, s[24:27], 0 offen offset:8 sc1
L_arr_1:
    s_add_u32 m0, s80, 0
    s_add_u32 s4, s81, 0
    buffer_load_dwordx4 v8, s[28:31], s4 offen offset:0 lds
    s_add_u32 m0, s80, 1024
    s_add_u32 s4, s81, 65536
    buffer_load_dwordx4 v8, s[28:31], s4 offen offset:0 lds
    s_add_u32 m0, s80, 2048
    s_add_u32 s4, s81, 131072
    buffer_load_dwordx4 v8, s[28:31], s4 offen offset:0 lds
    s_add_u32 m0, s80, 3072
    s_add_u32 s4, s81, 196608
    buffer_load_dwordx4 v8, s[28:31], s4 offen offset:0 lds
    s_add_u32 m0, s80, 4096
    s_add_u32 s4, s81, 262144
    buffer_load_dwordx4 v8, s[28:31], s4 offen offset:0 lds
    s_add_u32 m0, s80, 5120
    s_add_u32 s4, s81, 327680
    buffer_load_dwordx4 v8, s[28:31], s4 offen offset:0 lds
    s_add_u32 m0, s80, 6144
    s_add_u32 s4, s81, 393216
    buffer_load_dwordx4 v8, s[28:31], s4 offen offset:0 lds
    s_add_u32 m0, s80, 7168
    s_add_u32 s4, s81, 458752
    buffer_load_dwordx4 v8, s[28:31], s4 offen offset:0 lds
    ds_read_b64_tr_b16 a[160:161], v24 offset:32768
    ds_read_b64_tr_b16 a[162:163], v24 offset:33024
    ds_read_b64_tr_b16 a[164:165], v24 offset:36864
    ds_read_b64_tr_b16 a[166:167], v24 offset:37120
    ds_read_b64_tr_b16 a[168:169], v25 offset:32768
    ds_read_b64_tr_b16 a[170:171], v25 offset:33024
    ds_read_b64_tr_b16 a[172:173], v25 offset:36864
    ds_read_b64_tr_b16 a[174:175], v25 offset:37120
    ds_read_b64_tr_b16 a[176:177], v26 offset:32768
    ds_read_b64_tr_b16 a[178:179], v26 offset:33024
    ds_read_b64_tr_b16 a[180:181], v26 offset:36864
    ds_read_b64_tr_b16 a[182:183], v26 offset:37120
    ds_read_b64_tr_b16 a[184:185], v27 offset:32768
    ds_read_b64_tr_b16 a[186:187], v27 offset:33024
    ds_read_b64_tr_b16 a[188:189], v27 offset:36864
    ds_read_b64_tr_b16 a[190:191], v27 offset:37120
    s_waitcnt lgkmcnt(0)
    s_waitcnt vmcnt(16)
    s_barrier
    s_add_u32 m0, s80, 32768
    s_add_u32 s4, s81, 2097152
    buffer_load_dwordx4 v8, s[28:31], s4 offen offset:0 lds
    s_add_u32 m0, s80, 33792
    s_add_u32 s4, s81, 2162688
    buffer_load_dwordx4 v8, s[28:31], s4 offen offset:0 lds
    s_add_u32 m0, s80, 34816
    s_add_u32 s4, s81, 2228224
    buffer_load_dwordx4 v8, s[28:31], s4 offen offset:0 lds
    s_add_u32 m0, s80, 35840
    s_add_u32 s4, s81, 2293760
    buffer_load_dwordx4 v8, s[28:31], s4 offen offset:0 lds
    s_add_u32 m0, s80, 36864
    s_add_u32 s4, s81, 2359296
    buffer_load_dwordx4 v8, s[28:31], s4 offen offset:0 lds
    s_add_u32 m0, s80, 37888
    s_add_u32 s4, s81, 2424832
    buffer_load_dwordx4 v8, s[28:31], s4 offen offset:0 lds
    s_add_u32 m0, s80, 38912
    s_add_u32 s4, s81, 2490368
    buffer_load_dwordx4 v8, s[28:31], s4 offen offset:0 lds
    s_add_u32 m0, s80, 39936
    s_add_u32 s4, s81, 2555904
    buffer_load_dwordx4 v8, s[28:31], s4 offen offset:0 lds
    ds_read_b64_tr_b16 a[192:193], v28 offset:0
    ds_read_b64_tr_b16 a[194:195], v28 offset:256
    ds_read_b64_tr_b16 a[196:197], v28 offset:4096
    ds_read_b64_tr_b16 a[198:199], v28 offset:4352
    ds_read_b64_tr_b16 a[200:201], v29 offset:0
    ds_read_b64_tr_b16 a[202:203], v29 offset:256
    ds_read_b64_tr_b16 a[204:205], v29 offset:4096
    ds_read_b64_tr_b16 a[206:207], v29 offset:4352
    ds_read_b64_tr_b16 a[208:209], v30 offset:0
    ds_read_b64_tr_b16 a[210:211], v30 offset:256
    ds_read_b64_tr_b16 a[212:213], v30 offset:4096
    ds_read_b64_tr_b16 a[214:215], v30 offset:4352
    ds_read_b64_tr_b16 a[216:217], v31 offset:0
    ds_read_b64_tr_b16 a[218:219], v31 offset:256
    ds_read_b64_tr_b16 a[220:221], v31 offset:4096
    ds_read_b64_tr_b16 a[222:223], v31 offset:4352
    s_waitcnt lgkmcnt(0)
    s_waitcnt vmcnt(16)
    s_barrier
    s_add_u32 m0, s80, 65536
    s_add_u32 s4, s81, 4194304
    buffer_load_dwordx4 v8, s[28:31], s4 offen offset:0 lds
    s_add_u32 m0, s80, 66560
    s_add_u32 s4, s81, 4259840
    buffer_load_dwordx4 v8, s[28:31], s4 offen offset:0 lds
    s_add_u32 m0, s80, 67584
    s_add_u32 s4, s81, 4325376
    buffer_load_dwordx4 v8, s[28:31], s4 offen offset:0 lds
    s_add_u32 m0, s80, 68608
    s_add_u32 s4, s81, 4390912
    buffer_load_dwordx4 v8, s[28:31], s4 offen offset:0 lds
    s_add_u32 m0, s80, 69632
    s_add_u32 s4, s81, 4456448
    buffer_load_dwordx4 v8, s[28:31], s4 offen offset:0 lds
    s_add_u32 m0, s80, 70656
    s_add_u32 s4, s81, 4521984
    buffer_load_dwordx4 v8, s[28:31], s4 offen offset:0 lds
    s_add_u32 m0, s80, 71680
    s_add_u32 s4, s81, 4587520
    buffer_load_dwordx4 v8, s[28:31], s4 offen offset:0 lds
    s_add_u32 m0, s80, 72704
    s_add_u32 s4, s81, 4653056
    buffer_load_dwordx4 v8, s[28:31], s4 offen offset:0 lds
    ds_read_b64_tr_b16 a[224:225], v28 offset:32768
    ds_read_b64_tr_b16 a[226:227], v28 offset:33024
    ds_read_b64_tr_b16 a[228:229], v28 offset:36864
    ds_read_b64_tr_b16 a[230:231], v28 offset:37120
    ds_read_b64_tr_b16 a[232:233], v29 offset:32768
    ds_read_b64_tr_b16 a[234:235], v29 offset:33024
    ds_read_b64_tr_b16 a[236:237], v29 offset:36864
    ds_read_b64_tr_b16 a[238:239], v29 offset:37120
    ds_read_b64_tr_b16 a[240:241], v30 offset:32768
    ds_read_b64_tr_b16 a[242:243], v30 offset:33024
    ds_read_b64_tr_b16 a[244:245], v30 offset:36864
    ds_read_b64_tr_b16 a[246:247], v30 offset:37120
    ds_read_b64_tr_b16 a[248:249], v31 offset:32768
    ds_read_b64_tr_b16 a[250:251], v31 offset:33024
    ds_read_b64_tr_b16 a[252:253], v31 offset:36864
    ds_read_b64_tr_b16 a[254:255], v31 offset:37120
    s_waitcnt lgkmcnt(0)
    s_waitcnt vmcnt(16)
    s_barrier
    s_add_u32 m0, s80, 98304
    s_add_u32 s4, s81, 6291456
    buffer_load_dwordx4 v8, s[28:31], s4 offen offset:0 lds
    s_add_u32 m0, s80, 99328
    s_add_u32 s4, s81, 6356992
    buffer_load_dwordx4 v8, s[28:31], s4 offen offset:0 lds
    s_add_u32 m0, s80, 100352
    s_add_u32 s4, s81, 6422528
    buffer_load_dwordx4 v8, s[28:31], s4 offen offset:0 lds
    s_add_u32 m0, s80, 101376
    s_add_u32 s4, s81, 6488064
    buffer_load_dwordx4 v8, s[28:31], s4 offen offset:0 lds
    s_add_u32 m0, s80, 102400
    s_add_u32 s4, s81, 6553600
    buffer_load_dwordx4 v8, s[28:31], s4 offen offset:0 lds
    s_add_u32 m0, s80, 103424
    s_add_u32 s4, s81, 6619136
    buffer_load_dwordx4 v8, s[28:31], s4 offen offset:0 lds
    s_add_u32 m0, s80, 104448
    s_add_u32 s4, s81, 6684672
    buffer_load_dwordx4 v8, s[28:31], s4 offen offset:0 lds
    s_add_u32 m0, s80, 105472
    s_add_u32 s4, s81, 6750208
    buffer_load_dwordx4 v8, s[28:31], s4 offen offset:0 lds
    ds_read_b64_tr_b16 v[128:129], v24 offset:0
    ds_read_b64_tr_b16 v[130:131], v24 offset:256
    ds_read_b64_tr_b16 v[132:133], v24 offset:4096
    ds_read_b64_tr_b16 v[134:135], v24 offset:4352
    ds_read_b64_tr_b16 v[136:137], v25 offset:0
    ds_read_b64_tr_b16 v[138:139], v25 offset:256
    ds_read_b64_tr_b16 v[140:141], v25 offset:4096
    ds_read_b64_tr_b16 v[142:143], v25 offset:4352
    ds_read_b64_tr_b16 v[144:145], v26 offset:0
    ds_read_b64_tr_b16 v[146:147], v26 offset:256
    ds_read_b64_tr_b16 v[148:149], v26 offset:4096
    ds_read_b64_tr_b16 v[150:151], v26 offset:4352
    ds_read_b64_tr_b16 v[152:153], v27 offset:0
    ds_read_b64_tr_b16 v[154:155], v27 offset:256
    ds_read_b64_tr_b16 v[156:157], v27 offset:4096
    ds_read_b64_tr_b16 v[158:159], v27 offset:4352
    s_waitcnt lgkmcnt(0)
    s_waitcnt vmcnt(16)
    s_barrier
    s_add_u32 m0, s80, 0
    s_add_u32 s4, s81, 128
    buffer_load_dwordx4 v8, s[28:31], s4 offen offset:0 lds
    s_add_u32 m0, s80, 1024
    s_add_u32 s4, s81, 65664
    buffer_load_dwordx4 v8, s[28:31], s4 offen offset:0 lds
    s_add_u32 m0, s80, 2048
    s_add_u32 s4, s81, 131200
    buffer_load_dwordx4 v8, s[28:31], s4 offen offset:0 lds
    s_add_u32 m0, s80, 3072
    s_add_u32 s4, s81, 196736
    buffer_load_dwordx4 v8, s[28:31], s4 offen offset:0 lds
    s_add_u32 m0, s80, 4096
    s_add_u32 s4, s81, 262272
    buffer_load_dwordx4 v8, s[28:31], s4 offen offset:0 lds
    s_add_u32 m0, s80, 5120
    s_add_u32 s4, s81, 327808
    buffer_load_dwordx4 v8, s[28:31], s4 offen offset:0 lds
    s_add_u32 m0, s80, 6144
    s_add_u32 s4, s81, 393344
    buffer_load_dwordx4 v8, s[28:31], s4 offen offset:0 lds
    s_add_u32 m0, s80, 7168
    s_add_u32 s4, s81, 458880
    buffer_load_dwordx4 v8, s[28:31], s4 offen offset:0 lds
    ds_read_b64_tr_b16 v[160:161], v24 offset:32768
    ds_read_b64_tr_b16 v[162:163], v24 offset:33024
    ds_read_b64_tr_b16 v[164:165], v24 offset:36864
    ds_read_b64_tr_b16 v[166:167], v24 offset:37120
    ds_read_b64_tr_b16 v[168:169], v25 offset:32768
    ds_read_b64_tr_b16 v[170:171], v25 offset:33024
    ds_read_b64_tr_b16 v[172:173], v25 offset:36864
    ds_read_b64_tr_b16 v[174:175], v25 offset:37120
    ds_read_b64_tr_b16 v[176:177], v26 offset:32768
    ds_read_b64_tr_b16 v[178:179], v26 offset:33024
    ds_read_b64_tr_b16 v[180:181], v26 offset:36864
    ds_read_b64_tr_b16 v[182:183], v26 offset:37120
    ds_read_b64_tr_b16 v[184:185], v27 offset:32768
    ds_read_b64_tr_b16 v[186:187], v27 offset:33024
    ds_read_b64_tr_b16 v[188:189], v27 offset:36864
    ds_read_b64_tr_b16 v[190:191], v27 offset:37120
    s_waitcnt lgkmcnt(0)
    s_waitcnt vmcnt(16)
    s_barrier
    s_add_u32 m0, s80, 32768
    s_add_u32 s4, s81, 2097280
    buffer_load_dwordx4 v8, s[28:31], s4 offen offset:0 lds
    s_add_u32 m0, s80, 33792
    s_add_u32 s4, s81, 2162816
    buffer_load_dwordx4 v8, s[28:31], s4 offen offset:0 lds
    s_add_u32 m0, s80, 34816
    s_add_u32 s4, s81, 2228352
    buffer_load_dwordx4 v8, s[28:31], s4 offen offset:0 lds
    s_add_u32 m0, s80, 35840
    s_add_u32 s4, s81, 2293888
    buffer_load_dwordx4 v8, s[28:31], s4 offen offset:0 lds
    s_add_u32 m0, s80, 36864
    s_add_u32 s4, s81, 2359424
    buffer_load_dwordx4 v8, s[28:31], s4 offen offset:0 lds
    s_add_u32 m0, s80, 37888
    s_add_u32 s4, s81, 2424960
    buffer_load_dwordx4 v8, s[28:31], s4 offen offset:0 lds
    s_add_u32 m0, s80, 38912
    s_add_u32 s4, s81, 2490496
    buffer_load_dwordx4 v8, s[28:31], s4 offen offset:0 lds
    s_add_u32 m0, s80, 39936
    s_add_u32 s4, s81, 2556032
    buffer_load_dwordx4 v8, s[28:31], s4 offen offset:0 lds
    ds_read_b64_tr_b16 v[192:193], v28 offset:0
    ds_read_b64_tr_b16 v[194:195], v28 offset:256
    ds_read_b64_tr_b16 v[196:197], v28 offset:4096
    ds_read_b64_tr_b16 v[198:199], v28 offset:4352
    ds_read_b64_tr_b16 v[200:201], v29 offset:0
    ds_read_b64_tr_b16 v[202:203], v29 offset:256
    ds_read_b64_tr_b16 v[204:205], v29 offset:4096
    ds_read_b64_tr_b16 v[206:207], v29 offset:4352
    ds_read_b64_tr_b16 v[208:209], v30 offset:0
    ds_read_b64_tr_b16 v[210:211], v30 offset:256
    ds_read_b64_tr_b16 v[212:213], v30 offset:4096
    ds_read_b64_tr_b16 v[214:215], v30 offset:4352
    ds_read_b64_tr_b16 v[216:217], v31 offset:0
    ds_read_b64_tr_b16 v[218:219], v31 offset:256
    ds_read_b64_tr_b16 v[220:221], v31 offset:4096
    ds_read_b64_tr_b16 v[222:223], v31 offset:4352
    s_waitcnt lgkmcnt(0)
    s_waitcnt vmcnt(16)
    s_barrier
    s_add_u32 m0, s80, 65536
    s_add_u32 s4, s81, 4194432
    buffer_load_dwordx4 v8, s[28:31], s4 offen offset:0 lds
    s_add_u32 m0, s80, 66560
    s_add_u32 s4, s81, 4259968
    buffer_load_dwordx4 v8, s[28:31], s4 offen offset:0 lds
    s_add_u32 m0, s80, 67584
    s_add_u32 s4, s81, 4325504
    buffer_load_dwordx4 v8, s[28:31], s4 offen offset:0 lds
    s_add_u32 m0, s80, 68608
    s_add_u32 s4, s81, 4391040
    buffer_load_dwordx4 v8, s[28:31], s4 offen offset:0 lds
    s_add_u32 m0, s80, 69632
    s_add_u32 s4, s81, 4456576
    buffer_load_dwordx4 v8, s[28:31], s4 offen offset:0 lds
    s_add_u32 m0, s80, 70656
    s_add_u32 s4, s81, 4522112
    buffer_load_dwordx4 v8, s[28:31], s4 offen offset:0 lds
    s_add_u32 m0, s80, 71680
    s_add_u32 s4, s81, 4587648
    buffer_load_dwordx4 v8, s[28:31], s4 offen offset:0 lds
    s_add_u32 m0, s80, 72704
    s_add_u32 s4, s81, 4653184
    buffer_load_dwordx4 v8, s[28:31], s4 offen offset:0 lds
    ds_read_b64_tr_b16 v[224:225], v28 offset:32768
    ds_read_b64_tr_b16 v[226:227], v28 offset:33024
    ds_read_b64_tr_b16 v[228:229], v28 offset:36864
    ds_read_b64_tr_b16 v[230:231], v28 offset:37120
    ds_read_b64_tr_b16 v[232:233], v29 offset:32768
    ds_read_b64_tr_b16 v[234:235], v29 offset:33024
    ds_read_b64_tr_b16 v[236:237], v29 offset:36864
    ds_read_b64_tr_b16 v[238:239], v29 offset:37120
    ds_read_b64_tr_b16 v[240:241], v30 offset:32768
    ds_read_b64_tr_b16 v[242:243], v30 offset:33024
    ds_read_b64_tr_b16 v[244:245], v30 offset:36864
    ds_read_b64_tr_b16 v[246:247], v30 offset:37120
    ds_read_b64_tr_b16 v[248:249], v31 offset:32768
    ds_read_b64_tr_b16 v[250:251], v31 offset:33024
    ds_read_b64_tr_b16 v[252:253], v31 offset:36864
    ds_read_b64_tr_b16 v[254:255], v31 offset:37120
    s_waitcnt lgkmcnt(0)
    s_waitcnt vmcnt(16)
    s_barrier
    s_add_u32 m0, s80, 98304
    s_add_u32 s4, s81, 6291584
    buffer_load_dwordx4 v8, s[28:31], s4 offen offset:0 lds
    s_add_u32 m0, s80, 99328
    s_add_u32 s4, s81, 6357120
    buffer_load_dwordx4 v8, s[28:31], s4 offen offset:0 lds
    s_add_u32 m0, s80, 100352
    s_add_u32 s4, s81, 6422656
    buffer_load_dwordx4 v8, s[28:31], s4 offen offset:0 lds
    s_add_u32 m0, s80, 101376
    s_add_u32 s4, s81, 6488192
    buffer_load_dwordx4 v8, s[28:31], s4 offen offset:0 lds
    s_add_u32 m0, s80, 102400
    s_add_u32 s4, s81, 6553728
    buffer_load_dwordx4 v8, s[28:31], s4 offen offset:0 lds
    s_add_u32 m0, s80, 103424
    s_add_u32 s4, s81, 6619264
    buffer_load_dwordx4 v8, s[28:31], s4 offen offset:0 lds
    s_add_u32 m0, s80, 104448
    s_add_u32 s4, s81, 6684800
    buffer_load_dwordx4 v8, s[28:31], s4 offen offset:0 lds
    s_add_u32 m0, s80, 105472
    s_add_u32 s4, s81, 6750336
    buffer_load_dwordx4 v8, s[28:31], s4 offen offset:0 lds
    ds_read_b64_tr_b16 v[64:65], v24 offset:0
    ds_read_b64_tr_b16 v[66:67], v24 offset:256
    ds_read_b64_tr_b16 v[68:69], v24 offset:4096
    ds_read_b64_tr_b16 v[70:71], v24 offset:4352
    ds_read_b64_tr_b16 v[72:73], v25 offset:0
    ds_read_b64_tr_b16 v[74:75], v25 offset:256
    ds_read_b64_tr_b16 v[76:77], v25 offset:4096
    ds_read_b64_tr_b16 v[78:79], v25 offset:4352
    ds_read_b64_tr_b16 v[80:81], v26 offset:0
    ds_read_b64_tr_b16 v[82:83], v26 offset:256
    ds_read_b64_tr_b16 v[84:85], v26 offset:4096
    ds_read_b64_tr_b16 v[86:87], v26 offset:4352
    ds_read_b64_tr_b16 v[88:89], v27 offset:0
    ds_read_b64_tr_b16 v[90:91], v27 offset:256
    ds_read_b64_tr_b16 v[92:93], v27 offset:4096
    ds_read_b64_tr_b16 v[94:95], v27 offset:4352
    s_waitcnt lgkmcnt(0)
    s_barrier
    v_add_u32 v5, 0, v3
    ds_write_b128 v5, v[64:67] offset:0
    ds_write_b128 v5, v[68:71] offset:1024
    ds_write_b128 v5, v[72:75] offset:2048
    ds_write_b128 v5, v[76:79] offset:3072
    ds_write_b128 v5, v[80:83] offset:4096
    ds_write_b128 v5, v[84:87] offset:5120
    ds_write_b128 v5, v[88:91] offset:6144
    ds_write_b128 v5, v[92:95] offset:7168
    s_waitcnt lgkmcnt(0)
    s_waitcnt vmcnt(16)
    s_barrier
    ds_read_b64_tr_b16 v[64:65], v24 offset:32768
    ds_read_b64_tr_b16 v[66:67], v24 offset:33024
    ds_read_b64_tr_b16 v[68:69], v24 offset:36864
    ds_read_b64_tr_b16 v[70:71], v24 offset:37120
    ds_read_b64_tr_b16 v[72:73], v25 offset:32768
    ds_read_b64_tr_b16 v[74:75], v25 offset:33024
    ds_read_b64_tr_b16 v[76:77], v25 offset:36864
    ds_read_b64_tr_b16 v[78:79], v25 offset:37120
    ds_read_b64_tr_b16 v[80:81], v26 offset:32768
    ds_read_b64_tr_b16 v[82:83], v26 offset:33024
    ds_read_b64_tr_b16 v[84:85], v26 offset:36864
    ds_read_b64_tr_b16 v[86:87], v26 offset:37120
    ds_read_b64_tr_b16 v[88:89], v27 offset:32768
    ds_read_b64_tr_b16 v[90:91], v27 offset:33024
    ds_read_b64_tr_b16 v[92:93], v27 offset:36864
    ds_read_b64_tr_b16 v[94:95], v27 offset:37120
    s_waitcnt lgkmcnt(0)
    s_barrier
    v_add_u32 v5, 32768, v3
    ds_write_b128 v5, v[64:67] offset:0
    ds_write_b128 v5, v[68:71] offset:1024
    ds_write_b128 v5, v[72:75] offset:2048
    ds_write_b128 v5, v[76:79] offset:3072
    ds_write_b128 v5, v[80:83] offset:4096
    ds_write_b128 v5, v[84:87] offset:5120
    ds_write_b128 v5, v[88:91] offset:6144
    ds_write_b128 v5, v[92:95] offset:7168
    s_waitcnt lgkmcnt(0)
    s_waitcnt vmcnt(8)
    s_barrier
    ds_read_b64_tr_b16 v[64:65], v28 offset:0
    ds_read_b64_tr_b16 v[66:67], v28 offset:256
    ds_read_b64_tr_b16 v[68:69], v28 offset:4096
    ds_read_b64_tr_b16 v[70:71], v28 offset:4352
    ds_read_b64_tr_b16 v[72:73], v29 offset:0
    ds_read_b64_tr_b16 v[74:75], v29 offset:256
    ds_read_b64_tr_b16 v[76:77], v29 offset:4096
    ds_read_b64_tr_b16 v[78:79], v29 offset:4352
    ds_read_b64_tr_b16 v[80:81], v30 offset:0
    ds_read_b64_tr_b16 v[82:83], v30 offset:256
    ds_read_b64_tr_b16 v[84:85], v30 offset:4096
    ds_read_b64_tr_b16 v[86:87], v30 offset:4352
    ds_read_b64_tr_b16 v[88:89], v31 offset:0
    ds_read_b64_tr_b16 v[90:91], v31 offset:256
    ds_read_b64_tr_b16 v[92:93], v31 offset:4096
    ds_read_b64_tr_b16 v[94:95], v31 offset:4352
    s_waitcnt lgkmcnt(0)
    s_barrier
    v_add_u32 v5, 65536, v3
    ds_write_b128 v5, v[64:67] offset:0
    ds_write_b128 v5, v[68:71] offset:1024
    ds_write_b128 v5, v[72:75] offset:2048
    ds_write_b128 v5, v[76:79] offset:3072
    ds_write_b128 v5, v[80:83] offset:4096
    ds_write_b128 v5, v[84:87] offset:5120
    ds_write_b128 v5, v[88:91] offset:6144
    ds_write_b128 v5, v[92:95] offset:7168
    s_waitcnt lgkmcnt(0)
    s_waitcnt vmcnt(0)
    s_barrier
    ds_read_b64_tr_b16 v[64:65], v28 offset:32768
    ds_read_b64_tr_b16 v[66:67], v28 offset:33024
    ds_read_b64_tr_b16 v[68:69], v28 offset:36864
    ds_read_b64_tr_b16 v[70:71], v28 offset:37120
    ds_read_b64_tr_b16 v[72:73], v29 offset:32768
    ds_read_b64_tr_b16 v[74:75], v29 offset:33024
    ds_read_b64_tr_b16 v[76:77], v29 offset:36864
    ds_read_b64_tr_b16 v[78:79], v29 offset:37120
    ds_read_b64_tr_b16 v[80:81], v30 offset:32768
    ds_read_b64_tr_b16 v[82:83], v30 offset:33024
    ds_read_b64_tr_b16 v[84:85], v30 offset:36864
    ds_read_b64_tr_b16 v[86:87], v30 offset:37120
    ds_read_b64_tr_b16 v[88:89], v31 offset:32768
    ds_read_b64_tr_b16 v[90:91], v31 offset:33024
    ds_read_b64_tr_b16 v[92:93], v31 offset:36864
    ds_read_b64_tr_b16 v[94:95], v31 offset:37120
    s_waitcnt lgkmcnt(0)
    s_barrier
    v_add_u32 v5, 98304, v3
    ds_write_b128 v5, v[64:67] offset:0
    ds_write_b128 v5, v[68:71] offset:1024
    ds_write_b128 v5, v[72:75] offset:2048
    ds_write_b128 v5, v[76:79] offset:3072
    ds_write_b128 v5, v[80:83] offset:4096
    ds_write_b128 v5, v[84:87] offset:5120
    ds_write_b128 v5, v[88:91] offset:6144
    ds_write_b128 v5, v[92:95] offset:7168
    s_waitcnt lgkmcnt(0)
    s_lshl_b32 s67, s62, 7
    s_lshl_b32 s4, s63, 2
    s_add_u32 s67, s67, s4
    s_add_u32 s67, s67, 104923136
    v_mov_b32 v2, 0x4444
    v_mov_b32 v5, 0xeeee
    v_and_b32 v6, 2, v0
    v_cmp_eq_u32 vcc, 2, v6
    s_nop 1
    v_cndmask_b32 v2, v2, v5, vcc
    v_and_b32 v6, 1, v0
    v_lshlrev_b32 v6, 4, v6
    v_mov_b32 v5, 0x3f80
    v_lshlrev_b32 v5, v6, v5
    v_mov_b32 v6, 0
    v_cndmask_b32 v20, v5, v6, vcc
    v_cndmask_b32 v21, v6, v5, vcc
    s_lshl_b32 s4, s63, 12
    s_add_u32 s4, s4, 131072
    v_add_u32 v5, s4, v1
    s_mov_b32 s70, 0
    v_and_b32 v12, 15, v0
    v_lshrrev_b32 v6, 4, v0
    s_lshl_b32 s4, s63, 8
    s_add_u32 s4, s4, 147456
    v_mul_u32_u24 v7, 1088, v6
    v_lshl_add_u32 v7, v12, 3, v7
    v_add_u32 v7, s4, v7
    v_and_b32 v13, 3, v0
    v_mul_u32_u24 v8, 1088, v13
    v_lshrrev_b32 v13, 2, v0
    v_lshl_add_u32 v8, v13, 3, v8
    v_add_u32 v8, 147456, v8
    v_lshrrev_b32 v13, 1, v6
    v_and_b32 v14, 1, v6
    v_lshl_add_u32 v9, v14, 1, v12
    v_lshlrev_b32 v9, 4, v9
    v_lshl_add_u32 v9, v13, 8, v9
    s_lshl_b32 s4, s63, 9
    v_add_u32 v9, s4, v9
    v_mov_b32 v10, 268435456
    v_and_b32 v13, 2, v0
    v_cmp_eq_u32 vcc, 0, v13
    s_nop 1
    v_cndmask_b32 v9, v10, v9, vcc
    v_lshlrev_b32 v11, 3, v0
    s_add_u32 s74, s74, s4
    s_and_b32 s5, s63, 1
    s_lshl_b32 s4, s5, 8
    v_lshlrev_b32 v10, 4, v12
    v_lshl_add_u32 v10, v6, 9, v10
    v_add_u32 v10, s4, v10
    v_mov_b32 v22, 0xf149f2ca
    s_lshl_b32 s5, s5, 4
    v_add_u32 v12, s5, v12
    v_lshlrev_b32 v6, 2, v6
    s_lshr_b32 s4, s68, 2
    s_lshl_b32 s4, s4, 7
    s_add_u32 s84, s84, s4
    s_and_b32 s4, s68, 3
    s_lshl_b32 s4, s4, 2
    s_add_u32 s4, s4, s63
    s_lshl_b32 s4, s4, 2
    s_add_u32 s84, s84, s4
    v_mov_b32 v16, 0x3f803f80
    v_mov_b32 v17, 0x3f803f80
    v_mov_b32 v18, 0x3f803f80
    v_mov_b32 v19, 0x3f803f80
    v_add_u32 v13, 0, v6
    v_cmp_gt_u32 s[32:33], v13, v12
    v_add_u32 v13, 1, v6
    v_cmp_gt_u32 s[34:35], v13, v12
    v_add_u32 v13, 2, v6
    v_cmp_gt_u32 s[36:37], v13, v12
    v_add_u32 v13, 3, v6
    v_cmp_gt_u32 s[38:39], v13, v12
    v_add_u32 v13, 16, v6
    v_cmp_gt_u32 s[40:41], v13, v12
    v_add_u32 v13, 17, v6
    v_cmp_gt_u32 s[42:43], v13, v12
    v_add_u32 v13, 18, v6
    v_cmp_gt_u32 s[44:45], v13, v12
    v_add_u32 v13, 19, v6
    v_cmp_gt_u32 s[46:47], v13, v12
    s_mov_b32 s78, 0x3e0293ee
    s_mov_b32 s79, 0x3e0293ee
    s_mov_b32 s77, 0xbe0293ee
    s_lshl_b32 s75, s69, 13
    s_lshl_b32 s4, s63, 11
    s_add_u32 s75, s75, s4
    s_add_u32 s80, s4, 152064
    s_and_b32 s5, s63, 1
    s_lshl_b32 s5, s5, 10
    s_add_u32 s81, s5, 16777216
    s_sub_u32 s81, s81, s4
    s_add_u32 s82, s75, 1048576
    s_mov_b32 s2, 2
    s_mov_b32 s76, 0
    v_mov_b32 v32, 0
    v_mov_b32 v33, 0
    v_mov_b32 v34, 0
    v_mov_b32 v35, 0
    v_mov_b32 v36, 0
    v_mov_b32 v37, 0
    v_mov_b32 v38, 0
    v_mov_b32 v39, 0
    s_lshl_b32 s4, s62, 2
    s_add_u32 s4, s4, s63
    v_lshlrev_b32 v40, 7, v0
    s_lshl_b32 s5, s4, 10
    s_add_u32 s6, s5, 105644032
    s_add_u32 s5, s5, 105906176
    s_lshl_b32 s4, s4, 9
    s_add_u32 s4, s4, 105119744
    s_mov_b64 exec, 0xff
    buffer_load_dword v41, v40, s[8:11], s5 offen sc1
    buffer_load_dword v41, v40, s[8:11], s6 offen sc1
    s_mov_b64 exec, 0xf
    buffer_load_dword v41, v40, s[8:11], s4 offen sc1
    s_mov_b64 exec, -1
    s_cmp_lg_u32 s63, 0
    s_cbranch_scc1 L_walld_3
L_wall_2:
    buffer_load_dword v40, v15, s[24:27], 0 offen offset:8 sc1
    s_waitcnt vmcnt(0)
    v_readfirstlane_b32 s4, v40
    s_nop 0
    s_cmp_ge_u32 s4, 256
    s_cbranch_scc1 L_walld_3
    s_sleep 4
    s_sub_u32 s65, s65, 1
    s_cmp_gt_i32 s65, 0
    s_cbranch_scc1 L_wall_2
L_walld_3:
    s_barrier
    buffer_load_dwordx2 v[40:41], v15, s[24:27], 0 offen offset:132 sc1
    s_waitcnt vmcnt(0)
    v_readfirstlane_b32 s64, v41
    s_mov_b32 s5, 0
    s_lshr_b32 s6, s63, 1
    s_and_b32 s4, s63, 1
    s_lshl3_add_u32 s4, s4, s6
    s_lshl_b32 s4, s4, 7
    s_add_u32 s72, s72, s5
    s_mov_b32 s99, 0x2400
    s_lshl_b32 s6, s66, 18
    s_add_u32 s6, s6, s5
    s_and_b32 s7, s68, 15
    s_lshl_b32 s7, s7, 14
    s_lshl2_add_u32 s3, s68, s7
    s_and_b32 s7, s68, 1
    s_mul_i32 s7, s7, 17408
    s_sub_u32 s3, s3, s7
    s_add_u32 s6, s6, 1024
    s_add_u32 s3, s3, s6
    s_add_u32 s3, s3, 106430464
    s_xor_b32 s6, s6, 0x40000
    s_add_u32 s6, s6, 106430464
    s_lshl_b32 s7, s66, 12
    s_add_u32 s4, s4, s7
    s_add_u32 s4, s4, 104925184
    v_and_b32 v42, 15, v0
    v_lshl_add_u32 v40, v42, 2, s4
    v_and_b32 v42, 12, v42
    v_or_b32 v42, s63, v42
    v_lshl_add_u32 v41, v42, 2, s6
    v_and_b32 v42, 15, v42
    v_lshl_add_u32 v41, v42, 14, v41
    s_and_b32 s7, s63, 1
    s_mul_i32 s7, s7, 17408
    v_subrev_u32 v41, s7, v41
    v_cmp_gt_u32 vcc, 16, v0
    s_nop 1
    v_cndmask_b32 v23, v40, v41, vcc
    s_add_u32 s5, s70, 1
    s_min_u32 s5, s5, 63
    s_cmp_gt_u32 s76, s5
    s_cbranch_scc1 L_ndd_5
    v_lshrrev_b32 v12, 6, v1
    v_min_u32 v12, 2, v12
    v_lshlrev_b32 v12, 12, v12
    v_bfe_u32 v13, v1, 2, 4
    v_add_u32 v12, v12, v13
    s_lshl_b32 s4, s69, 7
    s_add_u32 s4, s4, 104931328
L_nd_4:
    buffer_load_dword v13, v12, s[8:11], s4 offen sc1
    s_waitcnt vmcnt(0)
    v_min_u32_dpp v13, v13, v13 quad_perm:[1,0,3,2] row_mask:0xf bank_mask:0xf
    s_nop 1
    v_min_u32_dpp v13, v13, v13 quad_perm:[2,3,0,1] row_mask:0xf bank_mask:0xf
    s_nop 1
    v_min_u32_dpp v13, v13, v13 row_ror:4 row_mask:0xf bank_mask:0xf
    s_nop 1
    v_min_u32_dpp v13, v13, v13 row_ror:8 row_mask:0xf bank_mask:0xf
    s_nop 0
    v_readfirstlane_b32 s76, v13
    s_nop 0
    s_cmp_gt_u32 s76, s5
    s_cbranch_scc1 L_ndd_5
    s_sub_u32 s65, s65, 1
    s_cmp_gt_i32 s65, 0
    s_cbranch_scc1 L_nd_4
L_ndd_5:
    s_mov_b32 m0, s80
    s_add_u32 s5, s75, 33554432
    buffer_load_dwordx4 v1, s[8:11], s5 offen offset:0 sc1 lds
    buffer_load_dwordx4 v1, s[8:11], s5 offen offset:1024 sc1 lds
    s_add_u32 s4, s75, 50331648
    buffer_load_dwordx4 v[24:27], v1, s[8:11], s4 offen offset:0 sc1
    buffer_load_dwordx4 v[28:31], v1, s[8:11], s4 offen offset:1024 sc1
    v_mov_b32 v0, 0
    s_cmp_lg_u32 s64, 0
    s_cbranch_scc1 L_qk_loop1
L_qk_loop0:
    v_and_b32 v14, 0xf0, v1
    v_lshrrev_b32 v12, 8, v1
    v_min_u32 v12, 2, v12
    v_lshlrev_b32 v14, 3, v14
    v_lshl_add_u32 v14, v12, 24, v14
    s_add_u32 s6, s75, 17039360
    s_xor_b32 s5, s82, 2048
    s_max_u32 s4, s70, 1
    s_sub_u32 s4, s4, 1
    v_mov_b32 v13, s4
    s_add_u32 s4, s70, 3
    s_and_b32 s4, s4, 3
    s_lshl_b32 s4, s4, 14
    s_add_u32 s87, s71, s4
    v_mov_b32 v12, 128
    s_mov_b32 exec_hi, 0
    s_mov_b32 exec_lo, 0xffff0000
    s_waitcnt vmcnt(1)
    s_lshl_b32 s83, s70, 1
L_fp_6:
    s_sub_u32 s65, s65, 1
    s_cmp_gt_i32 s65, 0
    s_cselect_b32 s83, s83, 0
    s_nop 0
    buffer_load_dword v0, v23, s[8:11], 0 offen sc1
    s_waitcnt vmcnt(2)
L_fp_6c:
    v_cmpx_gt_u32 vcc, s83, v0
    s_cbranch_execnz L_fp_6
    s_mov_b64 exec, -1
    buffer_load_dwordx4 v[60:63], v1, s[8:11], s87 offen sc1
    s_add_u32 s88, s87, 4096
    s_add_u32 s89, s87, 8192
    s_add_u32 s90, s87, 12288
    s_add_u32 s4, s70, 3
    s_and_b32 s4, s4, 3
    s_lshl_b32 s4, s4, 15
    s_add_u32 s91, s72, s4
    s_add_u32 s92, s91, 4096
    s_add_u32 s93, s91, 16384
    s_add_u32 s94, s91, 20480
    s_mov_b64 exec, 0xffff
    buffer_load_dword v12, v23, s[8:11], 0 offen sc1
    s_mov_b64 exec, -1
    buffer_load_dwordx4 v[68:71], v1, s[8:11], s88 offen sc1
    ds_read_b128 v[104:107], v3 offset:0
    ds_read_b128 v[108:111], v3 offset:1024
    ds_read_b128 v[112:115], v3 offset:32768
    ds_read_b128 v[116:119], v3 offset:33792
    v_mov_b32 v40, 0
    v_mov_b32 v41, 0
    v_mov_b32 v42, 0
    v_mov_b32 v43, 0
    v_mov_b32 v44, 0
    v_mov_b32 v45, 0
    buffer_load_dwordx4 v[76:79], v1, s[8:11], s89 offen sc1
    v_mov_b32 v46, 0
    v_mov_b32 v47, 0
    v_mov_b32 v48, 0
    v_mov_b32 v49, 0
    v_mov_b32 v50, 0
    v_mov_b32 v51, 0
    v_mov_b32 v52, 0
    v_mov_b32 v53, 0
    v_mov_b32 v54, 0
    v_mov_b32 v55, 0
    buffer_load_dwordx4 v[84:87], v1, s[8:11], s90 offen sc1
    s_waitcnt vmcnt(3)
    v_cmp_gt_u32 vcc, s83, v12
    s_cbranch_vccnz L_lk_7
L_lk_7d:
    s_waitcnt vmcnt(3)
    buffer_load_dwordx4 v[88:91], v1, s[8:11], s91 offen sc1
    v_mov_b32 v6, v60
    v_mfma_f32_4x4x4_16b_bf16 v[56:59], v[20:21], v[60:61], 0
    v_mfma_f32_4x4x4_16b_bf16 v[60:63], v[20:21], v[62:63], 0
    s_waitcnt vmcnt(3)
    buffer_load_dwordx4 v[92:95], v1, s[8:11], s92 offen sc1
    v_max_u32 v6, v6, v68
    v_mfma_f32_4x4x4_16b_bf16 v[64:67], v[20:21], v[68:69], 0
    v_mfma_f32_4x4x4_16b_bf16 v[68:71], v[20:21], v[70:71], 0
    s_waitcnt vmcnt(3)
    buffer_load_dwordx4 v[96:99], v1, s[8:11], s93 offen sc1
    v_max_u32 v6, v6, v76
    v_mfma_f32_4x4x4_16b_bf16 v[72:75], v[20:21], v[76:77], 0
    v_mfma_f32_4x4x4_16b_bf16 v[76:79], v[20:21], v[78:79], 0
    s_waitcnt vmcnt(3)
    buffer_load_dwordx4 v[100:103], v1, s[8:11], s94 offen sc1
    v_max_u32 v6, v6, v84
    v_mfma_f32_4x4x4_16b_bf16 v[80:83], v[20:21], v[84:85], 0
    v_mfma_f32_4x4x4_16b_bf16 v[84:87], v[20:21], v[86:87], 0
    s_barrier
    buffer_store_dwordx4 v[32:35], v10, s[8:11], s82 offen sc1
    buffer_store_dwordx4 v[36:39], v10, s[8:11], s5 offen sc1
    buffer_store_dword v13, v15, s[8:11], s67 offen sc1
    buffer_load_dword v0, v14, s[8:11], s6 offen sc1
L_rl_8:
    s_waitcnt vmcnt(6)
    v_mfma_f32_4x4x4_16b_bf16 v[56:59], v[20:21], v[88:89], v[56:59]
    v_max3_u32 v6, v6, v88, v92
    v_mfma_f32_4x4x4_16b_bf16 v[60:63], v[20:21], v[90:91], v[60:63]
    v_mfma_f32_4x4x4_16b_bf16 v[64:67], v[20:21], v[92:93], v[64:67]
    v_mfma_f32_4x4x4_16b_bf16 v[68:71], v[20:21], v[94:95], v[68:71]
    v_cvt_pk_bf16_f32 v88, v56, v57
    v_cvt_pk_bf16_f32 v89, v58, v59
    v_cvt_pk_bf16_f32 v90, v60, v61
    v_cvt_pk_bf16_f32 v91, v62, v63
    ds_write_b128 v5, v[88:91] offset:0
    s_nop 0
    v_smfmac_f32_16x16x64_bf16 v[40:43], v[88:91], a[0:7], v2
    ds_read_b128 v[120:123], v4 offset:0
    v_cvt_pk_bf16_f32 v92, v64, v65
    v_smfmac_f32_16x16x64_bf16 v[44:47], v[88:91], v[128:135], v2
    ds_read_b128 v[124:127], v4 offset:1024
    v_cvt_pk_bf16_f32 v93, v66, v67
    v_smfmac_f32_16x16x64_bf16 v[48:51], v[88:91], a[128:135], v2
    s_waitcnt lgkmcnt(5)
    v_cvt_pk_bf16_f32 v94, v68, v69
    v_smfmac_f32_16x16x64_bf16 v[52:55], v[88:91], v[104:111], v2
    v_cvt_pk_bf16_f32 v95, v70, v71
    ds_write_b128 v5, v[92:95] offset:1024
    s_waitcnt vmcnt(4)
    v_mfma_f32_4x4x4_16b_bf16 v[72:75], v[20:21], v[96:97], v[72:75]
    v_max3_u32 v6, v6, v96, v100
    v_mfma_f32_4x4x4_16b_bf16 v[76:79], v[20:21], v[98:99], v[76:79]
    v_mfma_f32_4x4x4_16b_bf16 v[80:83], v[20:21], v[100:101], v[80:83]
    v_mfma_f32_4x4x4_16b_bf16 v[84:87], v[20:21], v[102:103], v[84:87]
    v_smfmac_f32_16x16x64_bf16 v[40:43], v[92:95], a[32:39], v2
    ds_read_b128 v[104:107], v4 offset:32768
    v_cvt_pk_bf16_f32 v96, v72, v73
    v_cvt_pk_bf16_f32 v97, v74, v75
    v_smfmac_f32_16x16x64_bf16 v[44:47], v[92:95], v[160:167], v2
    ds_read_b128 v[108:111], v4 offset:33792
    v_cvt_pk_bf16_f32 v98, v76, v77
    v_cvt_pk_bf16_f32 v99, v78, v79
    v_smfmac_f32_16x16x64_bf16 v[48:51], v[92:95], a[160:167], v2
    ds_write_b128 v5, v[96:99] offset:2048
    s_waitcnt lgkmcnt(7)
    v_cvt_pk_bf16_f32 v100, v80, v81
    v_cvt_pk_bf16_f32 v101, v82, v83
    v_smfmac_f32_16x16x64_bf16 v[52:55], v[92:95], v[112:119], v2
    v_cvt_pk_bf16_f32 v102, v84, v85
    v_cvt_pk_bf16_f32 v103, v86, v87
    ds_write_b128 v5, v[100:103] offset:3072
    v_smfmac_f32_16x16x64_bf16 v[40:43], v[96:99], a[64:71], v2
    ds_read_b128 v[112:115], v3 offset:2048
    v_cmp_eq_u32 vcc, -1, v6
    v_smfmac_f32_16x16x64_bf16 v[44:47], v[96:99], v[192:199], v2
    ds_read_b128 v[116:119], v3 offset:3072
    v_xor_b32 v5, 4096, v5
    v_smfmac_f32_16x16x64_bf16 v[48:51], v[96:99], a[192:199], v2
    s_waitcnt lgkmcnt(7)
    v_smfmac_f32_16x16x64_bf16 v[52:55], v[96:99], v[120:127], v2
    s_cbranch_vccnz L_fix_9
    s_waitcnt lgkmcnt(2)
    s_barrier
    ds_read_b128 v[56:59], v5 offset:0
    v_smfmac_f32_16x16x64_bf16 v[40:43], v[100:103], a[96:103], v2
    ds_read_b128 v[60:63], v5 offset:1024
    ds_read_b128 v[64:67], v5 offset:2048
    v_smfmac_f32_16x16x64_bf16 v[44:47], v[100:103], v[224:231], v2
    ds_read_b128 v[120:123], v3 offset:34816
    ds_read_b128 v[124:127], v3 offset:35840
    v_smfmac_f32_16x16x64_bf16 v[48:51], v[100:103], a[224:231], v2
    v_smfmac_f32_16x16x64_bf16 v[52:55], v[100:103], v[104:111], v2
    s_waitcnt lgkmcnt(4)
    v_smfmac_f32_16x16x64_bf16 v[40:43], v[56:59], a[8:15], v2
    ds_read_b128 v[68:71], v5 offset:3072
    ds_read_b128 v[104:107], v4 offset:2048
    v_smfmac_f32_16x16x64_bf16 v[44:47], v[56:59], v[136:143], v2
    ds_read_b128 v[108:111], v4 offset:3072
    v_smfmac_f32_16x16x64_bf16 v[48:51], v[56:59], a[136:143], v2
    v_add_u32 v6, 152064, v1
    v_smfmac_f32_16x16x64_bf16 v[52:55], v[56:59], v[112:119], v2
    s_waitcnt lgkmcnt(6)
    v_xor_b32 v5, 8192, v5
    v_smfmac_f32_16x16x64_bf16 v[40:43], v[60:63], a[40:47], v2
    ds_read_b128 v[56:59], v5 offset:0
    ds_read_b128 v[112:115], v4 offset:34816
    v_smfmac_f32_16x16x64_bf16 v[44:47], v[60:63], v[168:175], v2
    ds_read_b128 v[116:119], v4 offset:35840
    v_smfmac_f32_16x16x64_bf16 v[48:51], v[60:63], a[168:175], v2
    s_waitcnt lgkmcnt(6)
    v_smfmac_f32_16x16x64_bf16 v[52:55], v[60:63], v[120:127], v2
    v_smfmac_f32_16x16x64_bf16 v[40:43], v[64:67], a[72:79], v2
    ds_read_b128 v[60:63], v5 offset:1024
    ds_read_b128 v[120:123], v3 offset:6144
    v_smfmac_f32_16x16x64_bf16 v[44:47], v[64:67], v[200:207], v2
    ds_read_b128 v[124:127], v3 offset:7168
    s_and_b32 s86, s70, 3
    v_smfmac_f32_16x16x64_bf16 v[48:51], v[64:67], a[200:207], v2
    s_waitcnt lgkmcnt(6)
    v_smfmac_f32_16x16x64_bf16 v[52:55], v[64:67], v[104:111], v2
    v_smfmac_f32_16x16x64_bf16 v[40:43], v[68:71], a[104:111], v2
    ds_read_b128 v[64:67], v5 offset:2048
    ds_read_b128 v[104:107], v3 offset:38912
    v_smfmac_f32_16x16x64_bf16 v[44:47], v[68:71], v[232:239], v2
    ds_read_b128 v[108:111], v3 offset:39936
    s_lshl_b32 s85, s86, 15
    v_smfmac_f32_16x16x64_bf16 v[48:51], v[68:71], a[232:239], v2
    s_waitcnt lgkmcnt(6)
    v_smfmac_f32_16x16x64_bf16 v[52:55], v[68:71], v[112:119], v2
    v_smfmac_f32_16x16x64_bf16 v[40:43], v[56:59], a[24:31], v2
    ds_read_b128 v[68:71], v5 offset:3072
    ds_read_b128 v[112:115], v4 offset:6144
    v_smfmac_f32_16x16x64_bf16 v[44:47], v[56:59], v[152:159], v2
    ds_read_b128 v[116:119], v4 offset:7168
    s_add_u32 s85, s85, s73
    v_smfmac_f32_16x16x64_bf16 v[48:51], v[56:59], a[152:159], v2
    s_waitcnt lgkmcnt(6)
    v_smfmac_f32_16x16x64_bf16 v[52:55], v[56:59], v[120:127], v2
    v_xor_b32 v5, 4096, v5
    v_smfmac_f32_16x16x64_bf16 v[40:43], v[60:63], a[56:63], v2
    ds_read_b128 v[56:59], v5 offset:0
    ds_read_b128 v[120:123], v4 offset:38912
    v_smfmac_f32_16x16x64_bf16 v[44:47], v[60:63], v[184:191], v2
    ds_read_b128 v[124:127], v4 offset:39936
    s_add_u32 s82, s75, 67108864
    v_smfmac_f32_16x16x64_bf16 v[48:51], v[60:63], a[184:191], v2
    s_waitcnt lgkmcnt(6)
    v_smfmac_f32_16x16x64_bf16 v[52:55], v[60:63], v[104:111], v2
    v_smfmac_f32_16x16x64_bf16 v[40:43], v[64:67], a[88:95], v2
    ds_read_b128 v[60:63], v5 offset:1024
    ds_read_b128 v[104:107], v3 offset:4096
    ds_read_b128 v[108:111], v3 offset:5120
    v_smfmac_f32_16x16x64_bf16 v[44:47], v[64:67], v[216:223], v2
    s_add_u32 s4, s75, s81
    s_add_u32 s5, s4, 4096
    v_smfmac_f32_16x16x64_bf16 v[48:51], v[64:67], a[216:223], v2
    s_waitcnt lgkmcnt(6)
    v_smfmac_f32_16x16x64_bf16 v[52:55], v[64:67], v[112:119], v2
    v_smfmac_f32_16x16x64_bf16 v[40:43], v[68:71], a[120:127], v2
    ds_read_b128 v[64:67], v5 offset:2048
    ds_read_b128 v[112:115], v3 offset:36864
    ds_read_b128 v[116:119], v3 offset:37888
    v_smfmac_f32_16x16x64_bf16 v[44:47], v[68:71], v[248:255], v2
    s_lshl_b32 s6, s86, 11
    s_add_u32 s6, s6, s74
    v_smfmac_f32_16x16x64_bf16 v[48:51], v[68:71], a[248:255], v2
    s_waitcnt lgkmcnt(6)
    v_smfmac_f32_16x16x64_bf16 v[52:55], v[68:71], v[120:127], v2
    v_smfmac_f32_16x16x64_bf16 v[40:43], v[56:59], a[16:23], v2
    ds_read_b128 v[68:71], v5 offset:3072
    ds_read_b128 v[120:123], v4 offset:4096
    ds_read_b128 v[124:127], v4 offset:5120
    v_smfmac_f32_16x16x64_bf16 v[44:47], v[56:59], v[144:151], v2
    s_xor_b32 s7, s6, 512
    s_lshl1_add_u32 s86, s70, 2
    v_smfmac_f32_16x16x64_bf16 v[48:51], v[56:59], a[144:151], v2
    s_waitcnt lgkmcnt(6)
    v_smfmac_f32_16x16x64_bf16 v[52:55], v[56:59], v[104:111], v2
    v_xor_b32 v5, 8192, v5
    v_smfmac_f32_16x16x64_bf16 v[40:43], v[60:63], a[48:55], v2
    ds_read_b128 v[104:107], v4 offset:36864
    ds_read_b128 v[108:111], v4 offset:37888
    v_smfmac_f32_16x16x64_bf16 v[44:47], v[60:63], v[176:183], v2
    ds_read_b128 v[72:75], v6 offset:0
    ds_read_b128 v[76:79], v6 offset:1024
    v_smfmac_f32_16x16x64_bf16 v[48:51], v[60:63], a[176:183], v2
    s_waitcnt lgkmcnt(7)
    v_smfmac_f32_16x16x64_bf16 v[52:55], v[60:63], v[112:119], v2
    v_smfmac_f32_16x16x64_bf16 v[40:43], v[64:67], a[80:87], v2
    ds_read_b128 v[80:83], v6 offset:2048
    ds_read_b128 v[84:87], v6 offset:3072
    v_smfmac_f32_16x16x64_bf16 v[44:47], v[64:67], v[208:215], v2
    ds_read_b128 v[88:91], v6 offset:4096
    v_smfmac_f32_16x16x64_bf16 v[48:51], v[64:67], a[208:215], v2
    s_waitcnt lgkmcnt(7)
    v_smfmac_f32_16x16x64_bf16 v[52:55], v[64:67], v[120:127], v2
    v_smfmac_f32_16x16x64_bf16 v[40:43], v[68:71], a[112:119], v2
    ds_read_b128 v[92:95], v6 offset:5120
    ds_read_b128 v[96:99], v6 offset:6144
    v_smfmac_f32_16x16x64_bf16 v[44:47], v[68:71], v[240:247], v2
    ds_read_b128 v[100:103], v6 offset:7168
    v_smfmac_f32_16x16x64_bf16 v[48:51], v[68:71], a[240:247], v2
    s_waitcnt lgkmcnt(8)
    v_pk_add_f32 v[40:41], v[40:41], v[42:43]
    v_smfmac_f32_16x16x64_bf16 v[52:55], v[68:71], v[104:111], v2
    v_pk_add_f32 v[44:45], v[44:45], v[46:47]
    v_cvt_pk_bf16_f32 v40, v40, v41
    v_cvt_pk_bf16_f32 v41, v44, v45
    ds_write_b64 v7, v[40:41]
    v_pk_add_f32 v[48:49], v[48:49], v[50:51]
    v_cvt_pk_bf16_f32 v48, v48, v49
    v_mov_b32 v125, 0
    v_mov_b32 v126, 0
    v_pk_add_f32 v[52:53], v[52:53], v[54:55]
    v_cvt_pk_bf16_f32 v49, v52, v53
    ds_write_b64 v7, v[48:49] offset:128
    v_mov_b32 v6, s86
    s_cmp_eq_u32 s70, s2
    s_cbranch_scc1 L_qk_spec0
L_qk_back0:
    s_waitcnt lgkmcnt(0)
    s_barrier
    ds_read_b64_tr_b16 v[56:57], v8 offset:0
    ds_read_b64_tr_b16 v[58:59], v8 offset:128
    ds_read_b64_tr_b16 v[60:61], v8 offset:256
    ds_read_b64_tr_b16 v[62:63], v8 offset:384
    ds_read_b64_tr_b16 v[64:65], v8 offset:512
    ds_read_b64_tr_b16 v[66:67], v8 offset:640
    ds_read_b64_tr_b16 v[68:69], v8 offset:768
    ds_read_b64_tr_b16 v[70:71], v8 offset:896
    s_waitcnt lgkmcnt(6)
    v_mfma_f32_16x16x32_bf16 v[40:43], v[72:75], v[56:59], 0
    v_mfma_f32_16x16x32_bf16 v[44:47], v[76:79], v[56:59], 0
    s_waitcnt lgkmcnt(4)
    v_mfma_f32_16x16x32_bf16 v[40:43], v[80:83], v[60:63], v[40:43]
    buffer_load_dwordx2 v[120:121], v11, s[8:11], s6 offen sc1
    v_mfma_f32_16x16x32_bf16 v[44:47], v[84:87], v[60:63], v[44:47]
    buffer_load_dwordx2 v[122:123], v11, s[8:11], s7 offen sc1
    s_waitcnt lgkmcnt(2)
    v_mfma_f32_16x16x32_bf16 v[40:43], v[88:91], v[64:67], v[40:43]
    buffer_load_dwordx4 v[104:107], v1, s[8:11], s4 offen offset:0 sc1
    v_mfma_f32_16x16x32_bf16 v[44:47], v[92:95], v[64:67], v[44:47]
    s_waitcnt lgkmcnt(0)
    v_mfma_f32_16x16x32_bf16 v[40:43], v[96:99], v[68:71], v[40:43]
    buffer_load_dwordx4 v[108:111], v1, s[8:11], s4 offen offset:2048 sc1
    v_mfma_f32_16x16x32_bf16 v[44:47], v[100:103], v[68:71], v[44:47]
    v_mfma_f32_16x16x32_bf16 v[48:51], v[56:59], v[56:59], 0
    buffer_load_dwordx4 v[112:115], v1, s[8:11], s5 offen offset:0 sc1
    v_mfma_f32_16x16x32_bf16 v[48:51], v[60:63], v[60:63], v[48:51]
    v_max3_f32 v14, v40, v41, v42
    v_mfma_f32_16x16x32_bf16 v[48:51], v[64:67], v[64:67], v[48:51]
    v_max3_f32 v14, v14, v43, v44
    v_max3_f32 v14, v14, v45, v46
    v_mfma_f32_16x16x32_bf16 v[48:51], v[68:71], v[68:71], v[48:51]
    buffer_load_dwordx4 v[116:119], v1, s[8:11], s5 offen offset:2048 sc1
    v_max_f32 v14, v14, v47
    s_nop 5
    v_max3_f32 v12, v14, v50, v51
    v_max3_f32 v13, v14, v50, v51
    s_nop 1
    v_permlane16_swap_b32 v12, v13
    v_max_f32 v14, v12, v13
    v_max_f32 v12, v12, v13
    s_nop 1
    v_permlane32_swap_b32 v12, v14
    v_max_f32 v14, v12, v14
    v_mul_f32 v14, s77, v14
    v_pk_fma_f32 v[40:41], v[40:41], s[78:79], v[14:15] op_sel_hi:[1,1,0]
    v_pk_fma_f32 v[42:43], v[42:43], s[78:79], v[14:15] op_sel_hi:[1,1,0]
    v_pk_fma_f32 v[44:45], v[44:45], s[78:79], v[14:15] op_sel_hi:[1,1,0]
    v_pk_fma_f32 v[46:47], v[46:47], s[78:79], v[14:15] op_sel_hi:[1,1,0]
    v_exp_f32 v40, v40
    v_exp_f32 v41, v41
    v_exp_f32 v42, v42
    v_cvt_pk_bf16_f32 v52, v40, v41
    v_exp_f32 v43, v43
    v_exp_f32 v44, v44
    v_cvt_pk_bf16_f32 v53, v42, v43
    v_exp_f32 v45, v45
    v_exp_f32 v46, v46
    v_cvt_pk_bf16_f32 v54, v44, v45
    v_exp_f32 v47, v47
    s_waitcnt vmcnt(4)
    v_max_u32 v0, v120, v122
    v_pk_fma_f32 v[12:13], v[50:51], s[78:79], v[14:15] op_sel_hi:[1,1,0]
    v_cvt_pk_bf16_f32 v55, v46, v47
    v_cmp_eq_u32 vcc, -1, v0
    v_exp_f32 v12, v12
    v_mfma_f32_16x16x32_bf16 v[48:51], v[16:19], v[52:55], 0
    v_exp_f32 v13, v13
    v_mfma_f32_16x16x32_bf16 v[40:43], v[24:27], v[52:55], 0
    buffer_store_dword v6, v15, s[8:11], s84 offen offset:512
    v_cvt_pk_bf16_f32 v124, v12, v13
    v_cvt_pk_bf16_f32 v127, v12, v13
    v_mfma_f32_16x16x32_bf16 v[44:47], v[28:31], v[52:55], 0
    s_cbranch_vccnz L_fix_11
L_rv_10:
    v_mfma_f32_16x16x16_bf16 v[48:51], v[16:17], v[124:125], v[48:51]
    v_mfma_f32_16x16x16_bf16 v[40:43], v[120:121], v[124:125], v[40:43]
    v_mfma_f32_16x16x16_bf16 v[44:47], v[120:121], v[126:127], v[44:47]
    v_rcp_f32 v14, v48
    s_nop 2
    v_pk_mul_f32 v[40:41], v[40:41], v[14:15] op_sel_hi:[1,0]
    v_pk_mul_f32 v[42:43], v[42:43], v[14:15] op_sel_hi:[1,0]
    v_cvt_pk_bf16_f32 v52, v40, v41
    v_cvt_pk_bf16_f32 v53, v42, v43
    v_pk_mul_f32 v[44:45], v[44:45], v[14:15] op_sel_hi:[1,0]
    v_pk_mul_f32 v[46:47], v[46:47], v[14:15] op_sel_hi:[1,0]
    v_cvt_pk_bf16_f32 v54, v44, v45
    v_cvt_pk_bf16_f32 v55, v46, v47
    buffer_store_dwordx4 v[52:55], v9, s[8:11], s85 offen
    s_waitcnt vmcnt(2)
    v_cndmask_b32 v40, 0, v22, s[32:33]
    v_cndmask_b32 v41, 0, v22, s[34:35]
    v_cndmask_b32 v42, 0, v22, s[36:37]
    v_cndmask_b32 v43, 0, v22, s[38:39]
    v_cndmask_b32 v44, 0, v22, s[40:41]
    v_cndmask_b32 v45, 0, v22, s[42:43]
    v_cndmask_b32 v46, 0, v22, s[44:45]
    v_cndmask_b32 v47, 0, v22, s[46:47]
    v_mfma_f32_16x16x32_bf16 v[40:43], v[72:75], v[104:107], v[40:43]
    v_mfma_f32_16x16x32_bf16 v[40:43], v[80:83], v[108:111], v[40:43]
    v_mfma_f32_16x16x32_bf16 v[40:43], v[88:91], v[112:115], v[40:43]
    v_mfma_f32_16x16x32_bf16 v[40:43], v[96:99], v[116:119], v[40:43]
    v_mfma_f32_16x16x32_bf16 v[44:47], v[76:79], v[104:107], v[44:47]
    v_mfma_f32_16x16x32_bf16 v[44:47], v[84:87], v[108:111], v[44:47]
    v_mfma_f32_16x16x32_bf16 v[44:47], v[92:95], v[112:115], v[44:47]
    v_mfma_f32_16x16x32_bf16 v[44:47], v[100:103], v[116:119], v[44:47]
    v_mfma_f32_16x16x32_bf16 v[48:51], v[56:59], v[104:107], 0
    v_max3_f32 v14, v40, v41, v42
    v_mfma_f32_16x16x32_bf16 v[48:51], v[60:63], v[108:111], v[48:51]
    v_mfma_f32_16x16x32_bf16 v[48:51], v[64:67], v[112:115], v[48:51]
    v_max3_f32 v14, v14, v43, v44
    v_max3_f32 v14, v14, v45, v46
    v_mfma_f32_16x16x32_bf16 v[48:51], v[68:71], v[116:119], v[48:51]
    v_max_f32 v14, v14, v47
    s_add_u32 s4, s75, 50331648
    s_xor_b32 s4, s4, 2048
    buffer_load_dwordx4 v[32:35], v1, s[8:11], s4 offen offset:0 sc1
    buffer_load_dwordx4 v[36:39], v1, s[8:11], s4 offen offset:1024 sc1
    v_mov_b64 v[104:105], -1
    v_mov_b64 v[106:107], -1
    s_xor_b32 s85, s85, 0x10000
    buffer_store_dwordx4 v[104:107], v9, s[8:11], s85 offen
    s_mov_b32 m0, s80
    s_add_u32 s5, s75, 33816576
    buffer_load_dwordx4 v1, s[8:11], s5 offen offset:0 sc1 lds
    buffer_load_dwordx4 v1, s[8:11], s5 offen offset:1024 sc1 lds
    v_max3_f32 v12, v14, v50, v51
    v_max3_f32 v13, v14, v50, v51
    s_nop 1
    v_permlane16_swap_b32 v12, v13
    v_max_f32 v14, v12, v13
    v_max_f32 v12, v12, v13
    s_nop 1
    v_permlane32_swap_b32 v12, v14
    v_max_f32 v14, v12, v14
    v_mul_f32 v14, s77, v14
    v_pk_fma_f32 v[40:41], v[40:41], s[78:79], v[14:15] op_sel_hi:[1,1,0]
    v_pk_fma_f32 v[42:43], v[42:43], s[78:79], v[14:15] op_sel_hi:[1,1,0]
    v_pk_fma_f32 v[44:45], v[44:45], s[78:79], v[14:15] op_sel_hi:[1,1,0]
    v_pk_fma_f32 v[46:47], v[46:47], s[78:79], v[14:15] op_sel_hi:[1,1,0]
    v_exp_f32 v40, v40
    v_exp_f32 v41, v41
    v_exp_f32 v42, v42
    v_cvt_pk_bf16_f32 v52, v40, v41
    v_exp_f32 v43, v43
    v_exp_f32 v44, v44
    v_cvt_pk_bf16_f32 v53, v42, v43
    v_exp_f32 v45, v45
    v_exp_f32 v46, v46
    v_cvt_pk_bf16_f32 v54, v44, v45
    v_exp_f32 v47, v47
    v_pk_fma_f32 v[12:13], v[50:51], s[78:79], v[14:15] op_sel_hi:[1,1,0]
    v_cvt_pk_bf16_f32 v55, v46, v47
    v_exp_f32 v12, v12
    s_nop 0
    v_mfma_f32_16x16x32_bf16 v[48:51], v[16:19], v[52:55], 0
    v_exp_f32 v13, v13
    v_mfma_f32_16x16x32_bf16 v[72:75], v[24:27], v[52:55], 0
    v_cvt_pk_bf16_f32 v124, v12, v13
    v_cvt_pk_bf16_f32 v127, v12, v13
    v_mfma_f32_16x16x32_bf16 v[76:79], v[28:31], v[52:55], 0
    s_waitcnt vmcnt(3)
    v_mov_b32 v0, 0
    v_mfma_f32_16x16x32_bf16 v[80:83], v[32:35], v[52:55], 0
    v_mfma_f32_16x16x32_bf16 v[84:87], v[36:39], v[52:55], 0
    s_add_u32 s4, s75, 50593792
    buffer_load_dwordx4 v[24:27], v1, s[8:11], s4 offen offset:0 sc1
    buffer_load_dwordx4 v[28:31], v1, s[8:11], s4 offen offset:1024 sc1
    v_mfma_f32_16x16x16_bf16 v[48:51], v[16:17], v[124:125], v[48:51]
    v_mfma_f32_16x16x16_bf16 v[72:75], v[120:121], v[124:125], v[72:75]
    v_mfma_f32_16x16x16_bf16 v[76:79], v[120:121], v[126:127], v[76:79]
    v_rcp_f32 v14, v48
    v_mfma_f32_16x16x16_bf16 v[80:83], v[122:123], v[124:125], v[80:83]
    v_mfma_f32_16x16x16_bf16 v[84:87], v[122:123], v[126:127], v[84:87]
    v_pk_mul_f32 v[72:73], v[72:73], v[14:15] op_sel_hi:[1,0]
    v_pk_mul_f32 v[74:75], v[74:75], v[14:15] op_sel_hi:[1,0]
    v_cvt_pk_bf16_f32 v32, v72, v73
    v_cvt_pk_bf16_f32 v33, v74, v75
    v_pk_mul_f32 v[76:77], v[76:77], v[14:15] op_sel_hi:[1,0]
    v_pk_mul_f32 v[78:79], v[78:79], v[14:15] op_sel_hi:[1,0]
    v_cvt_pk_bf16_f32 v34, v76, v77
    v_cvt_pk_bf16_f32 v35, v78, v79
    v_pk_mul_f32 v[80:81], v[80:81], v[14:15] op_sel_hi:[1,0]
    v_pk_mul_f32 v[82:83], v[82:83], v[14:15] op_sel_hi:[1,0]
    v_cvt_pk_bf16_f32 v36, v80, v81
    v_cvt_pk_bf16_f32 v37, v82, v83
    v_pk_mul_f32 v[84:85], v[84:85], v[14:15] op_sel_hi:[1,0]
    v_pk_mul_f32 v[86:87], v[86:87], v[14:15] op_sel_hi:[1,0]
    v_cvt_pk_bf16_f32 v38, v84, v85
    v_cvt_pk_bf16_f32 v39, v86, v87
    s_add_u32 s4, s99, 128
    s_or_b32 s5, s4, 0x2400
    s_sub_u32 s4, s5, s99
    s_mov_b32 s99, s5
    s_add_u32 s3, s3, s4
    s_mov_b64 exec, 0xffff
    v_add_u32 v23, s4, v23
    s_mov_b64 exec, -1
    s_add_u32 s75, s75, 262144
    s_add_u32 s70, s70, 1
    s_branch L_qk_loop0
L_qk_spec0:
    s_cmp_eq_u32 s70, 63
    s_cbranch_scc1 L_qk_last0
    buffer_load_dword v0, v15, s[24:27], 0 offen offset:132 sc1
    s_waitcnt vmcnt(0)
    v_readfirstlane_b32 s83, v0
    s_nop 0
    s_cmp_gt_i32 s83, 0
    s_cselect_b32 s83, 8192, 0
    s_add_u32 s3, s3, s83
    s_add_u32 s72, s72, s83
    s_mov_b64 exec, 0xffff
    v_add_u32 v23, s83, v23
    s_mov_b64 exec, -1
    s_mov_b32 s2, 63
    s_branch L_qk_back0
L_qk_last0:
    s_waitcnt lgkmcnt(0)
    s_barrier
    ds_read_b64_tr_b16 v[56:57], v8 offset:0
    ds_read_b64_tr_b16 v[58:59], v8 offset:128
    ds_read_b64_tr_b16 v[60:61], v8 offset:256
    ds_read_b64_tr_b16 v[62:63], v8 offset:384
    ds_read_b64_tr_b16 v[64:65], v8 offset:512
    ds_read_b64_tr_b16 v[66:67], v8 offset:640
    ds_read_b64_tr_b16 v[68:69], v8 offset:768
    ds_read_b64_tr_b16 v[70:71], v8 offset:896
    buffer_load_dwordx4 v[104:107], v1, s[8:11], s4 offen offset:0 sc1
    buffer_load_dwordx4 v[108:111], v1, s[8:11], s4 offen offset:2048 sc1
    buffer_load_dwordx4 v[112:115], v1, s[8:11], s5 offen offset:0 sc1
    buffer_load_dwordx4 v[116:119], v1, s[8:11], s5 offen offset:2048 sc1
    s_add_u32 s4, s75, 50331648
    s_xor_b32 s4, s4, 2048
    buffer_load_dwordx4 v[32:35], v1, s[8:11], s4 offen offset:0 sc1
    buffer_load_dwordx4 v[36:39], v1, s[8:11], s4 offen offset:1024 sc1
    buffer_load_dwordx2 v[120:121], v11, s[8:11], s6 offen sc1
    buffer_load_dwordx2 v[122:123], v11, s[8:11], s7 offen sc1
    s_waitcnt vmcnt(0)
    v_max_u32 v0, v120, v122
    v_cmp_eq_u32 vcc, -1, v0
    s_cbranch_vccnz L_fix_14
L_rv_13:
    v_mov_b32 v52, 63
    v_mov_b32 v53, 63
    v_mov_b32 v54, 63
    v_mov_b32 v55, 63
    s_cmp_eq_u32 s63, 0
    s_cselect_b64 exec, 1, 0
    s_barrier
    buffer_store_dwordx4 v[52:55], v15, s[8:11], s67 offen sc1
    s_mov_b64 exec, -1
    s_waitcnt lgkmcnt(0)
    v_cndmask_b32 v40, 0, v22, s[32:33]
    v_cndmask_b32 v41, 0, v22, s[34:35]
    v_cndmask_b32 v42, 0, v22, s[36:37]
    v_cndmask_b32 v43, 0, v22, s[38:39]
    v_cndmask_b32 v44, 0, v22, s[40:41]
    v_cndmask_b32 v45, 0, v22, s[42:43]
    v_cndmask_b32 v46, 0, v22, s[44:45]
    v_cndmask_b32 v47, 0, v22, s[46:47]
    v_mfma_f32_16x16x32_bf16 v[40:43], v[72:75], v[104:107], v[40:43]
    v_mfma_f32_16x16x32_bf16 v[40:43], v[80:83], v[108:111], v[40:43]
    v_mfma_f32_16x16x32_bf16 v[40:43], v[88:91], v[112:115], v[40:43]
    v_mfma_f32_16x16x32_bf16 v[40:43], v[96:99], v[116:119], v[40:43]
    v_mfma_f32_16x16x32_bf16 v[44:47], v[76:79], v[104:107], v[44:47]
    v_mfma_f32_16x16x32_bf16 v[44:47], v[84:87], v[108:111], v[44:47]
    v_mfma_f32_16x16x32_bf16 v[44:47], v[92:95], v[112:115], v[44:47]
    v_mfma_f32_16x16x32_bf16 v[44:47], v[100:103], v[116:119], v[44:47]
    v_mfma_f32_16x16x32_bf16 v[48:51], v[56:59], v[104:107], 0
    v_max3_f32 v14, v40, v41, v42
    v_mfma_f32_16x16x32_bf16 v[48:51], v[60:63], v[108:111], v[48:51]
    v_mfma_f32_16x16x32_bf16 v[48:51], v[64:67], v[112:115], v[48:51]
    v_max3_f32 v14, v14, v43, v44
    v_max3_f32 v14, v14, v45, v46
    v_mfma_f32_16x16x32_bf16 v[48:51], v[68:71], v[116:119], v[48:51]
    v_max_f32 v14, v14, v47
    s_nop 6
    v_max3_f32 v12, v14, v50, v51
    v_max3_f32 v13, v14, v50, v51
    s_nop 1
    v_permlane16_swap_b32 v12, v13
    v_max_f32 v14, v12, v13
    v_max_f32 v12, v12, v13
    s_nop 1
    v_permlane32_swap_b32 v12, v14
    v_max_f32 v14, v12, v14
    v_mul_f32 v14, s77, v14
    v_pk_fma_f32 v[40:41], v[40:41], s[78:79], v[14:15] op_sel_hi:[1,1,0]
    v_pk_fma_f32 v[42:43], v[42:43], s[78:79], v[14:15] op_sel_hi:[1,1,0]
    v_pk_fma_f32 v[44:45], v[44:45], s[78:79], v[14:15] op_sel_hi:[1,1,0]
    v_pk_fma_f32 v[46:47], v[46:47], s[78:79], v[14:15] op_sel_hi:[1,1,0]
    v_exp_f32 v40, v40
    v_exp_f32 v41, v41
    v_exp_f32 v42, v42
    v_cvt_pk_bf16_f32 v52, v40, v41
    v_exp_f32 v43, v43
    v_exp_f32 v44, v44
    v_cvt_pk_bf16_f32 v53, v42, v43
    v_exp_f32 v45, v45
    v_exp_f32 v46, v46
    v_cvt_pk_bf16_f32 v54, v44, v45
    v_exp_f32 v47, v47
    v_pk_fma_f32 v[12:13], v[50:51], s[78:79], v[14:15] op_sel_hi:[1,1,0]
    v_cvt_pk_bf16_f32 v55, v46, v47
    v_exp_f32 v12, v12
    s_nop 0
    v_mfma_f32_16x16x32_bf16 v[48:51], v[16:19], v[52:55], 0
    v_exp_f32 v13, v13
    v_mfma_f32_16x16x32_bf16 v[72:75], v[24:27], v[52:55], 0
    v_cvt_pk_bf16_f32 v124, v12, v13
    v_cvt_pk_bf16_f32 v127, v12, v13
    v_mfma_f32_16x16x32_bf16 v[76:79], v[28:31], v[52:55], 0
    v_mfma_f32_16x16x32_bf16 v[80:83], v[32:35], v[52:55], 0
    v_mfma_f32_16x16x32_bf16 v[84:87], v[36:39], v[52:55], 0
    v_mfma_f32_16x16x16_bf16 v[48:51], v[16:17], v[124:125], v[48:51]
    v_mfma_f32_16x16x16_bf16 v[72:75], v[120:121], v[124:125], v[72:75]
    v_mfma_f32_16x16x16_bf16 v[76:79], v[120:121], v[126:127], v[76:79]
    v_rcp_f32 v14, v48
    v_mfma_f32_16x16x16_bf16 v[80:83], v[122:123], v[124:125], v[80:83]
    v_mfma_f32_16x16x16_bf16 v[84:87], v[122:123], v[126:127], v[84:87]
    v_pk_mul_f32 v[72:73], v[72:73], v[14:15] op_sel_hi:[1,0]
    v_pk_mul_f32 v[74:75], v[74:75], v[14:15] op_sel_hi:[1,0]
    v_cvt_pk_bf16_f32 v32, v72, v73
    v_cvt_pk_bf16_f32 v33, v74, v75
    v_pk_mul_f32 v[76:77], v[76:77], v[14:15] op_sel_hi:[1,0]
    v_pk_mul_f32 v[78:79], v[78:79], v[14:15] op_sel_hi:[1,0]
    v_cvt_pk_bf16_f32 v34, v76, v77
    v_cvt_pk_bf16_f32 v35, v78, v79
    v_pk_mul_f32 v[80:81], v[80:81], v[14:15] op_sel_hi:[1,0]
    v_pk_mul_f32 v[82:83], v[82:83], v[14:15] op_sel_hi:[1,0]
    v_cvt_pk_bf16_f32 v36, v80, v81
    v_cvt_pk_bf16_f32 v37, v82, v83
    v_pk_mul_f32 v[84:85], v[84:85], v[14:15] op_sel_hi:[1,0]
    v_pk_mul_f32 v[86:87], v[86:87], v[14:15] op_sel_hi:[1,0]
    v_cvt_pk_bf16_f32 v38, v84, v85
    v_cvt_pk_bf16_f32 v39, v86, v87
    s_xor_b32 s5, s82, 2048
    buffer_store_dwordx4 v[32:35], v10, s[8:11], s82 offen sc1
    buffer_store_dwordx4 v[36:39], v10, s[8:11], s5 offen sc1
    s_waitcnt vmcnt(0)
    v_mov_b32 v52, 64
    v_mov_b32 v53, 64
    v_mov_b32 v54, 64
    v_mov_b32 v55, 64
    s_cmp_eq_u32 s63, 0
    s_cselect_b64 exec, 1, 0
    s_barrier
    buffer_store_dwordx4 v[52:55], v15, s[8:11], s67 offen sc1
    s_mov_b64 exec, -1
    s_endpgm
L_fix_9:
    s_nop 7
    buffer_load_dwordx4 v[60:63], v1, s[8:11], s87 offen sc1
    buffer_load_dwordx4 v[68:71], v1, s[8:11], s88 offen sc1
    buffer_load_dwordx4 v[76:79], v1, s[8:11], s89 offen sc1
    buffer_load_dwordx4 v[84:87], v1, s[8:11], s90 offen sc1
    buffer_load_dwordx4 v[88:91], v1, s[8:11], s91 offen sc1
    buffer_load_dwordx4 v[92:95], v1, s[8:11], s92 offen sc1
    buffer_load_dwordx4 v[96:99], v1, s[8:11], s93 offen sc1
    buffer_load_dwordx4 v[100:103], v1, s[8:11], s94 offen sc1
    s_waitcnt vmcnt(0)
    v_max3_u32 v0, v60, v68, v76
    v_max3_u32 v0, v0, v84, v88
    v_max3_u32 v0, v0, v92, v96
    v_max_u32 v0, v0, v100
    v_cmp_eq_u32 vcc, -1, v0
    s_cbranch_vccz L_fix_9d
    s_sub_u32 s65, s65, 1
    s_cmp_gt_i32 s65, 0
    s_cbranch_scc1 L_fix_9
    s_endpgm
L_fix_9d:
    v_mov_b32 v6, 0
    s_waitcnt lgkmcnt(0)
    v_mfma_f32_4x4x4_16b_bf16 v[56:59], v[20:21], v[60:61], 0
    v_mfma_f32_4x4x4_16b_bf16 v[60:63], v[20:21], v[62:63], 0
    v_mfma_f32_4x4x4_16b_bf16 v[64:67], v[20:21], v[68:69], 0
    v_mfma_f32_4x4x4_16b_bf16 v[68:71], v[20:21], v[70:71], 0
    v_mfma_f32_4x4x4_16b_bf16 v[72:75], v[20:21], v[76:77], 0
    v_mfma_f32_4x4x4_16b_bf16 v[76:79], v[20:21], v[78:79], 0
    v_mfma_f32_4x4x4_16b_bf16 v[80:83], v[20:21], v[84:85], 0
    v_mfma_f32_4x4x4_16b_bf16 v[84:87], v[20:21], v[86:87], 0
    ds_read_b128 v[104:107], v3 offset:0
    ds_read_b128 v[108:111], v3 offset:1024
    ds_read_b128 v[112:115], v3 offset:32768
    ds_read_b128 v[116:119], v3 offset:33792
    v_mov_b32 v40, 0
    v_mov_b32 v41, 0
    v_mov_b32 v42, 0
    v_mov_b32 v43, 0
    v_mov_b32 v44, 0
    v_mov_b32 v45, 0
    v_mov_b32 v46, 0
    v_mov_b32 v47, 0
    v_mov_b32 v48, 0
    v_mov_b32 v49, 0
    v_mov_b32 v50, 0
    v_mov_b32 v51, 0
    v_mov_b32 v52, 0
    v_mov_b32 v53, 0
    v_mov_b32 v54, 0
    v_mov_b32 v55, 0
    v_xor_b32 v5, 4096, v5
    s_branch L_rl_8
L_fix_11:
    s_nop 7
    buffer_load_dwordx2 v[120:121], v11, s[8:11], s6 offen sc1
    buffer_load_dwordx2 v[122:123], v11, s[8:11], s7 offen sc1
    s_waitcnt vmcnt(0)
    v_max_u32 v0, v120, v122
    v_cmp_eq_u32 vcc, -1, v0
    s_cbranch_vccz L_fix_11d
    s_sub_u32 s65, s65, 1
    s_cmp_gt_i32 s65, 0
    s_cbranch_scc1 L_fix_11
    s_endpgm
L_fix_11d:
    s_branch L_rv_10
L_fix_14:
    s_nop 7
    buffer_load_dwordx2 v[120:121], v11, s[8:11], s6 offen sc1
    buffer_load_dwordx2 v[122:123], v11, s[8:11], s7 offen sc1
    s_waitcnt vmcnt(0)
    v_max_u32 v0, v120, v122
    v_cmp_eq_u32 vcc, -1, v0
    s_cbranch_vccz L_fix_14d
    s_sub_u32 s65, s65, 1
    s_cmp_gt_i32 s65, 0
    s_cbranch_scc1 L_fix_14
    s_endpgm
L_fix_14d:
    s_branch L_rv_13
L_lk_7:
    s_mov_b64 exec, 0xffff
    buffer_load_dword v12, v23, s[8:11], 0 offen sc1
    s_mov_b64 exec, -1
    s_waitcnt vmcnt(0)
    v_cmp_gt_u32 vcc, s83, v12
    s_cbranch_vccz L_lk_7e
    s_sub_u32 s65, s65, 1
    s_cmp_gt_i32 s65, 0
    s_cbranch_scc1 L_lk_7
    s_endpgm
L_lk_7e:
    s_branch L_lk_7d
L_qk_loop1:
    v_and_b32 v14, 0xf0, v1
    v_lshrrev_b32 v12, 8, v1
    v_min_u32 v12, 2, v12
    v_lshlrev_b32 v14, 3, v14
    v_lshl_add_u32 v14, v12, 24, v14
    s_add_u32 s6, s75, 17039360
    s_xor_b32 s5, s82, 2048
    s_max_u32 s4, s70, 1
    s_sub_u32 s4, s4, 1
    v_mov_b32 v13, s4
    s_add_u32 s4, s70, 3
    s_and_b32 s4, s4, 3
    s_lshl_b32 s4, s4, 14
    s_add_u32 s87, s71, s4
    v_mov_b32 v12, 128
    s_mov_b32 exec_hi, 0
    s_mov_b32 exec_lo, 0xffff0000
    s_waitcnt vmcnt(1)
    s_lshl_b32 s83, s70, 1
L_fp_15:
    s_sub_u32 s65, s65, 1
    s_cmp_gt_i32 s65, 0
    s_cselect_b32 s83, s83, 0
    s_nop 0
    buffer_load_dword v0, v23, s[8:11], 0 offen sc1
    s_waitcnt vmcnt(2)
L_fp_15c:
    v_cmpx_gt_u32 vcc, s83, v0
    s_cbranch_execnz L_fp_15
    s_mov_b64 exec, -1
    buffer_load_dwordx4 v[60:63], v1, s[8:11], s87 offen sc1
    s_add_u32 s88, s87, 4096
    s_add_u32 s89, s87, 8192
    s_add_u32 s90, s87, 12288
    s_add_u32 s4, s70, 3
    s_and_b32 s4, s4, 3
    s_lshl_b32 s4, s4, 15
    s_add_u32 s91, s72, s4
    s_add_u32 s92, s91, 4096
    s_add_u32 s93, s91, 16384
    s_add_u32 s94, s91, 20480
    s_mov_b64 exec, 0xffff
    buffer_load_dword v12, v23, s[8:11], 0 offen sc1
    s_mov_b64 exec, -1
    buffer_load_dwordx4 v[68:71], v1, s[8:11], s88 offen sc1
    ds_read_b128 v[104:107], v3 offset:0
    ds_read_b128 v[108:111], v3 offset:1024
    ds_read_b128 v[112:115], v3 offset:32768
    ds_read_b128 v[116:119], v3 offset:33792
    v_mov_b32 v40, 0
    v_mov_b32 v41, 0
    v_mov_b32 v42, 0
    v_mov_b32 v43, 0
    v_mov_b32 v44, 0
    v_mov_b32 v45, 0
    buffer_load_dwordx4 v[76:79], v1, s[8:11], s89 offen sc1
    v_mov_b32 v46, 0
    v_mov_b32 v47, 0
    v_mov_b32 v48, 0
    v_mov_b32 v49, 0
    v_mov_b32 v50, 0
    v_mov_b32 v51, 0
    v_mov_b32 v52, 0
    v_mov_b32 v53, 0
    v_mov_b32 v54, 0
    v_mov_b32 v55, 0
    buffer_load_dwordx4 v[84:87], v1, s[8:11], s90 offen sc1
    s_waitcnt vmcnt(3)
    v_cmp_gt_u32 vcc, s83, v12
    s_cbranch_vccnz L_lk_16
L_lk_16d:
    s_waitcnt vmcnt(3)
    buffer_load_dwordx4 v[88:91], v1, s[8:11], s91 offen sc1
    v_mov_b32 v6, v60
    v_mfma_f32_4x4x4_16b_bf16 v[56:59], v[20:21], v[60:61], 0
    v_mfma_f32_4x4x4_16b_bf16 v[60:63], v[20:21], v[62:63], 0
    s_waitcnt vmcnt(3)
    buffer_load_dwordx4 v[92:95], v1, s[8:11], s92 offen sc1
    v_max_u32 v6, v6, v68
    v_mfma_f32_4x4x4_16b_bf16 v[64:67], v[20:21], v[68:69], 0
    v_mfma_f32_4x4x4_16b_bf16 v[68:71], v[20:21], v[70:71], 0
    s_waitcnt vmcnt(3)
    buffer_load_dwordx4 v[96:99], v1, s[8:11], s93 offen sc1
    v_max_u32 v6, v6, v76
    v_mfma_f32_4x4x4_16b_bf16 v[72:75], v[20:21], v[76:77], 0
    v_mfma_f32_4x4x4_16b_bf16 v[76:79], v[20:21], v[78:79], 0
    s_waitcnt vmcnt(3)
    buffer_load_dwordx4 v[100:103], v1, s[8:11], s94 offen sc1
    v_max_u32 v6, v6, v84
    v_mfma_f32_4x4x4_16b_bf16 v[80:83], v[20:21], v[84:85], 0
    v_mfma_f32_4x4x4_16b_bf16 v[84:87], v[20:21], v[86:87], 0
    s_barrier
    buffer_store_dwordx4 v[32:35], v10, s[8:11], s82 offen sc1
    buffer_store_dwordx4 v[36:39], v10, s[8:11], s5 offen sc1
    buffer_store_dword v13, v15, s[8:11], s67 offen sc1
    buffer_load_dword v0, v14, s[8:11], s6 offen sc1
L_rl_17:
    s_waitcnt vmcnt(6)
    v_mfma_f32_4x4x4_16b_bf16 v[56:59], v[20:21], v[88:89], v[56:59]
    v_max3_u32 v6, v6, v88, v92
    v_mfma_f32_4x4x4_16b_bf16 v[60:63], v[20:21], v[90:91], v[60:63]
    v_mfma_f32_4x4x4_16b_bf16 v[64:67], v[20:21], v[92:93], v[64:67]
    v_mfma_f32_4x4x4_16b_bf16 v[68:71], v[20:21], v[94:95], v[68:71]
    v_cvt_pk_bf16_f32 v88, v56, v57
    v_cvt_pk_bf16_f32 v89, v58, v59
    v_cvt_pk_bf16_f32 v90, v60, v61
    v_cvt_pk_bf16_f32 v91, v62, v63
    ds_write_b128 v5, v[88:91] offset:0
    s_nop 0
    v_smfmac_f32_16x16x64_bf16 v[40:43], v[88:91], a[0:7], v2
    ds_read_b128 v[120:123], v4 offset:0
    v_cvt_pk_bf16_f32 v92, v64, v65
    v_smfmac_f32_16x16x64_bf16 v[44:47], v[88:91], v[128:135], v2
    ds_read_b128 v[124:127], v4 offset:1024
    v_cvt_pk_bf16_f32 v93, v66, v67
    v_smfmac_f32_16x16x64_bf16 v[48:51], v[88:91], a[128:135], v2
    s_waitcnt lgkmcnt(5)
    v_cvt_pk_bf16_f32 v94, v68, v69
    v_smfmac_f32_16x16x64_bf16 v[52:55], v[88:91], v[104:111], v2
    v_cvt_pk_bf16_f32 v95, v70, v71
    ds_write_b128 v5, v[92:95] offset:1024
    s_waitcnt vmcnt(4)
    v_mfma_f32_4x4x4_16b_bf16 v[72:75], v[20:21], v[96:97], v[72:75]
    v_max3_u32 v6, v6, v96, v100
    v_mfma_f32_4x4x4_16b_bf16 v[76:79], v[20:21], v[98:99], v[76:79]
    v_mfma_f32_4x4x4_16b_bf16 v[80:83], v[20:21], v[100:101], v[80:83]
    v_mfma_f32_4x4x4_16b_bf16 v[84:87], v[20:21], v[102:103], v[84:87]
    v_smfmac_f32_16x16x64_bf16 v[40:43], v[92:95], a[32:39], v2
    ds_read_b128 v[104:107], v4 offset:32768
    v_cvt_pk_bf16_f32 v96, v72, v73
    v_cvt_pk_bf16_f32 v97, v74, v75
    v_smfmac_f32_16x16x64_bf16 v[44:47], v[92:95], v[160:167], v2
    ds_read_b128 v[108:111], v4 offset:33792
    v_cvt_pk_bf16_f32 v98, v76, v77
    v_cvt_pk_bf16_f32 v99, v78, v79
    v_smfmac_f32_16x16x64_bf16 v[48:51], v[92:95], a[160:167], v2
    ds_write_b128 v5, v[96:99] offset:2048
    s_waitcnt lgkmcnt(7)
    v_cvt_pk_bf16_f32 v100, v80, v81
    v_cvt_pk_bf16_f32 v101, v82, v83
    v_smfmac_f32_16x16x64_bf16 v[52:55], v[92:95], v[112:119], v2
    v_cvt_pk_bf16_f32 v102, v84, v85
    v_cvt_pk_bf16_f32 v103, v86, v87
    ds_write_b128 v5, v[100:103] offset:3072
    v_smfmac_f32_16x16x64_bf16 v[40:43], v[96:99], a[64:71], v2
    ds_read_b128 v[112:115], v3 offset:2048
    v_cmp_eq_u32 vcc, -1, v6
    v_smfmac_f32_16x16x64_bf16 v[44:47], v[96:99], v[192:199], v2
    ds_read_b128 v[116:119], v3 offset:3072
    v_xor_b32 v5, 4096, v5
    v_smfmac_f32_16x16x64_bf16 v[48:51], v[96:99], a[192:199], v2
    s_waitcnt lgkmcnt(7)
    v_smfmac_f32_16x16x64_bf16 v[52:55], v[96:99], v[120:127], v2
    s_cbranch_vccnz L_fix_18
    s_waitcnt lgkmcnt(2)
    s_barrier
    ds_read_b128 v[56:59], v5 offset:0
    v_smfmac_f32_16x16x64_bf16 v[40:43], v[100:103], a[96:103], v2
    ds_read_b128 v[60:63], v5 offset:1024
    ds_read_b128 v[64:67], v5 offset:2048
    v_smfmac_f32_16x16x64_bf16 v[44:47], v[100:103], v[224:231], v2
    ds_read_b128 v[120:123], v3 offset:34816
    ds_read_b128 v[124:127], v3 offset:35840
    v_smfmac_f32_16x16x64_bf16 v[48:51], v[100:103], a[224:231], v2
    v_smfmac_f32_16x16x64_bf16 v[52:55], v[100:103], v[104:111], v2
    s_waitcnt lgkmcnt(4)
    v_smfmac_f32_16x16x64_bf16 v[40:43], v[56:59], a[8:15], v2
    ds_read_b128 v[68:71], v5 offset:3072
    ds_read_b128 v[104:107], v4 offset:2048
    v_smfmac_f32_16x16x64_bf16 v[44:47], v[56:59], v[136:143], v2
    ds_read_b128 v[108:111], v4 offset:3072
    v_smfmac_f32_16x16x64_bf16 v[48:51], v[56:59], a[136:143], v2
    v_add_u32 v6, 152064, v1
    v_smfmac_f32_16x16x64_bf16 v[52:55], v[56:59], v[112:119], v2
    s_waitcnt lgkmcnt(6)
    v_xor_b32 v5, 8192, v5
    v_smfmac_f32_16x16x64_bf16 v[40:43], v[60:63], a[40:47], v2
    ds_read_b128 v[56:59], v5 offset:0
    ds_read_b128 v[112:115], v4 offset:34816
    v_smfmac_f32_16x16x64_bf16 v[44:47], v[60:63], v[168:175], v2
    ds_read_b128 v[116:119], v4 offset:35840
    v_smfmac_f32_16x16x64_bf16 v[48:51], v[60:63], a[168:175], v2
    s_waitcnt lgkmcnt(6)
    v_smfmac_f32_16x16x64_bf16 v[52:55], v[60:63], v[120:127], v2
    v_smfmac_f32_16x16x64_bf16 v[40:43], v[64:67], a[72:79], v2
    ds_read_b128 v[60:63], v5 offset:1024
    ds_read_b128 v[120:123], v3 offset:6144
    v_smfmac_f32_16x16x64_bf16 v[44:47], v[64:67], v[200:207], v2
    ds_read_b128 v[124:127], v3 offset:7168
    s_and_b32 s86, s70, 3
    v_smfmac_f32_16x16x64_bf16 v[48:51], v[64:67], a[200:207], v2
    s_waitcnt lgkmcnt(6)
    v_smfmac_f32_16x16x64_bf16 v[52:55], v[64:67], v[104:111], v2
    v_smfmac_f32_16x16x64_bf16 v[40:43], v[68:71], a[104:111], v2
    ds_read_b128 v[64:67], v5 offset:2048
    ds_read_b128 v[104:107], v3 offset:38912
    v_smfmac_f32_16x16x64_bf16 v[44:47], v[68:71], v[232:239], v2
    ds_read_b128 v[108:111], v3 offset:39936
    s_lshl_b32 s85, s86, 15
    v_smfmac_f32_16x16x64_bf16 v[48:51], v[68:71], a[232:239], v2
    s_waitcnt lgkmcnt(6)
    v_smfmac_f32_16x16x64_bf16 v[52:55], v[68:71], v[112:119], v2
    v_smfmac_f32_16x16x64_bf16 v[40:43], v[56:59], a[24:31], v2
    ds_read_b128 v[68:71], v5 offset:3072
    ds_read_b128 v[112:115], v4 offset:6144
    v_smfmac_f32_16x16x64_bf16 v[44:47], v[56:59], v[152:159], v2
    ds_read_b128 v[116:119], v4 offset:7168
    s_add_u32 s85, s85, s73
    v_smfmac_f32_16x16x64_bf16 v[48:51], v[56:59], a[152:159], v2
    s_waitcnt lgkmcnt(6)
    v_smfmac_f32_16x16x64_bf16 v[52:55], v[56:59], v[120:127], v2
    v_xor_b32 v5, 4096, v5
    v_smfmac_f32_16x16x64_bf16 v[40:43], v[60:63], a[56:63], v2
    ds_read_b128 v[56:59], v5 offset:0
    ds_read_b128 v[120:123], v4 offset:38912
    v_smfmac_f32_16x16x64_bf16 v[44:47], v[60:63], v[184:191], v2
    ds_read_b128 v[124:127], v4 offset:39936
    s_add_u32 s82, s75, 67108864
    v_smfmac_f32_16x16x64_bf16 v[48:51], v[60:63], a[184:191], v2
    s_waitcnt lgkmcnt(6)
    v_smfmac_f32_16x16x64_bf16 v[52:55], v[60:63], v[104:111], v2
    v_smfmac_f32_16x16x64_bf16 v[40:43], v[64:67], a[88:95], v2
    ds_read_b128 v[60:63], v5 offset:1024
    ds_read_b128 v[104:107], v3 offset:4096
    ds_read_b128 v[108:111], v3 offset:5120
    v_smfmac_f32_16x16x64_bf16 v[44:47], v[64:67], v[216:223], v2
    s_add_u32 s4, s75, s81
    s_add_u32 s5, s4, 4096
    v_smfmac_f32_16x16x64_bf16 v[48:51], v[64:67], a[216:223], v2
    s_waitcnt lgkmcnt(6)
    v_smfmac_f32_16x16x64_bf16 v[52:55], v[64:67], v[112:119], v2
    v_smfmac_f32_16x16x64_bf16 v[40:43], v[68:71], a[120:127], v2
    ds_read_b128 v[64:67], v5 offset:2048
    ds_read_b128 v[112:115], v3 offset:36864
    ds_read_b128 v[116:119], v3 offset:37888
    v_smfmac_f32_16x16x64_bf16 v[44:47], v[68:71], v[248:255], v2
    s_lshl_b32 s6, s86, 11
    s_add_u32 s6, s6, s74
    v_smfmac_f32_16x16x64_bf16 v[48:51], v[68:71], a[248:255], v2
    s_waitcnt lgkmcnt(6)
    v_smfmac_f32_16x16x64_bf16 v[52:55], v[68:71], v[120:127], v2
    v_smfmac_f32_16x16x64_bf16 v[40:43], v[56:59], a[16:23], v2
    ds_read_b128 v[68:71], v5 offset:3072
    ds_read_b128 v[120:123], v4 offset:4096
    ds_read_b128 v[124:127], v4 offset:5120
    v_smfmac_f32_16x16x64_bf16 v[44:47], v[56:59], v[144:151], v2
    s_xor_b32 s7, s6, 512
    s_lshl1_add_u32 s86, s70, 2
    v_smfmac_f32_16x16x64_bf16 v[48:51], v[56:59], a[144:151], v2
    s_waitcnt lgkmcnt(6)
    v_smfmac_f32_16x16x64_bf16 v[52:55], v[56:59], v[104:111], v2
    v_xor_b32 v5, 8192, v5
    v_smfmac_f32_16x16x64_bf16 v[40:43], v[60:63], a[48:55], v2
    ds_read_b128 v[104:107], v4 offset:36864
    ds_read_b128 v[108:111], v4 offset:37888
    v_smfmac_f32_16x16x64_bf16 v[44:47], v[60:63], v[176:183], v2
    ds_read_b128 v[72:75], v6 offset:0
    ds_read_b128 v[76:79], v6 offset:1024
    v_smfmac_f32_16x16x64_bf16 v[48:51], v[60:63], a[176:183], v2
    s_waitcnt lgkmcnt(7)
    v_smfmac_f32_16x16x64_bf16 v[52:55], v[60:63], v[112:119], v2
    v_smfmac_f32_16x16x64_bf16 v[40:43], v[64:67], a[80:87], v2
    ds_read_b128 v[80:83], v6 offset:2048
    ds_read_b128 v[84:87], v6 offset:3072
    v_smfmac_f32_16x16x64_bf16 v[44:47], v[64:67], v[208:215], v2
    ds_read_b128 v[88:91], v6 offset:4096
    v_smfmac_f32_16x16x64_bf16 v[48:51], v[64:67], a[208:215], v2
    s_waitcnt lgkmcnt(7)
    v_smfmac_f32_16x16x64_bf16 v[52:55], v[64:67], v[120:127], v2
    v_smfmac_f32_16x16x64_bf16 v[40:43], v[68:71], a[112:119], v2
    ds_read_b128 v[92:95], v6 offset:5120
    ds_read_b128 v[96:99], v6 offset:6144
    v_smfmac_f32_16x16x64_bf16 v[44:47], v[68:71], v[240:247], v2
    ds_read_b128 v[100:103], v6 offset:7168
    v_smfmac_f32_16x16x64_bf16 v[48:51], v[68:71], a[240:247], v2
    s_waitcnt lgkmcnt(8)
    v_pk_add_f32 v[40:41], v[40:41], v[42:43]
    v_smfmac_f32_16x16x64_bf16 v[52:55], v[68:71], v[104:111], v2
    v_pk_add_f32 v[44:45], v[44:45], v[46:47]
    v_cvt_pk_bf16_f32 v40, v40, v41
    v_cvt_pk_bf16_f32 v41, v44, v45
    ds_write_b64 v7, v[40:41]
    v_pk_add_f32 v[48:49], v[48:49], v[50:51]
    v_cvt_pk_bf16_f32 v48, v48, v49
    v_mov_b32 v125, 0
    v_mov_b32 v126, 0
    v_pk_add_f32 v[52:53], v[52:53], v[54:55]
    v_cvt_pk_bf16_f32 v49, v52, v53
    ds_write_b64 v7, v[48:49] offset:128
    v_mov_b32 v6, s86
    s_cmp_eq_u32 s70, s2
    s_cbranch_scc1 L_qk_spec1
L_qk_back1:
    s_waitcnt lgkmcnt(0)
    s_barrier
    ds_read_b64_tr_b16 v[56:57], v8 offset:0
    ds_read_b64_tr_b16 v[58:59], v8 offset:128
    ds_read_b64_tr_b16 v[60:61], v8 offset:256
    ds_read_b64_tr_b16 v[62:63], v8 offset:384
    ds_read_b64_tr_b16 v[64:65], v8 offset:512
    ds_read_b64_tr_b16 v[66:67], v8 offset:640
    ds_read_b64_tr_b16 v[68:69], v8 offset:768
    ds_read_b64_tr_b16 v[70:71], v8 offset:896
    s_waitcnt lgkmcnt(6)
    v_mfma_f32_16x16x32_bf16 v[40:43], v[72:75], v[56:59], 0
    v_mfma_f32_16x16x32_bf16 v[44:47], v[76:79], v[56:59], 0
    s_waitcnt lgkmcnt(4)
    v_mfma_f32_16x16x32_bf16 v[40:43], v[80:83], v[60:63], v[40:43]
    buffer_load_dwordx2 v[120:121], v11, s[8:11], s6 offen sc1
    v_mfma_f32_16x16x32_bf16 v[44:47], v[84:87], v[60:63], v[44:47]
    buffer_load_dwordx2 v[122:123], v11, s[8:11], s7 offen sc1
    s_waitcnt lgkmcnt(2)
    v_mfma_f32_16x16x32_bf16 v[40:43], v[88:91], v[64:67], v[40:43]
    buffer_load_dwordx4 v[104:107], v1, s[8:11], s4 offen offset:0 sc1
    v_mfma_f32_16x16x32_bf16 v[44:47], v[92:95], v[64:67], v[44:47]
    s_waitcnt lgkmcnt(0)
    v_mfma_f32_16x16x32_bf16 v[40:43], v[96:99], v[68:71], v[40:43]
    buffer_load_dwordx4 v[108:111], v1, s[8:11], s4 offen offset:2048 sc1
    v_mfma_f32_16x16x32_bf16 v[44:47], v[100:103], v[68:71], v[44:47]
    v_mfma_f32_16x16x32_bf16 v[48:51], v[56:59], v[56:59], 0
    buffer_load_dwordx4 v[112:115], v1, s[8:11], s5 offen offset:0 sc1
    v_mfma_f32_16x16x32_bf16 v[48:51], v[60:63], v[60:63], v[48:51]
    v_max3_f32 v14, v40, v41, v42
    v_mfma_f32_16x16x32_bf16 v[48:51], v[64:67], v[64:67], v[48:51]
    v_max3_f32 v14, v14, v43, v44
    v_max3_f32 v14, v14, v45, v46
    v_mfma_f32_16x16x32_bf16 v[48:51], v[68:71], v[68:71], v[48:51]
    buffer_load_dwordx4 v[116:119], v1, s[8:11], s5 offen offset:2048 sc1
    v_max_f32 v14, v14, v47
    s_nop 5
    v_max3_f32 v12, v14, v50, v51
    v_max3_f32 v13, v14, v50, v51
    s_nop 1
    v_permlane16_swap_b32 v12, v13
    v_max_f32 v14, v12, v13
    v_max_f32 v12, v12, v13
    s_nop 1
    v_permlane32_swap_b32 v12, v14
    v_max_f32 v14, v12, v14
    v_mul_f32 v14, s77, v14
    v_pk_fma_f32 v[40:41], v[40:41], s[78:79], v[14:15] op_sel_hi:[1,1,0]
    v_pk_fma_f32 v[42:43], v[42:43], s[78:79], v[14:15] op_sel_hi:[1,1,0]
    v_pk_fma_f32 v[44:45], v[44:45], s[78:79], v[14:15] op_sel_hi:[1,1,0]
    v_pk_fma_f32 v[46:47], v[46:47], s[78:79], v[14:15] op_sel_hi:[1,1,0]
    v_exp_f32 v40, v40
    v_exp_f32 v41, v41
    v_exp_f32 v42, v42
    v_cvt_pk_bf16_f32 v52, v40, v41
    v_exp_f32 v43, v43
    v_exp_f32 v44, v44
    v_cvt_pk_bf16_f32 v53, v42, v43
    v_exp_f32 v45, v45
    v_exp_f32 v46, v46
    v_cvt_pk_bf16_f32 v54, v44, v45
    v_exp_f32 v47, v47
    s_waitcnt vmcnt(4)
    v_max_u32 v0, v120, v122
    v_pk_fma_f32 v[12:13], v[50:51], s[78:79], v[14:15] op_sel_hi:[1,1,0]
    v_cvt_pk_bf16_f32 v55, v46, v47
    v_cmp_eq_u32 vcc, -1, v0
    v_exp_f32 v12, v12
    v_mfma_f32_16x16x32_bf16 v[48:51], v[16:19], v[52:55], 0
    v_exp_f32 v13, v13
    v_mfma_f32_16x16x32_bf16 v[40:43], v[24:27], v[52:55], 0
    buffer_store_dword v6, v15, s[8:11], s84 offen offset:512 sc1
    v_cvt_pk_bf16_f32 v124, v12, v13
    v_cvt_pk_bf16_f32 v127, v12, v13
    v_mfma_f32_16x16x32_bf16 v[44:47], v[28:31], v[52:55], 0
    s_cbranch_vccnz L_fix_20
L_rv_19:
    v_mfma_f32_16x16x16_bf16 v[48:51], v[16:17], v[124:125], v[48:51]
    v_mfma_f32_16x16x16_bf16 v[40:43], v[120:121], v[124:125], v[40:43]
    v_mfma_f32_16x16x16_bf16 v[44:47], v[120:121], v[126:127], v[44:47]
    v_rcp_f32 v14, v48
    s_nop 2
    v_pk_mul_f32 v[40:41], v[40:41], v[14:15] op_sel_hi:[1,0]
    v_pk_mul_f32 v[42:43], v[42:43], v[14:15] op_sel_hi:[1,0]
    v_cvt_pk_bf16_f32 v52, v40, v41
    v_cvt_pk_bf16_f32 v53, v42, v43
    v_pk_mul_f32 v[44:45], v[44:45], v[14:15] op_sel_hi:[1,0]
    v_pk_mul_f32 v[46:47], v[46:47], v[14:15] op_sel_hi:[1,0]
    v_cvt_pk_bf16_f32 v54, v44, v45
    v_cvt_pk_bf16_f32 v55, v46, v47
    buffer_store_dwordx4 v[52:55], v9, s[8:11], s85 offen sc1
    s_waitcnt vmcnt(2)
    v_cndmask_b32 v40, 0, v22, s[32:33]
    v_cndmask_b32 v41, 0, v22, s[34:35]
    v_cndmask_b32 v42, 0, v22, s[36:37]
    v_cndmask_b32 v43, 0, v22, s[38:39]
    v_cndmask_b32 v44, 0, v22, s[40:41]
    v_cndmask_b32 v45, 0, v22, s[42:43]
    v_cndmask_b32 v46, 0, v22, s[44:45]
    v_cndmask_b32 v47, 0, v22, s[46:47]
    v_mfma_f32_16x16x32_bf16 v[40:43], v[72:75], v[104:107], v[40:43]
    v_mfma_f32_16x16x32_bf16 v[40:43], v[80:83], v[108:111], v[40:43]
    v_mfma_f32_16x16x32_bf16 v[40:43], v[88:91], v[112:115], v[40:43]
    v_mfma_f32_16x16x32_bf16 v[40:43], v[96:99], v[116:119], v[40:43]
    v_mfma_f32_16x16x32_bf16 v[44:47], v[76:79], v[104:107], v[44:47]
    v_mfma_f32_16x16x32_bf16 v[44:47], v[84:87], v[108:111], v[44:47]
    v_mfma_f32_16x16x32_bf16 v[44:47], v[92:95], v[112:115], v[44:47]
    v_mfma_f32_16x16x32_bf16 v[44:47], v[100:103], v[116:119], v[44:47]
    v_mfma_f32_16x16x32_bf16 v[48:51], v[56:59], v[104:107], 0
    v_max3_f32 v14, v40, v41, v42
    v_mfma_f32_16x16x32_bf16 v[48:51], v[60:63], v[108:111], v[48:51]
    v_mfma_f32_16x16x32_bf16 v[48:51], v[64:67], v[112:115], v[48:51]
    v_max3_f32 v14, v14, v43, v44
    v_max3_f32 v14, v14, v45, v46
    v_mfma_f32_16x16x32_bf16 v[48:51], v[68:71], v[116:119], v[48:51]
    v_max_f32 v14, v14, v47
    s_add_u32 s4, s75, 50331648
    s_xor_b32 s4, s4, 2048
    buffer_load_dwordx4 v[32:35], v1, s[8:11], s4 offen offset:0 sc1
    buffer_load_dwordx4 v[36:39], v1, s[8:11], s4 offen offset:1024 sc1
    v_mov_b64 v[104:105], -1
    v_mov_b64 v[106:107], -1
    s_xor_b32 s85, s85, 0x10000
    buffer_store_dwordx4 v[104:107], v9, s[8:11], s85 offen sc1
    s_mov_b32 m0, s80
    s_add_u32 s5, s75, 33816576
    buffer_load_dwordx4 v1, s[8:11], s5 offen offset:0 sc1 lds
    buffer_load_dwordx4 v1, s[8:11], s5 offen offset:1024 sc1 lds
    v_max3_f32 v12, v14, v50, v51
    v_max3_f32 v13, v14, v50, v51
    s_nop 1
    v_permlane16_swap_b32 v12, v13
    v_max_f32 v14, v12, v13
    v_max_f32 v12, v12, v13
    s_nop 1
    v_permlane32_swap_b32 v12, v14
    v_max_f32 v14, v12, v14
    v_mul_f32 v14, s77, v14
    v_pk_fma_f32 v[40:41], v[40:41], s[78:79], v[14:15] op_sel_hi:[1,1,0]
    v_pk_fma_f32 v[42:43], v[42:43], s[78:79], v[14:15] op_sel_hi:[1,1,0]
    v_pk_fma_f32 v[44:45], v[44:45], s[78:79], v[14:15] op_sel_hi:[1,1,0]
    v_pk_fma_f32 v[46:47], v[46:47], s[78:79], v[14:15] op_sel_hi:[1,1,0]
    v_exp_f32 v40, v40
    v_exp_f32 v41, v41
    v_exp_f32 v42, v42
    v_cvt_pk_bf16_f32 v52, v40, v41
    v_exp_f32 v43, v43
    v_exp_f32 v44, v44
    v_cvt_pk_bf16_f32 v53, v42, v43
    v_exp_f32 v45, v45
    v_exp_f32 v46, v46
    v_cvt_pk_bf16_f32 v54, v44, v45
    v_exp_f32 v47, v47
    v_pk_fma_f32 v[12:13], v[50:51], s[78:79], v[14:15] op_sel_hi:[1,1,0]
    v_cvt_pk_bf16_f32 v55, v46, v47
    v_exp_f32 v12, v12
    s_nop 0
    v_mfma_f32_16x16x32_bf16 v[48:51], v[16:19], v[52:55], 0
    v_exp_f32 v13, v13
    v_mfma_f32_16x16x32_bf16 v[72:75], v[24:27], v[52:55], 0
    v_cvt_pk_bf16_f32 v124, v12, v13
    v_cvt_pk_bf16_f32 v127, v12, v13
    v_mfma_f32_16x16x32_bf16 v[76:79], v[28:31], v[52:55], 0
    s_waitcnt vmcnt(3)
    v_mov_b32 v0, 0
    v_mfma_f32_16x16x32_bf16 v[80:83], v[32:35], v[52:55], 0
    v_mfma_f32_16x16x32_bf16 v[84:87], v[36:39], v[52:55], 0
    s_add_u32 s4, s75, 50593792
    buffer_load_dwordx4 v[24:27], v1, s[8:11], s4 offen offset:0 sc1
    buffer_load_dwordx4 v[28:31], v1, s[8:11], s4 offen offset:1024 sc1
    v_mfma_f32_16x16x16_bf16 v[48:51], v[16:17], v[124:125], v[48:51]
    v_mfma_f32_16x16x16_bf16 v[72:75], v[120:121], v[124:125], v[72:75]
    v_mfma_f32_16x16x16_bf16 v[76:79], v[120:121], v[126:127], v[76:79]
    v_rcp_f32 v14, v48
    v_mfma_f32_16x16x16_bf16 v[80:83], v[122:123], v[124:125], v[80:83]
    v_mfma_f32_16x16x16_bf16 v[84:87], v[122:123], v[126:127], v[84:87]
    v_pk_mul_f32 v[72:73], v[72:73], v[14:15] op_sel_hi:[1,0]
    v_pk_mul_f32 v[74:75], v[74:75], v[14:15] op_sel_hi:[1,0]
    v_cvt_pk_bf16_f32 v32, v72, v73
    v_cvt_pk_bf16_f32 v33, v74, v75
    v_pk_mul_f32 v[76:77], v[76:77], v[14:15] op_sel_hi:[1,0]
    v_pk_mul_f32 v[78:79], v[78:79], v[14:15] op_sel_hi:[1,0]
    v_cvt_pk_bf16_f32 v34, v76, v77
    v_cvt_pk_bf16_f32 v35, v78, v79
    v_pk_mul_f32 v[80:81], v[80:81], v[14:15] op_sel_hi:[1,0]
    v_pk_mul_f32 v[82:83], v[82:83], v[14:15] op_sel_hi:[1,0]
    v_cvt_pk_bf16_f32 v36, v80, v81
    v_cvt_pk_bf16_f32 v37, v82, v83
    v_pk_mul_f32 v[84:85], v[84:85], v[14:15] op_sel_hi:[1,0]
    v_pk_mul_f32 v[86:87], v[86:87], v[14:15] op_sel_hi:[1,0]
    v_cvt_pk_bf16_f32 v38, v84, v85
    v_cvt_pk_bf16_f32 v39, v86, v87
    s_add_u32 s4, s99, 128
    s_or_b32 s5, s4, 0x2400
    s_sub_u32 s4, s5, s99
    s_mov_b32 s99, s5
    s_add_u32 s3, s3, s4
    s_mov_b64 exec, 0xffff
    v_add_u32 v23, s4, v23
    s_mov_b64 exec, -1
    s_add_u32 s75, s75, 262144
    s_add_u32 s70, s70, 1
    s_branch L_qk_loop1
L_qk_spec1:
    s_cmp_eq_u32 s70, 63
    s_cbranch_scc1 L_qk_last1
    buffer_load_dword v0, v15, s[24:27], 0 offen offset:132 sc1
    s_waitcnt vmcnt(0)
    v_readfirstlane_b32 s83, v0
    s_nop 0
    s_cmp_gt_i32 s83, 0
    s_cselect_b32 s83, 8192, 0
    s_add_u32 s3, s3, s83
    s_add_u32 s72, s72, s83
    s_mov_b64 exec, 0xffff
    v_add_u32 v23, s83, v23
    s_mov_b64 exec, -1
    s_mov_b32 s2, 63
    s_branch L_qk_back1
L_qk_last1:
    s_waitcnt lgkmcnt(0)
    s_barrier
    ds_read_b64_tr_b16 v[56:57], v8 offset:0
    ds_read_b64_tr_b16 v[58:59], v8 offset:128
    ds_read_b64_tr_b16 v[60:61], v8 offset:256
    ds_read_b64_tr_b16 v[62:63], v8 offset:384
    ds_read_b64_tr_b16 v[64:65], v8 offset:512
    ds_read_b64_tr_b16 v[66:67], v8 offset:640
    ds_read_b64_tr_b16 v[68:69], v8 offset:768
    ds_read_b64_tr_b16 v[70:71], v8 offset:896
    buffer_load_dwordx4 v[104:107], v1, s[8:11], s4 offen offset:0 sc1
    buffer_load_dwordx4 v[108:111], v1, s[8:11], s4 offen offset:2048 sc1
    buffer_load_dwordx4 v[112:115], v1, s[8:11], s5 offen offset:0 sc1
    buffer_load_dwordx4 v[116:119], v1, s[8:11], s5 offen offset:2048 sc1
    s_add_u32 s4, s75, 50331648
    s_xor_b32 s4, s4, 2048
    buffer_load_dwordx4 v[32:35], v1, s[8:11], s4 offen offset:0 sc1
    buffer_load_dwordx4 v[36:39], v1, s[8:11], s4 offen offset:1024 sc1
    buffer_load_dwordx2 v[120:121], v11, s[8:11], s6 offen sc1
    buffer_load_dwordx2 v[122:123], v11, s[8:11], s7 offen sc1
    s_waitcnt vmcnt(0)
    v_max_u32 v0, v120, v122
    v_cmp_eq_u32 vcc, -1, v0
    s_cbranch_vccnz L_fix_23
L_rv_22:
    v_mov_b32 v52, 63
    v_mov_b32 v53, 63
    v_mov_b32 v54, 63
    v_mov_b32 v55, 63
    s_cmp_eq_u32 s63, 0
    s_cselect_b64 exec, 1, 0
    s_barrier
    buffer_store_dwordx4 v[52:55], v15, s[8:11], s67 offen sc1
    s_mov_b64 exec, -1
    s_waitcnt lgkmcnt(0)
    v_cndmask_b32 v40, 0, v22, s[32:33]
    v_cndmask_b32 v41, 0, v22, s[34:35]
    v_cndmask_b32 v42, 0, v22, s[36:37]
    v_cndmask_b32 v43, 0, v22, s[38:39]
    v_cndmask_b32 v44, 0, v22, s[40:41]
    v_cndmask_b32 v45, 0, v22, s[42:43]
    v_cndmask_b32 v46, 0, v22, s[44:45]
    v_cndmask_b32 v47, 0, v22, s[46:47]
    v_mfma_f32_16x16x32_bf16 v[40:43], v[72:75], v[104:107], v[40:43]
    v_mfma_f32_16x16x32_bf16 v[40:43], v[80:83], v[108:111], v[40:43]
    v_mfma_f32_16x16x32_bf16 v[40:43], v[88:91], v[112:115], v[40:43]
    v_mfma_f32_16x16x32_bf16 v[40:43], v[96:99], v[116:119], v[40:43]
    v_mfma_f32_16x16x32_bf16 v[44:47], v[76:79], v[104:107], v[44:47]
    v_mfma_f32_16x16x32_bf16 v[44:47], v[84:87], v[108:111], v[44:47]
    v_mfma_f32_16x16x32_bf16 v[44:47], v[92:95], v[112:115], v[44:47]
    v_mfma_f32_16x16x32_bf16 v[44:47], v[100:103], v[116:119], v[44:47]
    v_mfma_f32_16x16x32_bf16 v[48:51], v[56:59], v[104:107], 0
    v_max3_f32 v14, v40, v41, v42
    v_mfma_f32_16x16x32_bf16 v[48:51], v[60:63], v[108:111], v[48:51]
    v_mfma_f32_16x16x32_bf16 v[48:51], v[64:67], v[112:115], v[48:51]
    v_max3_f32 v14, v14, v43, v44
    v_max3_f32 v14, v14, v45, v46
    v_mfma_f32_16x16x32_bf16 v[48:51], v[68:71], v[116:119], v[48:51]
    v_max_f32 v14, v14, v47
    s_nop 6
    v_max3_f32 v12, v14, v50, v51
    v_max3_f32 v13, v14, v50, v51
    s_nop 1
    v_permlane16_swap_b32 v12, v13
    v_max_f32 v14, v12, v13
    v_max_f32 v12, v12, v13
    s_nop 1
    v_permlane32_swap_b32 v12, v14
    v_max_f32 v14, v12, v14
    v_mul_f32 v14, s77, v14
    v_pk_fma_f32 v[40:41], v[40:41], s[78:79], v[14:15] op_sel_hi:[1,1,0]
    v_pk_fma_f32 v[42:43], v[42:43], s[78:79], v[14:15] op_sel_hi:[1,1,0]
    v_pk_fma_f32 v[44:45], v[44:45], s[78:79], v[14:15] op_sel_hi:[1,1,0]
    v_pk_fma_f32 v[46:47], v[46:47], s[78:79], v[14:15] op_sel_hi:[1,1,0]
    v_exp_f32 v40, v40
    v_exp_f32 v41, v41
    v_exp_f32 v42, v42
    v_cvt_pk_bf16_f32 v52, v40, v41
    v_exp_f32 v43, v43
    v_exp_f32 v44, v44
    v_cvt_pk_bf16_f32 v53, v42, v43
    v_exp_f32 v45, v45
    v_exp_f32 v46, v46
    v_cvt_pk_bf16_f32 v54, v44, v45
    v_exp_f32 v47, v47
    v_pk_fma_f32 v[12:13], v[50:51], s[78:79], v[14:15] op_sel_hi:[1,1,0]
    v_cvt_pk_bf16_f32 v55, v46, v47
    v_exp_f32 v12, v12
    s_nop 0
    v_mfma_f32_16x16x32_bf16 v[48:51], v[16:19], v[52:55], 0
    v_exp_f32 v13, v13
    v_mfma_f32_16x16x32_bf16 v[72:75], v[24:27], v[52:55], 0
    v_cvt_pk_bf16_f32 v124, v12, v13
    v_cvt_pk_bf16_f32 v127, v12, v13
    v_mfma_f32_16x16x32_bf16 v[76:79], v[28:31], v[52:55], 0
    v_mfma_f32_16x16x32_bf16 v[80:83], v[32:35], v[52:55], 0
    v_mfma_f32_16x16x32_bf16 v[84:87], v[36:39], v[52:55], 0
    v_mfma_f32_16x16x16_bf16 v[48:51], v[16:17], v[124:125], v[48:51]
    v_mfma_f32_16x16x16_bf16 v[72:75], v[120:121], v[124:125], v[72:75]
    v_mfma_f32_16x16x16_bf16 v[76:79], v[120:121], v[126:127], v[76:79]
    v_rcp_f32 v14, v48
    v_mfma_f32_16x16x16_bf16 v[80:83], v[122:123], v[124:125], v[80:83]
    v_mfma_f32_16x16x16_bf16 v[84:87], v[122:123], v[126:127], v[84:87]
    v_pk_mul_f32 v[72:73], v[72:73], v[14:15] op_sel_hi:[1,0]
    v_pk_mul_f32 v[74:75], v[74:75], v[14:15] op_sel_hi:[1,0]
    v_cvt_pk_bf16_f32 v32, v72, v73
    v_cvt_pk_bf16_f32 v33, v74, v75
    v_pk_mul_f32 v[76:77], v[76:77], v[14:15] op_sel_hi:[1,0]
    v_pk_mul_f32 v[78:79], v[78:79], v[14:15] op_sel_hi:[1,0]
    v_cvt_pk_bf16_f32 v34, v76, v77
    v_cvt_pk_bf16_f32 v35, v78, v79
    v_pk_mul_f32 v[80:81], v[80:81], v[14:15] op_sel_hi:[1,0]
    v_pk_mul_f32 v[82:83], v[82:83], v[14:15] op_sel_hi:[1,0]
    v_cvt_pk_bf16_f32 v36, v80, v81
    v_cvt_pk_bf16_f32 v37, v82, v83
    v_pk_mul_f32 v[84:85], v[84:85], v[14:15] op_sel_hi:[1,0]
    v_pk_mul_f32 v[86:87], v[86:87], v[14:15] op_sel_hi:[1,0]
    v_cvt_pk_bf16_f32 v38, v84, v85
    v_cvt_pk_bf16_f32 v39, v86, v87
    s_xor_b32 s5, s82, 2048
    buffer_store_dwordx4 v[32:35], v10, s[8:11], s82 offen sc1
    buffer_store_dwordx4 v[36:39], v10, s[8:11], s5 offen sc1
    s_waitcnt vmcnt(0)
    v_mov_b32 v52, 64
    v_mov_b32 v53, 64
    v_mov_b32 v54, 64
    v_mov_b32 v55, 64
    s_cmp_eq_u32 s63, 0
    s_cselect_b64 exec, 1, 0
    s_barrier
    buffer_store_dwordx4 v[52:55], v15, s[8:11], s67 offen sc1
    s_mov_b64 exec, -1
    s_endpgm
L_fix_18:
    s_nop 7
    buffer_load_dwordx4 v[60:63], v1, s[8:11], s87 offen sc1
    buffer_load_dwordx4 v[68:71], v1, s[8:11], s88 offen sc1
    buffer_load_dwordx4 v[76:79], v1, s[8:11], s89 offen sc1
    buffer_load_dwordx4 v[84:87], v1, s[8:11], s90 offen sc1
    buffer_load_dwordx4 v[88:91], v1, s[8:11], s91 offen sc1
    buffer_load_dwordx4 v[92:95], v1, s[8:11], s92 offen sc1
    buffer_load_dwordx4 v[96:99], v1, s[8:11], s93 offen sc1
    buffer_load_dwordx4 v[100:103], v1, s[8:11], s94 offen sc1
    s_waitcnt vmcnt(0)
    v_max3_u32 v0, v60, v68, v76
    v_max3_u32 v0, v0, v84, v88
    v_max3_u32 v0, v0, v92, v96
    v_max_u32 v0, v0, v100
    v_cmp_eq_u32 vcc, -1, v0
    s_cbranch_vccz L_fix_18d
    s_sub_u32 s65, s65, 1
    s_cmp_gt_i32 s65, 0
    s_cbranch_scc1 L_fix_18
    s_endpgm
L_fix_18d:
    v_mov_b32 v6, 0
    s_waitcnt lgkmcnt(0)
    v_mfma_f32_4x4x4_16b_bf16 v[56:59], v[20:21], v[60:61], 0
    v_mfma_f32_4x4x4_16b_bf16 v[60:63], v[20:21], v[62:63], 0
    v_mfma_f32_4x4x4_16b_bf16 v[64:67], v[20:21], v[68:69], 0
    v_mfma_f32_4x4x4_16b_bf16 v[68:71], v[20:21], v[70:71], 0
    v_mfma_f32_4x4x4_16b_bf16 v[72:75], v[20:21], v[76:77], 0
    v_mfma_f32_4x4x4_16b_bf16 v[76:79], v[20:21], v[78:79], 0
    v_mfma_f32_4x4x4_16b_bf16 v[80:83], v[20:21], v[84:85], 0
    v_mfma_f32_4x4x4_16b_bf16 v[84:87], v[20:21], v[86:87], 0
    ds_read_b128 v[104:107], v3 offset:0
    ds_read_b128 v[108:111], v3 offset:1024
    ds_read_b128 v[112:115], v3 offset:32768
    ds_read_b128 v[116:119], v3 offset:33792
    v_mov_b32 v40, 0
    v_mov_b32 v41, 0
    v_mov_b32 v42, 0
    v_mov_b32 v43, 0
    v_mov_b32 v44, 0
    v_mov_b32 v45, 0
    v_mov_b32 v46, 0
    v_mov_b32 v47, 0
    v_mov_b32 v48, 0
    v_mov_b32 v49, 0
    v_mov_b32 v50, 0
    v_mov_b32 v51, 0
    v_mov_b32 v52, 0
    v_mov_b32 v53, 0
    v_mov_b32 v54, 0
    v_mov_b32 v55, 0
    v_xor_b32 v5, 4096, v5
    s_branch L_rl_17
L_fix_20:
    s_nop 7
    buffer_load_dwordx2 v[120:121], v11, s[8:11], s6 offen sc1
    buffer_load_dwordx2 v[122:123], v11, s[8:11], s7 offen sc1
    s_waitcnt vmcnt(0)
    v_max_u32 v0, v120, v122
    v_cmp_eq_u32 vcc, -1, v0
    s_cbranch_vccz L_fix_20d
    s_sub_u32 s65, s65, 1
    s_cmp_gt_i32 s65, 0
    s_cbranch_scc1 L_fix_20
    s_endpgm
L_fix_20d:
    s_branch L_rv_19
L_fix_23:
    s_nop 7
    buffer_load_dwordx2 v[120:121], v11, s[8:11], s6 offen sc1
    buffer_load_dwordx2 v[122:123], v11, s[8:11], s7 offen sc1
    s_waitcnt vmcnt(0)
    v_max_u32 v0, v120, v122
    v_cmp_eq_u32 vcc, -1, v0
    s_cbranch_vccz L_fix_23d
    s_sub_u32 s65, s65, 1
    s_cmp_gt_i32 s65, 0
    s_cbranch_scc1 L_fix_23
    s_endpgm
L_fix_23d:
    s_branch L_rv_22
L_lk_16:
    s_mov_b64 exec, 0xffff
    buffer_load_dword v12, v23, s[8:11], 0 offen sc1
    s_mov_b64 exec, -1
    s_waitcnt vmcnt(0)
    v_cmp_gt_u32 vcc, s83, v12
    s_cbranch_vccz L_lk_16e
    s_sub_u32 s65, s65, 1
    s_cmp_gt_i32 s65, 0
    s_cbranch_scc1 L_lk_16
    s_endpgm
L_lk_16e:
    s_branch L_lk_16d
L_vo:
    s_lshl_b32 s4, s69, 8
    s_lshr_b32 s5, s63, 1
    s_lshl_b32 s5, s5, 13
    s_add_u32 s4, s4, s5
    s_and_b32 s5, s63, 1
    s_lshl_b32 s5, s5, 7
    s_add_u32 s4, s4, s5
    s_add_u32 s4, s4, 105054208
    v_lshlrev_b32 v5, 14, v0
    s_mov_b64 exec, 15
    buffer_store_dword v16, v5, s[8:11], s4 offen sc1
    s_mov_b64 exec, -1
    s_lshl_b32 s4, s66, 16
    s_lshl_b32 s5, s68, 10
    s_add_u32 s4, s4, s5
    s_add_u32 s75, s4, 105119744
    s_lshl_b32 s4, s66, 17
    s_add_u32 s4, s4, s5
    s_and_b32 s5, s5, 0x2000
    s_add_u32 s4, s4, s5
    s_xor_b32 s4, s4, 0
    s_add_u32 s76, s4, 105381888
    s_lshl_b32 s4, s63, 11
    s_add_u32 s4, s4, s74
    buffer_store_dwordx4 v[16:19], v1, s[8:11], s4 offen sc1
    buffer_store_dwordx4 v[16:19], v1, s[8:11], s4 offen offset:1024 sc1
    v_bfe_u32 v5, v0, 2, 2
    v_and_b32 v7, 1, v0
    v_lshl_add_u32 v5, v5, 1, v7
    v_lshrrev_b32 v6, 4, v0
    v_bfe_u32 v7, v0, 1, 1
    v_lshlrev_b32 v5, 11, v5
    v_lshl_add_u32 v5, v6, 5, v5
    v_lshl_add_u32 v5, v7, 4, v5
    s_lshl_b32 s4, s68, 7
    s_lshl_b32 s5, s66, 20
    s_add_u32 s4, s4, s5
    v_add_u32 v5, s4, v5
    buffer_load_dwordx4 v[20:23], v5, s[28:31], 0 offen
    s_cmp_eq_u32 s63, 3
    s_cselect_b64 vcc, -1, 0
    s_lshl_b32 s4, s63, 14
    s_add_u32 s5, s4, s75
    s_lshl_b32 s4, s63, 15
    s_add_u32 s6, s4, s76
    s_add_u32 s7, s6, 8192
    s_mov_b32 s16, s40
    s_and_b32 s17, s41, 0xffff
    s_mov_b32 s18, 8388608
    s_mov_b32 s19, 0x20000
    s_mov_b32 s28, s42
    s_and_b32 s29, s43, 0xffff
    s_mov_b32 s30, 8388608
    s_mov_b32 s31, 0x20000
    s_lshl_b32 s82, s66, 2
    s_add_u32 s82, s82, s63
    s_lshl_b32 s82, s82, 20
    s_lshl_b32 s4, s68, 7
    s_add_u32 s82, s82, s4
    s_add_u32 m0, s80, 0
    s_add_u32 s4, s81, 0
    buffer_load_dwordx4 v8, s[16:19], s4 offen offset:0 lds
    s_add_u32 m0, s80, 1024
    s_add_u32 s4, s81, 65536
    buffer_load_dwordx4 v8, s[16:19], s4 offen offset:0 lds
    s_add_u32 m0, s80, 2048
    s_add_u32 s4, s81, 131072
    buffer_load_dwordx4 v8, s[16:19], s4 offen offset:0 lds
    s_add_u32 m0, s80, 3072
    s_add_u32 s4, s81, 196608
    buffer_load_dwordx4 v8, s[16:19], s4 offen offset:0 lds
    s_add_u32 m0, s80, 4096
    s_add_u32 s4, s81, 262144
    buffer_load_dwordx4 v8, s[16:19], s4 offen offset:0 lds
    s_add_u32 m0, s80, 5120
    s_add_u32 s4, s81, 327680
    buffer_load_dwordx4 v8, s[16:19], s4 offen offset:0 lds
    s_add_u32 m0, s80, 6144
    s_add_u32 s4, s81, 393216
    buffer_load_dwordx4 v8, s[16:19], s4 offen offset:0 lds
    s_add_u32 m0, s80, 7168
    s_add_u32 s4, s81, 458752
    buffer_load_dwordx4 v8, s[16:19], s4 offen offset:0 lds
    s_add_u32 m0, s80, 32768
    s_add_u32 s4, s81, 2097152
    buffer_load_dwordx4 v8, s[16:19], s4 offen offset:0 lds
    s_add_u32 m0, s80, 33792
    s_add_u32 s4, s81, 2162688
    buffer_load_dwordx4 v8, s[16:19], s4 offen offset:0 lds
    s_add_u32 m0, s80, 34816
    s_add_u32 s4, s81, 2228224
    buffer_load_dwordx4 v8, s[16:19], s4 offen offset:0 lds
    s_add_u32 m0, s80, 35840
    s_add_u32 s4, s81, 2293760
    buffer_load_dwordx4 v8, s[16:19], s4 offen offset:0 lds
    s_add_u32 m0, s80, 36864
    s_add_u32 s4, s81, 2359296
    buffer_load_dwordx4 v8, s[16:19], s4 offen offset:0 lds
    s_add_u32 m0, s80, 37888
    s_add_u32 s4, s81, 2424832
    buffer_load_dwordx4 v8, s[16:19], s4 offen offset:0 lds
    s_add_u32 m0, s80, 38912
    s_add_u32 s4, s81, 2490368
    buffer_load_dwordx4 v8, s[16:19], s4 offen offset:0 lds
    s_add_u32 m0, s80, 39936
    s_add_u32 s4, s81, 2555904
    buffer_load_dwordx4 v8, s[16:19], s4 offen offset:0 lds
    s_add_u32 m0, s80, 65536
    s_add_u32 s4, s81, 4194304
    buffer_load_dwordx4 v8, s[16:19], s4 offen offset:0 lds
    s_add_u32 m0, s80, 66560
    s_add_u32 s4, s81, 4259840
    buffer_load_dwordx4 v8, s[16:19], s4 offen offset:0 lds
    s_add_u32 m0, s80, 67584
    s_add_u32 s4, s81, 4325376
    buffer_load_dwordx4 v8, s[16:19], s4 offen offset:0 lds
    s_add_u32 m0, s80, 68608
    s_add_u32 s4, s81, 4390912
    buffer_load_dwordx4 v8, s[16:19], s4 offen offset:0 lds
    s_add_u32 m0, s80, 69632
    s_add_u32 s4, s81, 4456448
    buffer_load_dwordx4 v8, s[16:19], s4 offen offset:0 lds
    s_add_u32 m0, s80, 70656
    s_add_u32 s4, s81, 4521984
    buffer_load_dwordx4 v8, s[16:19], s4 offen offset:0 lds
    s_add_u32 m0, s80, 71680
    s_add_u32 s4, s81, 4587520
    buffer_load_dwordx4 v8, s[16:19], s4 offen offset:0 lds
    s_add_u32 m0, s80, 72704
    s_add_u32 s4, s81, 4653056
    buffer_load_dwordx4 v8, s[16:19], s4 offen offset:0 lds
    s_waitcnt vmcnt(24)
    v_cndmask_b32 v20, v16, v20, vcc
    v_cndmask_b32 v21, v17, v21, vcc
    v_cndmask_b32 v22, v18, v22, vcc
    v_cndmask_b32 v23, v19, v23, vcc
    buffer_store_dwordx4 v[20:23], v1, s[8:11], s5 offen sc1
    buffer_store_dwordx4 v[20:23], v1, s[8:11], s6 offen sc1
    buffer_store_dwordx4 v[16:19], v1, s[8:11], s7 offen sc1
    s_waitcnt vmcnt(16)
    s_barrier
    s_add_u32 m0, s80, 98304
    s_add_u32 s4, s81, 6291456
    buffer_load_dwordx4 v8, s[16:19], s4 offen offset:0 lds
    s_add_u32 m0, s80, 99328
    s_add_u32 s4, s81, 6356992
    buffer_load_dwordx4 v8, s[16:19], s4 offen offset:0 lds
    s_add_u32 m0, s80, 100352
    s_add_u32 s4, s81, 6422528
    buffer_load_dwordx4 v8, s[16:19], s4 offen offset:0 lds
    s_add_u32 m0, s80, 101376
    s_add_u32 s4, s81, 6488064
    buffer_load_dwordx4 v8, s[16:19], s4 offen offset:0 lds
    s_add_u32 m0, s80, 102400
    s_add_u32 s4, s81, 6553600
    buffer_load_dwordx4 v8, s[16:19], s4 offen offset:0 lds
    s_add_u32 m0, s80, 103424
    s_add_u32 s4, s81, 6619136
    buffer_load_dwordx4 v8, s[16:19], s4 offen offset:0 lds
    s_add_u32 m0, s80, 104448
    s_add_u32 s4, s81, 6684672
    buffer_load_dwordx4 v8, s[16:19], s4 offen offset:0 lds
    s_add_u32 m0, s80, 105472
    s_add_u32 s4, s81, 6750208
    buffer_load_dwordx4 v8, s[16:19], s4 offen offset:0 lds
    ds_read_b64_tr_b16 v[128:129], v24 offset:0
    ds_read_b64_tr_b16 v[130:131], v24 offset:256
    ds_read_b64_tr_b16 v[132:133], v24 offset:4096
    ds_read_b64_tr_b16 v[134:135], v24 offset:4352
    ds_read_b64_tr_b16 v[136:137], v25 offset:0
    ds_read_b64_tr_b16 v[138:139], v25 offset:256
    ds_read_b64_tr_b16 v[140:141], v25 offset:4096
    ds_read_b64_tr_b16 v[142:143], v25 offset:4352
    ds_read_b64_tr_b16 v[144:145], v26 offset:0
    ds_read_b64_tr_b16 v[146:147], v26 offset:256
    ds_read_b64_tr_b16 v[148:149], v26 offset:4096
    ds_read_b64_tr_b16 v[150:151], v26 offset:4352
    ds_read_b64_tr_b16 v[152:153], v27 offset:0
    ds_read_b64_tr_b16 v[154:155], v27 offset:256
    ds_read_b64_tr_b16 v[156:157], v27 offset:4096
    ds_read_b64_tr_b16 v[158:159], v27 offset:4352
    s_waitcnt lgkmcnt(0)
    s_waitcnt vmcnt(16)
    s_barrier
    s_add_u32 m0, s80, 0
    s_add_u32 s4, s82, 0
    buffer_load_dwordx4 v9, s[28:31], s4 offen offset:0 lds
    s_add_u32 m0, s80, 1024
    s_add_u32 s4, s82, 16384
    buffer_load_dwordx4 v9, s[28:31], s4 offen offset:0 lds
    s_add_u32 m0, s80, 2048
    s_add_u32 s4, s82, 131072
    buffer_load_dwordx4 v9, s[28:31], s4 offen offset:0 lds
    s_add_u32 m0, s80, 3072
    s_add_u32 s4, s82, 147456
    buffer_load_dwordx4 v9, s[28:31], s4 offen offset:0 lds
    s_add_u32 m0, s80, 4096
    s_add_u32 s4, s82, 32768
    buffer_load_dwordx4 v9, s[28:31], s4 offen offset:0 lds
    s_add_u32 m0, s80, 5120
    s_add_u32 s4, s82, 49152
    buffer_load_dwordx4 v9, s[28:31], s4 offen offset:0 lds
    s_add_u32 m0, s80, 6144
    s_add_u32 s4, s82, 163840
    buffer_load_dwordx4 v9, s[28:31], s4 offen offset:0 lds
    s_add_u32 m0, s80, 7168
    s_add_u32 s4, s82, 180224
    buffer_load_dwordx4 v9, s[28:31], s4 offen offset:0 lds
    ds_read_b64_tr_b16 v[160:161], v24 offset:32768
    ds_read_b64_tr_b16 v[162:163], v24 offset:33024
    ds_read_b64_tr_b16 v[164:165], v24 offset:36864
    ds_read_b64_tr_b16 v[166:167], v24 offset:37120
    ds_read_b64_tr_b16 v[168:169], v25 offset:32768
    ds_read_b64_tr_b16 v[170:171], v25 offset:33024
    ds_read_b64_tr_b16 v[172:173], v25 offset:36864
    ds_read_b64_tr_b16 v[174:175], v25 offset:37120
    ds_read_b64_tr_b16 v[176:177], v26 offset:32768
    ds_read_b64_tr_b16 v[178:179], v26 offset:33024
    ds_read_b64_tr_b16 v[180:181], v26 offset:36864
    ds_read_b64_tr_b16 v[182:183], v26 offset:37120
    ds_read_b64_tr_b16 v[184:185], v27 offset:32768
    ds_read_b64_tr_b16 v[186:187], v27 offset:33024
    ds_read_b64_tr_b16 v[188:189], v27 offset:36864
    ds_read_b64_tr_b16 v[190:191], v27 offset:37120
    s_waitcnt lgkmcnt(0)
    s_waitcnt vmcnt(16)
    s_barrier
    s_add_u32 m0, s80, 32768
    s_add_u32 s4, s82, 65536
    buffer_load_dwordx4 v9, s[28:31], s4 offen offset:0 lds
    s_add_u32 m0, s80, 33792
    s_add_u32 s4, s82, 81920
    buffer_load_dwordx4 v9, s[28:31], s4 offen offset:0 lds
    s_add_u32 m0, s80, 34816
    s_add_u32 s4, s82, 196608
    buffer_load_dwordx4 v9, s[28:31], s4 offen offset:0 lds
    s_add_u32 m0, s80, 35840
    s_add_u32 s4, s82, 212992
    buffer_load_dwordx4 v9, s[28:31], s4 offen offset:0 lds
    s_add_u32 m0, s80, 36864
    s_add_u32 s4, s82, 98304
    buffer_load_dwordx4 v9, s[28:31], s4 offen offset:0 lds
    s_add_u32 m0, s80, 37888
    s_add_u32 s4, s82, 114688
    buffer_load_dwordx4 v9, s[28:31], s4 offen offset:0 lds
    s_add_u32 m0, s80, 38912
    s_add_u32 s4, s82, 229376
    buffer_load_dwordx4 v9, s[28:31], s4 offen offset:0 lds
    s_add_u32 m0, s80, 39936
    s_add_u32 s4, s82, 245760
    buffer_load_dwordx4 v9, s[28:31], s4 offen offset:0 lds
    ds_read_b64_tr_b16 v[192:193], v28 offset:0
    ds_read_b64_tr_b16 v[194:195], v28 offset:256
    ds_read_b64_tr_b16 v[196:197], v28 offset:4096
    ds_read_b64_tr_b16 v[198:199], v28 offset:4352
    ds_read_b64_tr_b16 v[200:201], v29 offset:0
    ds_read_b64_tr_b16 v[202:203], v29 offset:256
    ds_read_b64_tr_b16 v[204:205], v29 offset:4096
    ds_read_b64_tr_b16 v[206:207], v29 offset:4352
    ds_read_b64_tr_b16 v[208:209], v30 offset:0
    ds_read_b64_tr_b16 v[210:211], v30 offset:256
    ds_read_b64_tr_b16 v[212:213], v30 offset:4096
    ds_read_b64_tr_b16 v[214:215], v30 offset:4352
    ds_read_b64_tr_b16 v[216:217], v31 offset:0
    ds_read_b64_tr_b16 v[218:219], v31 offset:256
    ds_read_b64_tr_b16 v[220:221], v31 offset:4096
    ds_read_b64_tr_b16 v[222:223], v31 offset:4352
    s_waitcnt lgkmcnt(0)
    s_waitcnt vmcnt(16)
    s_barrier
    s_add_u32 m0, s80, 65536
    s_add_u32 s4, s82, 262144
    buffer_load_dwordx4 v9, s[28:31], s4 offen offset:0 lds
    s_add_u32 m0, s80, 66560
    s_add_u32 s4, s82, 278528
    buffer_load_dwordx4 v9, s[28:31], s4 offen offset:0 lds
    s_add_u32 m0, s80, 67584
    s_add_u32 s4, s82, 393216
    buffer_load_dwordx4 v9, s[28:31], s4 offen offset:0 lds
    s_add_u32 m0, s80, 68608
    s_add_u32 s4, s82, 409600
    buffer_load_dwordx4 v9, s[28:31], s4 offen offset:0 lds
    s_add_u32 m0, s80, 69632
    s_add_u32 s4, s82, 294912
    buffer_load_dwordx4 v9, s[28:31], s4 offen offset:0 lds
    s_add_u32 m0, s80, 70656
    s_add_u32 s4, s82, 311296
    buffer_load_dwordx4 v9, s[28:31], s4 offen offset:0 lds
    s_add_u32 m0, s80, 71680
    s_add_u32 s4, s82, 425984
    buffer_load_dwordx4 v9, s[28:31], s4 offen offset:0 lds
    s_add_u32 m0, s80, 72704
    s_add_u32 s4, s82, 442368
    buffer_load_dwordx4 v9, s[28:31], s4 offen offset:0 lds
    ds_read_b64_tr_b16 v[224:225], v28 offset:32768
    ds_read_b64_tr_b16 v[226:227], v28 offset:33024
    ds_read_b64_tr_b16 v[228:229], v28 offset:36864
    ds_read_b64_tr_b16 v[230:231], v28 offset:37120
    ds_read_b64_tr_b16 v[232:233], v29 offset:32768
    ds_read_b64_tr_b16 v[234:235], v29 offset:33024
    ds_read_b64_tr_b16 v[236:237], v29 offset:36864
    ds_read_b64_tr_b16 v[238:239], v29 offset:37120
    ds_read_b64_tr_b16 v[240:241], v30 offset:32768
    ds_read_b64_tr_b16 v[242:243], v30 offset:33024
    ds_read_b64_tr_b16 v[244:245], v30 offset:36864
    ds_read_b64_tr_b16 v[246:247], v30 offset:37120
    ds_read_b64_tr_b16 v[248:249], v31 offset:32768
    ds_read_b64_tr_b16 v[250:251], v31 offset:33024
    ds_read_b64_tr_b16 v[252:253], v31 offset:36864
    ds_read_b64_tr_b16 v[254:255], v31 offset:37120
    s_waitcnt lgkmcnt(0)
    s_waitcnt vmcnt(16)
    s_barrier
    s_add_u32 m0, s80, 98304
    s_add_u32 s4, s82, 327680
    buffer_load_dwordx4 v9, s[28:31], s4 offen offset:0 lds
    s_add_u32 m0, s80, 99328
    s_add_u32 s4, s82, 344064
    buffer_load_dwordx4 v9, s[28:31], s4 offen offset:0 lds
    s_add_u32 m0, s80, 100352
    s_add_u32 s4, s82, 458752
    buffer_load_dwordx4 v9, s[28:31], s4 offen offset:0 lds
    s_add_u32 m0, s80, 101376
    s_add_u32 s4, s82, 475136
    buffer_load_dwordx4 v9, s[28:31], s4 offen offset:0 lds
    s_add_u32 m0, s80, 102400
    s_add_u32 s4, s82, 360448
    buffer_load_dwordx4 v9, s[28:31], s4 offen offset:0 lds
    s_add_u32 m0, s80, 103424
    s_add_u32 s4, s82, 376832
    buffer_load_dwordx4 v9, s[28:31], s4 offen offset:0 lds
    s_add_u32 m0, s80, 104448
    s_add_u32 s4, s82, 491520
    buffer_load_dwordx4 v9, s[28:31], s4 offen offset:0 lds
    s_add_u32 m0, s80, 105472
    s_add_u32 s4, s82, 507904
    buffer_load_dwordx4 v9, s[28:31], s4 offen offset:0 lds
    ds_read_b64_tr_b16 a[0:1], v12 offset:0
    ds_read_b64_tr_b16 a[2:3], v12 offset:256
    ds_read_b64_tr_b16 a[4:5], v12 offset:4096
    ds_read_b64_tr_b16 a[6:7], v12 offset:4352
    ds_read_b64_tr_b16 a[8:9], v12 offset:32
    ds_read_b64_tr_b16 a[10:11], v12 offset:288
    ds_read_b64_tr_b16 a[12:13], v12 offset:4128
    ds_read_b64_tr_b16 a[14:15], v12 offset:4384
    ds_read_b64_tr_b16 a[16:17], v12 offset:64
    ds_read_b64_tr_b16 a[18:19], v12 offset:320
    ds_read_b64_tr_b16 a[20:21], v12 offset:4160
    ds_read_b64_tr_b16 a[22:23], v12 offset:4416
    ds_read_b64_tr_b16 a[24:25], v12 offset:96
    ds_read_b64_tr_b16 a[26:27], v12 offset:352
    ds_read_b64_tr_b16 a[28:29], v12 offset:4192
    ds_read_b64_tr_b16 a[30:31], v12 offset:4448
    s_waitcnt lgkmcnt(0)
    s_waitcnt vmcnt(16)
    s_barrier
    s_cmp_lg_u32 s63, 0
    s_cbranch_scc1 L_arr_24
    v_mov_b32 v2, 1
    buffer_atomic_add v2, v15, s[24:27], 0 offen offset:8 sc1
L_arr_24:
    s_add_u32 m0, s80, 0
    s_add_u32 s4, s82, 524288
    buffer_load_dwordx4 v9, s[28:31], s4 offen offset:0 lds
    s_add_u32 m0, s80, 1024
    s_add_u32 s4, s82, 540672
    buffer_load_dwordx4 v9, s[28:31], s4 offen offset:0 lds
    s_add_u32 m0, s80, 2048
    s_add_u32 s4, s82, 655360
    buffer_load_dwordx4 v9, s[28:31], s4 offen offset:0 lds
    s_add_u32 m0, s80, 3072
    s_add_u32 s4, s82, 671744
    buffer_load_dwordx4 v9, s[28:31], s4 offen offset:0 lds
    s_add_u32 m0, s80, 4096
    s_add_u32 s4, s82, 557056
    buffer_load_dwordx4 v9, s[28:31], s4 offen offset:0 lds
    s_add_u32 m0, s80, 5120
    s_add_u32 s4, s82, 573440
    buffer_load_dwordx4 v9, s[28:31], s4 offen offset:0 lds
    s_add_u32 m0, s80, 6144
    s_add_u32 s4, s82, 688128
    buffer_load_dwordx4 v9, s[28:31], s4 offen offset:0 lds
    s_add_u32 m0, s80, 7168
    s_add_u32 s4, s82, 704512
    buffer_load_dwordx4 v9, s[28:31], s4 offen offset:0 lds
    ds_read_b64_tr_b16 a[32:33], v12 offset:32768
    ds_read_b64_tr_b16 a[34:35], v12 offset:33024
    ds_read_b64_tr_b16 a[36:37], v12 offset:36864
    ds_read_b64_tr_b16 a[38:39], v12 offset:37120
    ds_read_b64_tr_b16 a[40:41], v12 offset:32800
    ds_read_b64_tr_b16 a[42:43], v12 offset:33056
    ds_read_b64_tr_b16 a[44:45], v12 offset:36896
    ds_read_b64_tr_b16 a[46:47], v12 offset:37152
    ds_read_b64_tr_b16 a[48:49], v12 offset:32832
    ds_read_b64_tr_b16 a[50:51], v12 offset:33088
    ds_read_b64_tr_b16 a[52:53], v12 offset:36928
    ds_read_b64_tr_b16 a[54:55], v12 offset:37184
    ds_read_b64_tr_b16 a[56:57], v12 offset:32864
    ds_read_b64_tr_b16 a[58:59], v12 offset:33120
    ds_read_b64_tr_b16 a[60:61], v12 offset:36960
    ds_read_b64_tr_b16 a[62:63], v12 offset:37216
    s_waitcnt lgkmcnt(0)
    s_waitcnt vmcnt(16)
    s_barrier
    s_add_u32 m0, s80, 32768
    s_add_u32 s4, s82, 589824
    buffer_load_dwordx4 v9, s[28:31], s4 offen offset:0 lds
    s_add_u32 m0, s80, 33792
    s_add_u32 s4, s82, 606208
    buffer_load_dwordx4 v9, s[28:31], s4 offen offset:0 lds
    s_add_u32 m0, s80, 34816
    s_add_u32 s4, s82, 720896
    buffer_load_dwordx4 v9, s[28:31], s4 offen offset:0 lds
    s_add_u32 m0, s80, 35840
    s_add_u32 s4, s82, 737280
    buffer_load_dwordx4 v9, s[28:31], s4 offen offset:0 lds
    s_add_u32 m0, s80, 36864
    s_add_u32 s4, s82, 622592
    buffer_load_dwordx4 v9, s[28:31], s4 offen offset:0 lds
    s_add_u32 m0, s80, 37888
    s_add_u32 s4, s82, 638976
    buffer_load_dwordx4 v9, s[28:31], s4 offen offset:0 lds
    s_add_u32 m0, s80, 38912
    s_add_u32 s4, s82, 753664
    buffer_load_dwordx4 v9, s[28:31], s4 offen offset:0 lds
    s_add_u32 m0, s80, 39936
    s_add_u32 s4, s82, 770048
    buffer_load_dwordx4 v9, s[28:31], s4 offen offset:0 lds
    ds_read_b64_tr_b16 a[64:65], v13 offset:0
    ds_read_b64_tr_b16 a[66:67], v13 offset:256
    ds_read_b64_tr_b16 a[68:69], v13 offset:4096
    ds_read_b64_tr_b16 a[70:71], v13 offset:4352
    ds_read_b64_tr_b16 a[72:73], v13 offset:32
    ds_read_b64_tr_b16 a[74:75], v13 offset:288
    ds_read_b64_tr_b16 a[76:77], v13 offset:4128
    ds_read_b64_tr_b16 a[78:79], v13 offset:4384
    ds_read_b64_tr_b16 a[80:81], v13 offset:64
    ds_read_b64_tr_b16 a[82:83], v13 offset:320
    ds_read_b64_tr_b16 a[84:85], v13 offset:4160
    ds_read_b64_tr_b16 a[86:87], v13 offset:4416
    ds_read_b64_tr_b16 a[88:89], v13 offset:96
    ds_read_b64_tr_b16 a[90:91], v13 offset:352
    ds_read_b64_tr_b16 a[92:93], v13 offset:4192
    ds_read_b64_tr_b16 a[94:95], v13 offset:4448
    s_waitcnt lgkmcnt(0)
    s_waitcnt vmcnt(16)
    s_barrier
    s_add_u32 m0, s80, 65536
    s_add_u32 s4, s82, 786432
    buffer_load_dwordx4 v9, s[28:31], s4 offen offset:0 lds
    s_add_u32 m0, s80, 66560
    s_add_u32 s4, s82, 802816
    buffer_load_dwordx4 v9, s[28:31], s4 offen offset:0 lds
    s_add_u32 m0, s80, 67584
    s_add_u32 s4, s82, 917504
    buffer_load_dwordx4 v9, s[28:31], s4 offen offset:0 lds
    s_add_u32 m0, s80, 68608
    s_add_u32 s4, s82, 933888
    buffer_load_dwordx4 v9, s[28:31], s4 offen offset:0 lds
    s_add_u32 m0, s80, 69632
    s_add_u32 s4, s82, 819200
    buffer_load_dwordx4 v9, s[28:31], s4 offen offset:0 lds
    s_add_u32 m0, s80, 70656
    s_add_u32 s4, s82, 835584
    buffer_load_dwordx4 v9, s[28:31], s4 offen offset:0 lds
    s_add_u32 m0, s80, 71680
    s_add_u32 s4, s82, 950272
    buffer_load_dwordx4 v9, s[28:31], s4 offen offset:0 lds
    s_add_u32 m0, s80, 72704
    s_add_u32 s4, s82, 966656
    buffer_load_dwordx4 v9, s[28:31], s4 offen offset:0 lds
    ds_read_b64_tr_b16 a[96:97], v13 offset:32768
    ds_read_b64_tr_b16 a[98:99], v13 offset:33024
    ds_read_b64_tr_b16 a[100:101], v13 offset:36864
    ds_read_b64_tr_b16 a[102:103], v13 offset:37120
    ds_read_b64_tr_b16 a[104:105], v13 offset:32800
    ds_read_b64_tr_b16 a[106:107], v13 offset:33056
    ds_read_b64_tr_b16 a[108:109], v13 offset:36896
    ds_read_b64_tr_b16 a[110:111], v13 offset:37152
    ds_read_b64_tr_b16 a[112:113], v13 offset:32832
    ds_read_b64_tr_b16 a[114:115], v13 offset:33088
    ds_read_b64_tr_b16 a[116:117], v13 offset:36928
    ds_read_b64_tr_b16 a[118:119], v13 offset:37184
    ds_read_b64_tr_b16 a[120:121], v13 offset:32864
    ds_read_b64_tr_b16 a[122:123], v13 offset:33120
    ds_read_b64_tr_b16 a[124:125], v13 offset:36960
    ds_read_b64_tr_b16 a[126:127], v13 offset:37216
    s_waitcnt lgkmcnt(0)
    s_waitcnt vmcnt(16)
    s_barrier
    s_add_u32 m0, s80, 98304
    s_add_u32 s4, s82, 851968
    buffer_load_dwordx4 v9, s[28:31], s4 offen offset:0 lds
    s_add_u32 m0, s80, 99328
    s_add_u32 s4, s82, 868352
    buffer_load_dwordx4 v9, s[28:31], s4 offen offset:0 lds
    s_add_u32 m0, s80, 100352
    s_add_u32 s4, s82, 983040
    buffer_load_dwordx4 v9, s[28:31], s4 offen offset:0 lds
    s_add_u32 m0, s80, 101376
    s_add_u32 s4, s82, 999424
    buffer_load_dwordx4 v9, s[28:31], s4 offen offset:0 lds
    s_add_u32 m0, s80, 102400
    s_add_u32 s4, s82, 884736
    buffer_load_dwordx4 v9, s[28:31], s4 offen offset:0 lds
    s_add_u32 m0, s80, 103424
    s_add_u32 s4, s82, 901120
    buffer_load_dwordx4 v9, s[28:31], s4 offen offset:0 lds
    s_add_u32 m0, s80, 104448
    s_add_u32 s4, s82, 1015808
    buffer_load_dwordx4 v9, s[28:31], s4 offen offset:0 lds
    s_add_u32 m0, s80, 105472
    s_add_u32 s4, s82, 1032192
    buffer_load_dwordx4 v9, s[28:31], s4 offen offset:0 lds
    ds_read_b64_tr_b16 a[128:129], v12 offset:0
    ds_read_b64_tr_b16 a[130:131], v12 offset:256
    ds_read_b64_tr_b16 a[132:133], v12 offset:4096
    ds_read_b64_tr_b16 a[134:135], v12 offset:4352
    ds_read_b64_tr_b16 a[136:137], v12 offset:32
    ds_read_b64_tr_b16 a[138:139], v12 offset:288
    ds_read_b64_tr_b16 a[140:141], v12 offset:4128
    ds_read_b64_tr_b16 a[142:143], v12 offset:4384
    ds_read_b64_tr_b16 a[144:145], v12 offset:64
    ds_read_b64_tr_b16 a[146:147], v12 offset:320
    ds_read_b64_tr_b16 a[148:149], v12 offset:4160
    ds_read_b64_tr_b16 a[150:151], v12 offset:4416
    ds_read_b64_tr_b16 a[152:153], v12 offset:96
    ds_read_b64_tr_b16 a[154:155], v12 offset:352
    ds_read_b64_tr_b16 a[156:157], v12 offset:4192
    ds_read_b64_tr_b16 a[158:159], v12 offset:4448
    s_waitcnt lgkmcnt(0)
    s_waitcnt vmcnt(16)
    s_barrier
    s_add_u32 m0, s80, 0
    s_add_u32 s4, s81, 128
    buffer_load_dwordx4 v8, s[16:19], s4 offen offset:0 lds
    s_add_u32 m0, s80, 1024
    s_add_u32 s4, s81, 65664
    buffer_load_dwordx4 v8, s[16:19], s4 offen offset:0 lds
    s_add_u32 m0, s80, 2048
    s_add_u32 s4, s81, 131200
    buffer_load_dwordx4 v8, s[16:19], s4 offen offset:0 lds
    s_add_u32 m0, s80, 3072
    s_add_u32 s4, s81, 196736
    buffer_load_dwordx4 v8, s[16:19], s4 offen offset:0 lds
    s_add_u32 m0, s80, 4096
    s_add_u32 s4, s81, 262272
    buffer_load_dwordx4 v8, s[16:19], s4 offen offset:0 lds
    s_add_u32 m0, s80, 5120
    s_add_u32 s4, s81, 327808
    buffer_load_dwordx4 v8, s[16:19], s4 offen offset:0 lds
    s_add_u32 m0, s80, 6144
    s_add_u32 s4, s81, 393344
    buffer_load_dwordx4 v8, s[16:19], s4 offen offset:0 lds
    s_add_u32 m0, s80, 7168
    s_add_u32 s4, s81, 458880
    buffer_load_dwordx4 v8, s[16:19], s4 offen offset:0 lds
    ds_read_b64_tr_b16 a[160:161], v12 offset:32768
    ds_read_b64_tr_b16 a[162:163], v12 offset:33024
    ds_read_b64_tr_b16 a[164:165], v12 offset:36864
    ds_read_b64_tr_b16 a[166:167], v12 offset:37120
    ds_read_b64_tr_b16 a[168:169], v12 offset:32800
    ds_read_b64_tr_b16 a[170:171], v12 offset:33056
    ds_read_b64_tr_b16 a[172:173], v12 offset:36896
    ds_read_b64_tr_b16 a[174:175], v12 offset:37152
    ds_read_b64_tr_b16 a[176:177], v12 offset:32832
    ds_read_b64_tr_b16 a[178:179], v12 offset:33088
    ds_read_b64_tr_b16 a[180:181], v12 offset:36928
    ds_read_b64_tr_b16 a[182:183], v12 offset:37184
    ds_read_b64_tr_b16 a[184:185], v12 offset:32864
    ds_read_b64_tr_b16 a[186:187], v12 offset:33120
    ds_read_b64_tr_b16 a[188:189], v12 offset:36960
    ds_read_b64_tr_b16 a[190:191], v12 offset:37216
    s_waitcnt lgkmcnt(0)
    s_waitcnt vmcnt(16)
    s_barrier
    s_add_u32 m0, s80, 32768
    s_add_u32 s4, s81, 2097280
    buffer_load_dwordx4 v8, s[16:19], s4 offen offset:0 lds
    s_add_u32 m0, s80, 33792
    s_add_u32 s4, s81, 2162816
    buffer_load_dwordx4 v8, s[16:19], s4 offen offset:0 lds
    s_add_u32 m0, s80, 34816
    s_add_u32 s4, s81, 2228352
    buffer_load_dwordx4 v8, s[16:19], s4 offen offset:0 lds
    s_add_u32 m0, s80, 35840
    s_add_u32 s4, s81, 2293888
    buffer_load_dwordx4 v8, s[16:19], s4 offen offset:0 lds
    s_add_u32 m0, s80, 36864
    s_add_u32 s4, s81, 2359424
    buffer_load_dwordx4 v8, s[16:19], s4 offen offset:0 lds
    s_add_u32 m0, s80, 37888
    s_add_u32 s4, s81, 2424960
    buffer_load_dwordx4 v8, s[16:19], s4 offen offset:0 lds
    s_add_u32 m0, s80, 38912
    s_add_u32 s4, s81, 2490496
    buffer_load_dwordx4 v8, s[16:19], s4 offen offset:0 lds
    s_add_u32 m0, s80, 39936
    s_add_u32 s4, s81, 2556032
    buffer_load_dwordx4 v8, s[16:19], s4 offen offset:0 lds
    ds_read_b64_tr_b16 a[192:193], v13 offset:0
    ds_read_b64_tr_b16 a[194:195], v13 offset:256
    ds_read_b64_tr_b16 a[196:197], v13 offset:4096
    ds_read_b64_tr_b16 a[198:199], v13 offset:4352
    ds_read_b64_tr_b16 a[200:201], v13 offset:32
    ds_read_b64_tr_b16 a[202:203], v13 offset:288
    ds_read_b64_tr_b16 a[204:205], v13 offset:4128
    ds_read_b64_tr_b16 a[206:207], v13 offset:4384
    ds_read_b64_tr_b16 a[208:209], v13 offset:64
    ds_read_b64_tr_b16 a[210:211], v13 offset:320
    ds_read_b64_tr_b16 a[212:213], v13 offset:4160
    ds_read_b64_tr_b16 a[214:215], v13 offset:4416
    ds_read_b64_tr_b16 a[216:217], v13 offset:96
    ds_read_b64_tr_b16 a[218:219], v13 offset:352
    ds_read_b64_tr_b16 a[220:221], v13 offset:4192
    ds_read_b64_tr_b16 a[222:223], v13 offset:4448
    s_waitcnt lgkmcnt(0)
    s_waitcnt vmcnt(16)
    s_barrier
    s_add_u32 m0, s80, 65536
    s_add_u32 s4, s81, 4194432
    buffer_load_dwordx4 v8, s[16:19], s4 offen offset:0 lds
    s_add_u32 m0, s80, 66560
    s_add_u32 s4, s81, 4259968
    buffer_load_dwordx4 v8, s[16:19], s4 offen offset:0 lds
    s_add_u32 m0, s80, 67584
    s_add_u32 s4, s81, 4325504
    buffer_load_dwordx4 v8, s[16:19], s4 offen offset:0 lds
    s_add_u32 m0, s80, 68608
    s_add_u32 s4, s81, 4391040
    buffer_load_dwordx4 v8, s[16:19], s4 offen offset:0 lds
    s_add_u32 m0, s80, 69632
    s_add_u32 s4, s81, 4456576
    buffer_load_dwordx4 v8, s[16:19], s4 offen offset:0 lds
    s_add_u32 m0, s80, 70656
    s_add_u32 s4, s81, 4522112
    buffer_load_dwordx4 v8, s[16:19], s4 offen offset:0 lds
    s_add_u32 m0, s80, 71680
    s_add_u32 s4, s81, 4587648
    buffer_load_dwordx4 v8, s[16:19], s4 offen offset:0 lds
    s_add_u32 m0, s80, 72704
    s_add_u32 s4, s81, 4653184
    buffer_load_dwordx4 v8, s[16:19], s4 offen offset:0 lds
    ds_read_b64_tr_b16 a[224:225], v13 offset:32768
    ds_read_b64_tr_b16 a[226:227], v13 offset:33024
    ds_read_b64_tr_b16 a[228:229], v13 offset:36864
    ds_read_b64_tr_b16 a[230:231], v13 offset:37120
    ds_read_b64_tr_b16 a[232:233], v13 offset:32800
    ds_read_b64_tr_b16 a[234:235], v13 offset:33056
    ds_read_b64_tr_b16 a[236:237], v13 offset:36896
    ds_read_b64_tr_b16 a[238:239], v13 offset:37152
    ds_read_b64_tr_b16 a[240:241], v13 offset:32832
    ds_read_b64_tr_b16 a[242:243], v13 offset:33088
    ds_read_b64_tr_b16 a[244:245], v13 offset:36928
    ds_read_b64_tr_b16 a[246:247], v13 offset:37184
    ds_read_b64_tr_b16 a[248:249], v13 offset:32864
    ds_read_b64_tr_b16 a[250:251], v13 offset:33120
    ds_read_b64_tr_b16 a[252:253], v13 offset:36960
    ds_read_b64_tr_b16 a[254:255], v13 offset:37216
    s_waitcnt lgkmcnt(0)
    s_waitcnt vmcnt(16)
    s_barrier
    s_add_u32 m0, s80, 98304
    s_add_u32 s4, s81, 6291584
    buffer_load_dwordx4 v8, s[16:19], s4 offen offset:0 lds
    s_add_u32 m0, s80, 99328
    s_add_u32 s4, s81, 6357120
    buffer_load_dwordx4 v8, s[16:19], s4 offen offset:0 lds
    s_add_u32 m0, s80, 100352
    s_add_u32 s4, s81, 6422656
    buffer_load_dwordx4 v8, s[16:19], s4 offen offset:0 lds
    s_add_u32 m0, s80, 101376
    s_add_u32 s4, s81, 6488192
    buffer_load_dwordx4 v8, s[16:19], s4 offen offset:0 lds
    s_add_u32 m0, s80, 102400
    s_add_u32 s4, s81, 6553728
    buffer_load_dwordx4 v8, s[16:19], s4 offen offset:0 lds
    s_add_u32 m0, s80, 103424
    s_add_u32 s4, s81, 6619264
    buffer_load_dwordx4 v8, s[16:19], s4 offen offset:0 lds
    s_add_u32 m0, s80, 104448
    s_add_u32 s4, s81, 6684800
    buffer_load_dwordx4 v8, s[16:19], s4 offen offset:0 lds
    s_add_u32 m0, s80, 105472
    s_add_u32 s4, s81, 6750336
    buffer_load_dwordx4 v8, s[16:19], s4 offen offset:0 lds
    ds_read_b64_tr_b16 v[64:65], v24 offset:0
    ds_read_b64_tr_b16 v[66:67], v24 offset:256
    ds_read_b64_tr_b16 v[68:69], v24 offset:4096
    ds_read_b64_tr_b16 v[70:71], v24 offset:4352
    ds_read_b64_tr_b16 v[72:73], v25 offset:0
    ds_read_b64_tr_b16 v[74:75], v25 offset:256
    ds_read_b64_tr_b16 v[76:77], v25 offset:4096
    ds_read_b64_tr_b16 v[78:79], v25 offset:4352
    ds_read_b64_tr_b16 v[80:81], v26 offset:0
    ds_read_b64_tr_b16 v[82:83], v26 offset:256
    ds_read_b64_tr_b16 v[84:85], v26 offset:4096
    ds_read_b64_tr_b16 v[86:87], v26 offset:4352
    ds_read_b64_tr_b16 v[88:89], v27 offset:0
    ds_read_b64_tr_b16 v[90:91], v27 offset:256
    ds_read_b64_tr_b16 v[92:93], v27 offset:4096
    ds_read_b64_tr_b16 v[94:95], v27 offset:4352
    s_waitcnt lgkmcnt(0)
    s_barrier
    v_add_u32 v5, 0, v3
    ds_write_b128 v5, v[64:67] offset:0
    ds_write_b128 v5, v[68:71] offset:1024
    ds_write_b128 v5, v[72:75] offset:2048
    ds_write_b128 v5, v[76:79] offset:3072
    ds_write_b128 v5, v[80:83] offset:4096
    ds_write_b128 v5, v[84:87] offset:5120
    ds_write_b128 v5, v[88:91] offset:6144
    ds_write_b128 v5, v[92:95] offset:7168
    s_waitcnt lgkmcnt(0)
    s_waitcnt vmcnt(16)
    s_barrier
    ds_read_b64_tr_b16 v[64:65], v24 offset:32768
    ds_read_b64_tr_b16 v[66:67], v24 offset:33024
    ds_read_b64_tr_b16 v[68:69], v24 offset:36864
    ds_read_b64_tr_b16 v[70:71], v24 offset:37120
    ds_read_b64_tr_b16 v[72:73], v25 offset:32768
    ds_read_b64_tr_b16 v[74:75], v25 offset:33024
    ds_read_b64_tr_b16 v[76:77], v25 offset:36864
    ds_read_b64_tr_b16 v[78:79], v25 offset:37120
    ds_read_b64_tr_b16 v[80:81], v26 offset:32768
    ds_read_b64_tr_b16 v[82:83], v26 offset:33024
    ds_read_b64_tr_b16 v[84:85], v26 offset:36864
    ds_read_b64_tr_b16 v[86:87], v26 offset:37120
    ds_read_b64_tr_b16 v[88:89], v27 offset:32768
    ds_read_b64_tr_b16 v[90:91], v27 offset:33024
    ds_read_b64_tr_b16 v[92:93], v27 offset:36864
    ds_read_b64_tr_b16 v[94:95], v27 offset:37120
    s_waitcnt lgkmcnt(0)
    s_barrier
    v_add_u32 v5, 32768, v3
    ds_write_b128 v5, v[64:67] offset:0
    ds_write_b128 v5, v[68:71] offset:1024
    ds_write_b128 v5, v[72:75] offset:2048
    ds_write_b128 v5, v[76:79] offset:3072
    ds_write_b128 v5, v[80:83] offset:4096
    ds_write_b128 v5, v[84:87] offset:5120
    ds_write_b128 v5, v[88:91] offset:6144
    ds_write_b128 v5, v[92:95] offset:7168
    s_waitcnt lgkmcnt(0)
    s_waitcnt vmcnt(8)
    s_barrier
    ds_read_b64_tr_b16 v[64:65], v28 offset:0
    ds_read_b64_tr_b16 v[66:67], v28 offset:256
    ds_read_b64_tr_b16 v[68:69], v28 offset:4096
    ds_read_b64_tr_b16 v[70:71], v28 offset:4352
    ds_read_b64_tr_b16 v[72:73], v29 offset:0
    ds_read_b64_tr_b16 v[74:75], v29 offset:256
    ds_read_b64_tr_b16 v[76:77], v29 offset:4096
    ds_read_b64_tr_b16 v[78:79], v29 offset:4352
    ds_read_b64_tr_b16 v[80:81], v30 offset:0
    ds_read_b64_tr_b16 v[82:83], v30 offset:256
    ds_read_b64_tr_b16 v[84:85], v30 offset:4096
    ds_read_b64_tr_b16 v[86:87], v30 offset:4352
    ds_read_b64_tr_b16 v[88:89], v31 offset:0
    ds_read_b64_tr_b16 v[90:91], v31 offset:256
    ds_read_b64_tr_b16 v[92:93], v31 offset:4096
    ds_read_b64_tr_b16 v[94:95], v31 offset:4352
    s_waitcnt lgkmcnt(0)
    s_barrier
    v_add_u32 v5, 65536, v3
    ds_write_b128 v5, v[64:67] offset:0
    ds_write_b128 v5, v[68:71] offset:1024
    ds_write_b128 v5, v[72:75] offset:2048
    ds_write_b128 v5, v[76:79] offset:3072
    ds_write_b128 v5, v[80:83] offset:4096
    ds_write_b128 v5, v[84:87] offset:5120
    ds_write_b128 v5, v[88:91] offset:6144
    ds_write_b128 v5, v[92:95] offset:7168
    s_waitcnt lgkmcnt(0)
    s_waitcnt vmcnt(0)
    s_barrier
    ds_read_b64_tr_b16 v[64:65], v28 offset:32768
    ds_read_b64_tr_b16 v[66:67], v28 offset:33024
    ds_read_b64_tr_b16 v[68:69], v28 offset:36864
    ds_read_b64_tr_b16 v[70:71], v28 offset:37120
    ds_read_b64_tr_b16 v[72:73], v29 offset:32768
    ds_read_b64_tr_b16 v[74:75], v29 offset:33024
    ds_read_b64_tr_b16 v[76:77], v29 offset:36864
    ds_read_b64_tr_b16 v[78:79], v29 offset:37120
    ds_read_b64_tr_b16 v[80:81], v30 offset:32768
    ds_read_b64_tr_b16 v[82:83], v30 offset:33024
    ds_read_b64_tr_b16 v[84:85], v30 offset:36864
    ds_read_b64_tr_b16 v[86:87], v30 offset:37120
    ds_read_b64_tr_b16 v[88:89], v31 offset:32768
    ds_read_b64_tr_b16 v[90:91], v31 offset:33024
    ds_read_b64_tr_b16 v[92:93], v31 offset:36864
    ds_read_b64_tr_b16 v[94:95], v31 offset:37120
    s_waitcnt lgkmcnt(0)
    s_barrier
    v_add_u32 v5, 98304, v3
    ds_write_b128 v5, v[64:67] offset:0
    ds_write_b128 v5, v[68:71] offset:1024
    ds_write_b128 v5, v[72:75] offset:2048
    ds_write_b128 v5, v[76:79] offset:3072
    ds_write_b128 v5, v[80:83] offset:4096
    ds_write_b128 v5, v[84:87] offset:5120
    ds_write_b128 v5, v[88:91] offset:6144
    ds_write_b128 v5, v[92:95] offset:7168
    s_waitcnt lgkmcnt(0)
    v_mov_b32 v2, 0x4444
    v_mov_b32 v5, 0xeeee
    v_and_b32 v6, 2, v0
    v_cmp_eq_u32 vcc, 2, v6
    s_nop 1
    v_cndmask_b32 v2, v2, v5, vcc
    v_and_b32 v6, 1, v0
    v_lshlrev_b32 v6, 4, v6
    v_mov_b32 v5, 0x3f80
    v_lshlrev_b32 v5, v6, v5
    v_mov_b32 v6, 0
    v_cndmask_b32 v20, v5, v6, vcc
    v_cndmask_b32 v21, v6, v5, vcc
    s_lshl_b32 s4, s63, 12
    s_add_u32 s4, s4, 131072
    v_add_u32 v5, s4, v1
    s_mov_b32 s70, 0
    v_and_b32 v14, 15, v0
    v_lshrrev_b32 v6, 4, v0
    s_lshl_b32 s4, s63, 7
    s_add_u32 s4, s4, s84
    s_add_u32 s4, s4, 512
    v_lshl_add_u32 v22, v14, 2, s4
    s_lshl_b32 s4, s63, 9
    v_lshl_add_u32 v7, v0, 3, s4
    v_mul_u32_u24 v8, 40, v14
    v_lshl_add_u32 v8, v6, 3, v8
    s_mul_i32 s4, s63, 2560
    s_add_u32 s4, s4, 147456
    v_add_u32 v8, s4, v8
    v_bfe_u32 v9, v0, 2, 1
    v_lshl_add_u32 v6, v6, 1, v9
    v_bfe_u32 v9, v0, 3, 1
    v_and_b32 v14, 3, v0
    v_lshl_add_u32 v9, v9, 2, v14
    v_mul_u32_u24 v9, 80, v9
    v_lshl_add_u32 v9, v6, 2, v9
    s_mul_i32 s4, s63, 640
    s_add_u32 s4, s4, 147456
    v_add_u32 v9, s4, v9
    v_add_u32 v10, 2560, v9
    v_add_u32 v11, 5120, v9
    v_add_u32 v12, 7680, v9
    s_lshl_b32 s4, s63, 8
    v_lshl_add_u32 v13, v0, 2, s4
    v_mov_b32 v6, 268435456
    v_cmp_eq_u32 vcc, 0, v14
    s_nop 1
    v_cndmask_b32 v13, v6, v13, vcc
    s_lshl_b32 s4, s63, 10
    s_add_u32 s73, s73, s4
    s_lshr_b32 s4, s68, 2
    s_cmp_eq_u32 s4, s63
    s_cselect_b64 s[32:33], 1, 0
    s_and_b32 s6, s68, 3
    s_lshr_b32 s5, s6, 1
    s_and_b32 s4, s6, 1
    s_lshl3_add_u32 s4, s4, s5
    s_lshl_b32 s4, s4, 7
    s_and_b32 s5, s68, 12
    s_add_u32 s4, s4, s5
    s_add_u32 s84, s84, s4
    s_lshl_b32 s4, s63, 4
    s_add_u32 s84, s84, s4
    s_lshl_b32 s4, s62, 2
    s_add_u32 s4, s4, s63
    v_lshlrev_b32 v40, 7, v0
    s_lshl_b32 s5, s4, 10
    s_add_u32 s6, s5, 105644032
    s_add_u32 s5, s5, 105906176
    s_lshl_b32 s4, s4, 9
    s_add_u32 s4, s4, 105119744
    s_mov_b64 exec, 0xff
    buffer_load_dword v41, v40, s[8:11], s5 offen sc1
    buffer_load_dword v41, v40, s[8:11], s6 offen sc1
    s_mov_b64 exec, 0xf
    buffer_load_dword v41, v40, s[8:11], s4 offen sc1
    s_mov_b64 exec, -1
    s_cmp_lg_u32 s63, 0
    s_cbranch_scc1 L_walld_26
L_wall_25:
    buffer_load_dword v40, v15, s[24:27], 0 offen offset:8 sc1
    s_waitcnt vmcnt(0)
    v_readfirstlane_b32 s4, v40
    s_nop 0
    s_cmp_ge_u32 s4, 256
    s_cbranch_scc1 L_walld_26
    s_sleep 4
    s_sub_u32 s65, s65, 1
    s_cmp_gt_i32 s65, 0
    s_cbranch_scc1 L_wall_25
L_walld_26:
    s_barrier
    buffer_load_dwordx2 v[40:41], v15, s[24:27], 0 offen offset:132 sc1
    s_waitcnt vmcnt(0)
    v_readfirstlane_b32 s64, v41
    s_mov_b32 s5, 0
    s_lshr_b32 s6, s63, 1
    s_and_b32 s4, s63, 1
    s_lshl3_add_u32 s4, s4, s6
    s_lshl_b32 s4, s4, 7
    s_add_u32 s72, s72, s5
    s_mov_b32 s99, 0x2400
    s_lshl_b32 s6, s66, 18
    s_add_u32 s6, s6, s5
    s_and_b32 s7, s68, 15
    s_lshl_b32 s7, s7, 14
    s_lshl2_add_u32 s3, s68, s7
    s_and_b32 s7, s68, 1
    s_mul_i32 s7, s7, 17408
    s_sub_u32 s3, s3, s7
    s_add_u32 s6, s6, 1024
    s_add_u32 s3, s3, s6
    s_add_u32 s3, s3, 106430464
    s_xor_b32 s6, s6, 0x40000
    s_add_u32 s6, s6, 106430464
    s_lshl_b32 s7, s66, 12
    s_add_u32 s4, s4, s7
    s_add_u32 s4, s4, 104925184
    v_and_b32 v42, 15, v0
    v_lshl_add_u32 v40, v42, 2, s4
    v_and_b32 v42, 12, v42
    v_or_b32 v42, s63, v42
    v_lshl_add_u32 v41, v42, 2, s6
    v_and_b32 v42, 15, v42
    v_lshl_add_u32 v41, v42, 14, v41
    s_and_b32 s7, s63, 1
    s_mul_i32 s7, s7, 17408
    v_subrev_u32 v41, s7, v41
    v_cmp_gt_u32 vcc, 16, v0
    s_nop 1
    v_cndmask_b32 v23, v40, v41, vcc
    s_add_u32 s76, s76, s5
    s_mov_b32 s77, 0
    s_add_u32 s5, s70, 1
    s_min_u32 s5, s5, 63
    s_cmp_gt_u32 s77, s5
    s_cbranch_scc1 L_ndd_28
    v_lshrrev_b32 v40, 6, v1
    v_min_u32 v40, 2, v40
    v_lshlrev_b32 v40, 12, v40
    v_bfe_u32 v41, v1, 2, 4
    v_add_u32 v40, v40, v41
    s_lshl_b32 s4, s69, 7
    s_add_u32 s4, s4, 104931328
L_nd_27:
    buffer_load_dword v41, v40, s[8:11], s4 offen sc1
    s_waitcnt vmcnt(0)
    v_min_u32_dpp v41, v41, v41 quad_perm:[1,0,3,2] row_mask:0xf bank_mask:0xf
    s_nop 1
    v_min_u32_dpp v41, v41, v41 quad_perm:[2,3,0,1] row_mask:0xf bank_mask:0xf
    s_nop 1
    v_min_u32_dpp v41, v41, v41 row_ror:4 row_mask:0xf bank_mask:0xf
    s_nop 1
    v_min_u32_dpp v41, v41, v41 row_ror:8 row_mask:0xf bank_mask:0xf
    s_nop 0
    v_readfirstlane_b32 s77, v41
    s_nop 0
    s_cmp_gt_u32 s77, s5
    s_cbranch_scc1 L_ndd_28
    s_sub_u32 s65, s65, 1
    s_cmp_gt_i32 s65, 0
    s_cbranch_scc1 L_nd_27
L_ndd_28:
    s_lshl_b32 s82, s69, 13
    s_lshl_b32 s4, s63, 11
    s_add_u32 s82, s82, s4
    s_add_u32 s82, s82, 17039360
    v_and_b32 v40, 15, v0
    v_lshlrev_b32 v40, 7, v40
    v_lshrrev_b32 v41, 4, v0
    v_lshl_add_u32 v40, v41, 24, v40
    v_mov_b32 v14, v40
    s_cmp_lg_u32 s64, 0
    s_cbranch_scc1 L_vo_loop1
L_vo_loop0:
    s_add_u32 s4, s70, 0
    s_and_b32 s4, s4, 3
    s_lshl_b32 s4, s4, 15
    s_add_u32 s86, s76, s4
    s_xor_b32 s5, s86, 0x10000
    s_add_u32 s4, s70, 3
    s_and_b32 s4, s4, 3
    s_lshl_b32 s4, s4, 14
    s_add_u32 s87, s71, s4
    v_mov_b32 v0, 0
    s_mov_b32 exec_hi, 0
    s_lshl_b32 s83, s70, 1
L_fp_29:
    s_sub_u32 s65, s65, 1
    s_cmp_gt_i32 s65, 0
    s_cselect_b32 s83, s83, 0
    s_nop 0
    buffer_load_dword v0, v23, s[8:11], 0 offen sc1
    s_waitcnt vmcnt(1)
L_fp_29c:
    v_cmpx_gt_u32 vcc, s83, v0
    s_cbranch_execnz L_fp_29
    s_mov_b64 exec, -1
    buffer_load_dwordx4 v[60:63], v1, s[8:11], s87 offen sc1
    s_add_u32 s88, s87, 4096
    s_add_u32 s89, s87, 8192
    s_add_u32 s90, s87, 12288
    s_add_u32 s4, s70, 3
    s_and_b32 s4, s4, 3
    s_lshl_b32 s4, s4, 15
    s_add_u32 s91, s72, s4
    s_add_u32 s92, s91, 4096
    s_add_u32 s93, s91, 16384
    s_add_u32 s94, s91, 20480
    buffer_load_dwordx4 v[68:71], v1, s[8:11], s88 offen sc1
    ds_read_b128 v[104:107], v3 offset:0
    ds_read_b128 v[108:111], v3 offset:1024
    ds_read_b128 v[112:115], v3 offset:32768
    ds_read_b128 v[116:119], v3 offset:33792
    ds_read_b128 v[120:123], v4 offset:0
    ds_read_b128 v[124:127], v4 offset:1024
    ds_read_b128 v[24:27], v4 offset:32768
    ds_read_b128 v[28:31], v4 offset:33792
    ds_read_b128 v[32:35], v3 offset:2048
    buffer_load_dwordx4 v[76:79], v1, s[8:11], s89 offen sc1
    ds_read_b128 v[36:39], v3 offset:3072
    v_mov_b32 v40, 0
    v_mov_b32 v41, 0
    v_mov_b32 v42, 0
    v_mov_b32 v43, 0
    v_mov_b32 v44, 0
    v_mov_b32 v45, 0
    v_mov_b32 v46, 0
    v_mov_b32 v47, 0
    buffer_load_dwordx4 v[84:87], v1, s[8:11], s90 offen sc1
    s_waitcnt vmcnt(3)
    buffer_load_dwordx4 v[88:91], v1, s[8:11], s91 offen sc1
    v_mov_b32 v6, v60
    v_mfma_f32_4x4x4_16b_bf16 v[56:59], v[20:21], v[60:61], 0
    v_mfma_f32_4x4x4_16b_bf16 v[60:63], v[20:21], v[62:63], 0
    s_waitcnt vmcnt(3)
    buffer_load_dwordx4 v[92:95], v1, s[8:11], s92 offen sc1
    v_max_u32 v6, v6, v68
    v_mfma_f32_4x4x4_16b_bf16 v[64:67], v[20:21], v[68:69], 0
    v_mfma_f32_4x4x4_16b_bf16 v[68:71], v[20:21], v[70:71], 0
    s_waitcnt vmcnt(3)
    buffer_load_dwordx4 v[96:99], v1, s[8:11], s93 offen sc1
    v_max_u32 v6, v6, v76
    v_mfma_f32_4x4x4_16b_bf16 v[72:75], v[20:21], v[76:77], 0
    v_mfma_f32_4x4x4_16b_bf16 v[76:79], v[20:21], v[78:79], 0
    s_waitcnt vmcnt(3)
    buffer_load_dwordx4 v[100:103], v1, s[8:11], s94 offen sc1
    v_max_u32 v6, v6, v84
    v_mfma_f32_4x4x4_16b_bf16 v[80:83], v[20:21], v[84:85], 0
    v_mfma_f32_4x4x4_16b_bf16 v[84:87], v[20:21], v[86:87], 0
L_rl_30:
    s_waitcnt vmcnt(2)
    v_mfma_f32_4x4x4_16b_bf16 v[56:59], v[20:21], v[88:89], v[56:59]
    v_max3_u32 v6, v6, v88, v92
    v_mfma_f32_4x4x4_16b_bf16 v[60:63], v[20:21], v[90:91], v[60:63]
    v_mfma_f32_4x4x4_16b_bf16 v[64:67], v[20:21], v[92:93], v[64:67]
    v_mfma_f32_4x4x4_16b_bf16 v[68:71], v[20:21], v[94:95], v[68:71]
    v_cvt_pk_bf16_f32 v88, v56, v57
    v_cvt_pk_bf16_f32 v89, v58, v59
    v_cvt_pk_bf16_f32 v90, v60, v61
    v_cvt_pk_bf16_f32 v91, v62, v63
    ds_write_b128 v5, v[88:91] offset:0
    s_nop 0
    v_smfmac_f32_16x16x64_bf16 v[40:43], v[88:91], v[128:135], v2
    ds_read_b128 v[48:51], v3 offset:34816
    ds_read_b128 v[52:55], v3 offset:35840
    s_waitcnt lgkmcnt(11)
    v_cvt_pk_bf16_f32 v92, v64, v65
    v_cvt_pk_bf16_f32 v93, v66, v67
    v_smfmac_f32_16x16x64_bf16 v[44:47], v[88:91], v[104:111], v2
    v_cvt_pk_bf16_f32 v94, v68, v69
    v_cvt_pk_bf16_f32 v95, v70, v71
    ds_write_b128 v5, v[92:95] offset:1024
    s_waitcnt vmcnt(0)
    v_mfma_f32_4x4x4_16b_bf16 v[72:75], v[20:21], v[96:97], v[72:75]
    v_max3_u32 v6, v6, v96, v100
    v_mfma_f32_4x4x4_16b_bf16 v[76:79], v[20:21], v[98:99], v[76:79]
    v_mfma_f32_4x4x4_16b_bf16 v[80:83], v[20:21], v[100:101], v[80:83]
    v_mfma_f32_4x4x4_16b_bf16 v[84:87], v[20:21], v[102:103], v[84:87]
    v_cvt_pk_bf16_f32 v96, v72, v73
    v_cvt_pk_bf16_f32 v97, v74, v75
    v_cvt_pk_bf16_f32 v98, v76, v77
    v_cvt_pk_bf16_f32 v99, v78, v79
    ds_write_b128 v5, v[96:99] offset:2048
    v_smfmac_f32_16x16x64_bf16 v[40:43], v[92:95], v[160:167], v2
    ds_read_b128 v[104:107], v4 offset:2048
    ds_read_b128 v[108:111], v4 offset:3072
    s_waitcnt lgkmcnt(13)
    v_cvt_pk_bf16_f32 v100, v80, v81
    v_cvt_pk_bf16_f32 v101, v82, v83
    v_smfmac_f32_16x16x64_bf16 v[44:47], v[92:95], v[112:119], v2
    v_cvt_pk_bf16_f32 v102, v84, v85
    v_cvt_pk_bf16_f32 v103, v86, v87
    ds_write_b128 v5, v[100:103] offset:3072
    v_smfmac_f32_16x16x64_bf16 v[40:43], v[96:99], v[192:199], v2
    ds_read_b128 v[112:115], v4 offset:34816
    ds_read_b128 v[116:119], v4 offset:35840
    s_waitcnt lgkmcnt(14)
    v_cmp_eq_u32 vcc, -1, v6
    v_smfmac_f32_16x16x64_bf16 v[44:47], v[96:99], v[120:127], v2
    v_xor_b32 v5, 4096, v5
    s_cbranch_vccnz L_fix_31
    s_waitcnt lgkmcnt(2)
    s_barrier
    ds_read_b128 v[56:59], v5 offset:0
    v_smfmac_f32_16x16x64_bf16 v[40:43], v[100:103], v[224:231], v2
    ds_read_b128 v[60:63], v5 offset:1024
    ds_read_b128 v[64:67], v5 offset:2048
    v_smfmac_f32_16x16x64_bf16 v[44:47], v[100:103], v[24:31], v2
    ds_read_b128 v[120:123], v3 offset:6144
    ds_read_b128 v[124:127], v3 offset:7168
    s_waitcnt lgkmcnt(4)
    v_smfmac_f32_16x16x64_bf16 v[40:43], v[56:59], v[136:143], v2
    ds_read_b128 v[68:71], v5 offset:3072
    ds_read_b128 v[24:27], v3 offset:38912
    v_smfmac_f32_16x16x64_bf16 v[44:47], v[56:59], v[32:39], v2
    ds_read_b128 v[28:31], v3 offset:39936
    s_waitcnt lgkmcnt(6)
    v_xor_b32 v5, 8192, v5
    v_smfmac_f32_16x16x64_bf16 v[40:43], v[60:63], v[168:175], v2
    ds_read_b128 v[56:59], v5 offset:0
    ds_read_b128 v[32:35], v4 offset:6144
    v_smfmac_f32_16x16x64_bf16 v[44:47], v[60:63], v[48:55], v2
    ds_read_b128 v[36:39], v4 offset:7168
    s_waitcnt lgkmcnt(8)
    v_smfmac_f32_16x16x64_bf16 v[40:43], v[64:67], v[200:207], v2
    ds_read_b128 v[60:63], v5 offset:1024
    ds_read_b128 v[48:51], v4 offset:38912
    v_smfmac_f32_16x16x64_bf16 v[44:47], v[64:67], v[104:111], v2
    ds_read_b128 v[52:55], v4 offset:39936
    s_waitcnt lgkmcnt(8)
    v_smfmac_f32_16x16x64_bf16 v[40:43], v[68:71], v[232:239], v2
    ds_read_b128 v[64:67], v5 offset:2048
    ds_read_b128 v[104:107], v3 offset:4096
    v_smfmac_f32_16x16x64_bf16 v[44:47], v[68:71], v[112:119], v2
    ds_read_b128 v[108:111], v3 offset:5120
    s_waitcnt lgkmcnt(8)
    v_smfmac_f32_16x16x64_bf16 v[40:43], v[56:59], v[152:159], v2
    ds_read_b128 v[68:71], v5 offset:3072
    ds_read_b128 v[112:115], v3 offset:36864
    v_smfmac_f32_16x16x64_bf16 v[44:47], v[56:59], v[120:127], v2
    ds_read_b128 v[116:119], v3 offset:37888
    s_waitcnt lgkmcnt(8)
    v_xor_b32 v5, 4096, v5
    v_smfmac_f32_16x16x64_bf16 v[40:43], v[60:63], v[184:191], v2
    ds_read_b128 v[56:59], v5 offset:0
    ds_read_b128 v[120:123], v4 offset:4096
    v_smfmac_f32_16x16x64_bf16 v[44:47], v[60:63], v[24:31], v2
    ds_read_b128 v[124:127], v4 offset:5120
    s_waitcnt lgkmcnt(8)
    v_smfmac_f32_16x16x64_bf16 v[40:43], v[64:67], v[216:223], v2
    ds_read_b128 v[60:63], v5 offset:1024
    ds_read_b128 v[24:27], v4 offset:36864
    v_smfmac_f32_16x16x64_bf16 v[44:47], v[64:67], v[32:39], v2
    ds_read_b128 v[28:31], v4 offset:37888
    s_waitcnt lgkmcnt(8)
    v_smfmac_f32_16x16x64_bf16 v[40:43], v[68:71], v[248:255], v2
    ds_read_b128 v[64:67], v5 offset:2048
    v_smfmac_f32_16x16x64_bf16 v[44:47], v[68:71], v[48:55], v2
    s_waitcnt lgkmcnt(6)
    v_smfmac_f32_16x16x64_bf16 v[40:43], v[56:59], v[144:151], v2
    ds_read_b128 v[68:71], v5 offset:3072
    v_smfmac_f32_16x16x64_bf16 v[44:47], v[56:59], v[104:111], v2
    s_waitcnt lgkmcnt(4)
    v_xor_b32 v5, 8192, v5
    v_smfmac_f32_16x16x64_bf16 v[40:43], v[60:63], v[176:183], v2
    s_add_u32 s4, s70, 0
    s_and_b32 s4, s4, 3
    v_smfmac_f32_16x16x64_bf16 v[44:47], v[60:63], v[112:119], v2
    s_waitcnt lgkmcnt(1)
    v_smfmac_f32_16x16x64_bf16 v[40:43], v[64:67], v[208:215], v2
    s_lshl_b32 s4, s4, 11
    s_add_u32 s6, s74, s4
    v_smfmac_f32_16x16x64_bf16 v[44:47], v[64:67], v[120:127], v2
    s_waitcnt lgkmcnt(0)
    v_smfmac_f32_16x16x64_bf16 v[40:43], v[68:71], v[240:247], v2
    v_smfmac_f32_16x16x64_bf16 v[44:47], v[68:71], v[24:31], v2
    s_nop 3
    v_pk_add_f32 v[40:41], v[40:41], v[42:43]
    v_cvt_pk_bf16_f32 v40, v40, v41
    s_xor_b32 s7, s6, 0x1000
    s_nop 0
    v_pk_add_f32 v[44:45], v[44:45], v[46:47]
    v_cvt_pk_bf16_f32 v41, v44, v45
    buffer_store_dwordx2 v[40:41], v7, s[8:11], s6 offen
    s_cmp_eq_u32 s70, 63
    s_cbranch_scc1 L_vo_last0
    s_add_u32 s4, s70, 0
    s_and_b32 s4, s4, 3
    s_lshl_b32 s4, s4, 14
    s_add_u32 s85, s75, s4
    buffer_store_dwordx2 v[16:17], v7, s[8:11], s7 offen
    s_xor_b32 s4, s85, 0x8000
    buffer_store_dwordx4 v[16:19], v13, s[8:11], s4 offen
    buffer_store_dwordx4 v[16:19], v13, s[8:11], s5 offen sc1
    s_add_u32 s4, s70, 0
    s_and_b32 s4, s4, 3
    s_lshl_b32 s4, s4, 15
    s_add_u32 s87, s73, s4
    s_cmp_le_u32 s70, 2
    s_cbranch_scc1 L_vo_spec0
L_vo_back0:
    s_add_u32 s4, s99, 128
    s_or_b32 s5, s4, 0x2400
    s_sub_u32 s4, s5, s99
    s_mov_b32 s99, s5
    s_add_u32 s3, s3, s4
    s_mov_b64 exec, 0xffff
    v_add_u32 v23, s4, v23
    s_mov_b64 exec, -1
    s_add_u32 s5, s70, 2
    s_min_u32 s5, s5, 63
    s_cmp_gt_u32 s77, s5
    s_cbranch_scc1 L_ndd_33
    v_lshrrev_b32 v24, 6, v1
    v_min_u32 v24, 2, v24
    v_lshlrev_b32 v24, 12, v24
    v_bfe_u32 v25, v1, 2, 4
    v_add_u32 v24, v24, v25
    s_lshl_b32 s4, s69, 7
    s_add_u32 s4, s4, 104931328
L_nd_32:
    buffer_load_dword v25, v24, s[8:11], s4 offen sc1
    s_waitcnt vmcnt(0)
    v_min_u32_dpp v25, v25, v25 quad_perm:[1,0,3,2] row_mask:0xf bank_mask:0xf
    s_nop 1
    v_min_u32_dpp v25, v25, v25 quad_perm:[2,3,0,1] row_mask:0xf bank_mask:0xf
    s_nop 1
    v_min_u32_dpp v25, v25, v25 row_ror:4 row_mask:0xf bank_mask:0xf
    s_nop 1
    v_min_u32_dpp v25, v25, v25 row_ror:8 row_mask:0xf bank_mask:0xf
    s_nop 0
    v_readfirstlane_b32 s77, v25
    s_nop 0
    s_cmp_gt_u32 s77, s5
    s_cbranch_scc1 L_ndd_33
    s_sub_u32 s65, s65, 1
    s_cmp_gt_i32 s65, 0
    s_cbranch_scc1 L_nd_32
L_ndd_33:
    s_add_u32 s82, s82, 262144
    s_waitcnt vmcnt(0)
    v_mov_b32 v0, 0
    s_mov_b64 exec, 0xffff
    s_lshl_b32 s83, s70, 1
    s_add_u32 s83, s83, 2
L_fp_34:
    s_sub_u32 s65, s65, 1
    s_cmp_gt_i32 s65, 0
    s_cselect_b32 s83, s83, 0
    s_nop 0
    buffer_load_dword v0, v22, s[8:11], 0 offen sc1
    s_waitcnt vmcnt(2)
L_fp_34c:
    v_cmpx_gt_u32 vcc, s83, v0
    s_cbranch_execnz L_fp_34
    s_mov_b64 exec, -1
    buffer_load_dwordx4 v[56:59], v1, s[8:11], s87 offen sc1
    s_add_u32 s88, s87, 4096
    s_add_u32 s89, s87, 8192
    s_add_u32 s90, s87, 12288
    s_add_u32 s91, s87, 16384
    s_add_u32 s92, s87, 20480
    s_add_u32 s93, s87, 24576
    s_add_u32 s94, s87, 28672
    s_lshl1_add_u32 s4, s70, 2
    v_mov_b32 v36, s4
    buffer_load_dwordx4 v[60:63], v1, s[8:11], s88 offen sc1
    v_lshrrev_b32 v37, 1, v7
    v_mov_b32 v40, 0
    v_mov_b32 v41, 0
    v_mov_b32 v42, 0
    v_mov_b32 v43, 0
    v_mov_b32 v44, 0
    v_mov_b32 v45, 0
    v_mov_b32 v46, 0
    v_mov_b32 v47, 0
    buffer_load_dwordx4 v[64:67], v1, s[8:11], s89 offen sc1
    v_mov_b32 v48, 0
    v_mov_b32 v49, 0
    v_mov_b32 v50, 0
    v_mov_b32 v51, 0
    v_mov_b32 v52, 0
    v_mov_b32 v53, 0
    v_mov_b32 v54, 0
    v_mov_b32 v55, 0
    buffer_load_dwordx4 v[68:71], v1, s[8:11], s90 offen sc1
L_ro_35:
    s_waitcnt vmcnt(3)
    v_smfmac_f32_16x16x64_bf16 v[40:43], v[56:59], a[0:7], v2
    buffer_load_dwordx4 v[72:75], v1, s[8:11], s91 offen sc1
    v_smfmac_f32_16x16x64_bf16 v[44:47], v[56:59], a[8:15], v2
    v_smfmac_f32_16x16x64_bf16 v[48:51], v[56:59], a[16:23], v2
    v_smfmac_f32_16x16x64_bf16 v[52:55], v[56:59], a[24:31], v2
    s_waitcnt vmcnt(3)
    v_smfmac_f32_16x16x64_bf16 v[40:43], v[60:63], a[32:39], v2
    buffer_load_dwordx4 v[76:79], v1, s[8:11], s92 offen sc1
    v_max_u32 v6, v56, v60
    v_smfmac_f32_16x16x64_bf16 v[44:47], v[60:63], a[40:47], v2
    v_smfmac_f32_16x16x64_bf16 v[48:51], v[60:63], a[48:55], v2
    v_smfmac_f32_16x16x64_bf16 v[52:55], v[60:63], a[56:63], v2
    s_waitcnt vmcnt(3)
    v_smfmac_f32_16x16x64_bf16 v[40:43], v[64:67], a[64:71], v2
    buffer_load_dwordx4 v[80:83], v1, s[8:11], s93 offen sc1
    v_smfmac_f32_16x16x64_bf16 v[44:47], v[64:67], a[72:79], v2
    v_smfmac_f32_16x16x64_bf16 v[48:51], v[64:67], a[80:87], v2
    v_smfmac_f32_16x16x64_bf16 v[52:55], v[64:67], a[88:95], v2
    s_waitcnt vmcnt(3)
    v_smfmac_f32_16x16x64_bf16 v[40:43], v[68:71], a[96:103], v2
    buffer_load_dwordx4 v[84:87], v1, s[8:11], s94 offen sc1
    v_max3_u32 v6, v6, v64, v68
    v_smfmac_f32_16x16x64_bf16 v[44:47], v[68:71], a[104:111], v2
    v_smfmac_f32_16x16x64_bf16 v[48:51], v[68:71], a[112:119], v2
    v_smfmac_f32_16x16x64_bf16 v[52:55], v[68:71], a[120:127], v2
    s_waitcnt vmcnt(3)
    v_smfmac_f32_16x16x64_bf16 v[40:43], v[72:75], a[128:135], v2
    v_smfmac_f32_16x16x64_bf16 v[44:47], v[72:75], a[136:143], v2
    v_smfmac_f32_16x16x64_bf16 v[48:51], v[72:75], a[144:151], v2
    v_smfmac_f32_16x16x64_bf16 v[52:55], v[72:75], a[152:159], v2
    s_waitcnt vmcnt(2)
    v_smfmac_f32_16x16x64_bf16 v[40:43], v[76:79], a[160:167], v2
    v_max3_u32 v6, v6, v72, v76
    v_smfmac_f32_16x16x64_bf16 v[44:47], v[76:79], a[168:175], v2
    v_smfmac_f32_16x16x64_bf16 v[48:51], v[76:79], a[176:183], v2
    v_smfmac_f32_16x16x64_bf16 v[52:55], v[76:79], a[184:191], v2
    s_waitcnt vmcnt(1)
    v_smfmac_f32_16x16x64_bf16 v[40:43], v[80:83], a[192:199], v2
    v_smfmac_f32_16x16x64_bf16 v[44:47], v[80:83], a[200:207], v2
    v_smfmac_f32_16x16x64_bf16 v[48:51], v[80:83], a[208:215], v2
    v_smfmac_f32_16x16x64_bf16 v[52:55], v[80:83], a[216:223], v2
    s_waitcnt vmcnt(0)
    v_smfmac_f32_16x16x64_bf16 v[40:43], v[84:87], a[224:231], v2
    v_max3_u32 v6, v6, v80, v84
    v_smfmac_f32_16x16x64_bf16 v[44:47], v[84:87], a[232:239], v2
    v_cmp_eq_u32 vcc, -1, v6
    v_smfmac_f32_16x16x64_bf16 v[48:51], v[84:87], a[240:247], v2
    v_pk_add_f32 v[40:41], v[40:41], v[42:43]
    v_smfmac_f32_16x16x64_bf16 v[52:55], v[84:87], a[248:255], v2
    s_cbranch_vccnz L_fix_36
L_ro_35x:
    ds_write_b64 v8, v[40:41] offset:0
    v_pk_add_f32 v[44:45], v[44:45], v[46:47]
    ds_write_b64 v8, v[44:45] offset:640
    v_pk_add_f32 v[48:49], v[48:49], v[50:51]
    ds_write_b64 v8, v[48:49] offset:1280
    s_nop 1
    v_pk_add_f32 v[52:53], v[52:53], v[54:55]
    ds_write_b64 v8, v[52:53] offset:1920
    s_mov_b64 exec, s[32:33]
    buffer_store_dword v36, v15, s[8:11], s3 offen sc1
    s_mov_b64 exec, -1
    s_waitcnt lgkmcnt(0)
    s_barrier
    ds_read2_b32 v[24:25], v9 offset0:0 offset1:10
    ds_read2_b32 v[26:27], v10 offset0:0 offset1:10
    ds_read2_b32 v[28:29], v11 offset0:0 offset1:10
    ds_read2_b32 v[30:31], v12 offset0:0 offset1:10
    buffer_store_dword v36, v15, s[8:11], s84 offen
    s_waitcnt lgkmcnt(2)
    v_pk_add_f32 v[24:25], v[24:25], v[26:27]
    s_waitcnt lgkmcnt(0)
    v_pk_add_f32 v[28:29], v[28:29], v[30:31]
    v_pk_add_f32 v[24:25], v[24:25], v[28:29]
    v_cvt_pk_bf16_f32 v88, v24, v25
    s_nop 1
    v_mov_b32_dpp v89, v88 quad_perm:[1,1,1,1] row_mask:0xf bank_mask:0xf
    v_mov_b32_dpp v90, v88 quad_perm:[2,2,2,2] row_mask:0xf bank_mask:0xf
    v_mov_b32_dpp v91, v88 quad_perm:[3,3,3,3] row_mask:0xf bank_mask:0xf
    buffer_store_dwordx4 v[88:91], v13, s[8:11], s85 offen
    s_barrier
    buffer_store_dwordx4 v[88:91], v13, s[8:11], s86 offen sc1
    s_add_u32 s70, s70, 1
    s_branch L_vo_loop0
L_vo_spec0:
    s_cmp_eq_u32 s70, 2
    s_cbranch_scc1 L_vo_sw0
    s_sub_u32 s4, s70, 1
    s_cmp_lt_u32 s4, 1
    s_cbranch_scc0 L_vo_back0
    s_lshl_b32 s4, s69, 8
    s_lshr_b32 s5, s63, 1
    s_lshl_b32 s5, s5, 13
    s_add_u32 s4, s4, s5
    s_and_b32 s5, s63, 1
    s_lshl_b32 s5, s5, 7
    s_add_u32 s4, s4, s5
    s_add_u32 s4, s4, 105054208
    s_and_b32 s5, s70, 3
    s_lshl_b32 s5, s5, 14
    s_add_u32 s4, s4, s5
    s_lshl_b32 s5, s63, 2
    s_add_u32 s5, s5, 159744
    v_mov_b32 v24, 0
    v_mov_b32 v25, s5
    v_bfe_i32 v27, v25, 2, 1
    v_or_b32 v27, 1, v27
    s_mov_b64 exec, 1
    ds_write_b32 v25, v24
    v_mov_b32 v24, 1
    s_add_u32 s5, s63, 1
    s_bitcmp1_b32 s5, 1
    s_cselect_b64 exec, 1, 0
    s_waitcnt vmcnt(0) lgkmcnt(0)
    s_barrier
    buffer_load_dword v26, v1, s[8:11], s4 offen sc1
    s_barrier
    s_cbranch_scc0 L_race_37
    s_waitcnt vmcnt(0)
    ds_write_b32 v25, v24
    v_xor_b32 v25, 12, v25
    s_waitcnt lgkmcnt(0)
    ds_read_b32 v24, v25
    s_waitcnt lgkmcnt(0)
    v_cmpx_eq_u32 vcc, 0, v24
    buffer_atomic_add v27, v15, s[24:27], 0 offen offset:132 sc1
L_race_37:
    s_mov_b64 exec, -1
    s_branch L_vo_back0
L_vo_sw0:
    buffer_load_dword v0, v15, s[24:27], 0 offen offset:132 sc1
    s_waitcnt vmcnt(0)
    v_readfirstlane_b32 s83, v0
    s_nop 0
    s_cmp_gt_i32 s83, 0
    s_cselect_b32 s83, 8192, 0
    s_add_u32 s76, s76, s83
    s_add_u32 s86, s86, s83
    s_add_u32 s3, s3, s83
    s_add_u32 s72, s72, s83
    s_mov_b64 exec, 0xffff
    v_add_u32 v23, s83, v23
    s_mov_b64 exec, -1
    s_branch L_vo_back0
L_vo_last0:
    s_endpgm
L_fix_31:
    s_nop 7
    buffer_load_dwordx4 v[60:63], v1, s[8:11], s87 offen sc1
    buffer_load_dwordx4 v[68:71], v1, s[8:11], s88 offen sc1
    buffer_load_dwordx4 v[76:79], v1, s[8:11], s89 offen sc1
    buffer_load_dwordx4 v[84:87], v1, s[8:11], s90 offen sc1
    buffer_load_dwordx4 v[88:91], v1, s[8:11], s91 offen sc1
    buffer_load_dwordx4 v[92:95], v1, s[8:11], s92 offen sc1
    buffer_load_dwordx4 v[96:99], v1, s[8:11], s93 offen sc1
    buffer_load_dwordx4 v[100:103], v1, s[8:11], s94 offen sc1
    s_waitcnt vmcnt(0)
    v_max3_u32 v0, v60, v68, v76
    v_max3_u32 v0, v0, v84, v88
    v_max3_u32 v0, v0, v92, v96
    v_max_u32 v0, v0, v100
    v_cmp_eq_u32 vcc, -1, v0
    s_cbranch_vccz L_fix_31d
    s_sub_u32 s65, s65, 1
    s_cmp_gt_i32 s65, 0
    s_cbranch_scc1 L_fix_31
    s_endpgm
L_fix_31d:
    v_mov_b32 v6, 0
    s_waitcnt lgkmcnt(0)
    v_mfma_f32_4x4x4_16b_bf16 v[56:59], v[20:21], v[60:61], 0
    v_mfma_f32_4x4x4_16b_bf16 v[60:63], v[20:21], v[62:63], 0
    v_mfma_f32_4x4x4_16b_bf16 v[64:67], v[20:21], v[68:69], 0
    v_mfma_f32_4x4x4_16b_bf16 v[68:71], v[20:21], v[70:71], 0
    v_mfma_f32_4x4x4_16b_bf16 v[72:75], v[20:21], v[76:77], 0
    v_mfma_f32_4x4x4_16b_bf16 v[76:79], v[20:21], v[78:79], 0
    v_mfma_f32_4x4x4_16b_bf16 v[80:83], v[20:21], v[84:85], 0
    v_mfma_f32_4x4x4_16b_bf16 v[84:87], v[20:21], v[86:87], 0
    ds_read_b128 v[104:107], v3 offset:0
    ds_read_b128 v[108:111], v3 offset:1024
    ds_read_b128 v[112:115], v3 offset:32768
    ds_read_b128 v[116:119], v3 offset:33792
    ds_read_b128 v[120:123], v4 offset:0
    ds_read_b128 v[124:127], v4 offset:1024
    ds_read_b128 v[24:27], v4 offset:32768
    ds_read_b128 v[28:31], v4 offset:33792
    ds_read_b128 v[32:35], v3 offset:2048
    ds_read_b128 v[36:39], v3 offset:3072
    v_mov_b32 v40, 0
    v_mov_b32 v41, 0
    v_mov_b32 v42, 0
    v_mov_b32 v43, 0
    v_mov_b32 v44, 0
    v_mov_b32 v45, 0
    v_mov_b32 v46, 0
    v_mov_b32 v47, 0
    v_xor_b32 v5, 4096, v5
    s_branch L_rl_30
L_fix_36:
    s_nop 7
    buffer_load_dwordx4 v[56:59], v1, s[8:11], s87 offen sc1
    buffer_load_dwordx4 v[60:63], v1, s[8:11], s88 offen sc1
    buffer_load_dwordx4 v[64:67], v1, s[8:11], s89 offen sc1
    buffer_load_dwordx4 v[68:71], v1, s[8:11], s90 offen sc1
    buffer_load_dwordx4 v[72:75], v1, s[8:11], s91 offen sc1
    buffer_load_dwordx4 v[76:79], v1, s[8:11], s92 offen sc1
    buffer_load_dwordx4 v[80:83], v1, s[8:11], s93 offen sc1
    buffer_load_dwordx4 v[84:87], v1, s[8:11], s94 offen sc1
    s_waitcnt vmcnt(0)
    v_max3_u32 v0, v56, v60, v64
    v_max3_u32 v0, v0, v68, v72
    v_max3_u32 v0, v0, v76, v80
    v_max_u32 v0, v0, v84
    v_cmp_eq_u32 vcc, -1, v0
    s_cbranch_vccz L_fix_36d
    s_sub_u32 s65, s65, 1
    s_cmp_gt_i32 s65, 0
    s_cbranch_scc1 L_fix_36
    s_endpgm
L_fix_36d:
    v_mov_b32 v40, 0
    v_mov_b32 v41, 0
    v_mov_b32 v42, 0
    v_mov_b32 v43, 0
    v_mov_b32 v44, 0
    v_mov_b32 v45, 0
    v_mov_b32 v46, 0
    v_mov_b32 v47, 0
    v_mov_b32 v48, 0
    v_mov_b32 v49, 0
    v_mov_b32 v50, 0
    v_mov_b32 v51, 0
    v_mov_b32 v52, 0
    v_mov_b32 v53, 0
    v_mov_b32 v54, 0
    v_mov_b32 v55, 0
    v_smfmac_f32_16x16x64_bf16 v[40:43], v[56:59], a[0:7], v2
    v_smfmac_f32_16x16x64_bf16 v[44:47], v[56:59], a[8:15], v2
    v_smfmac_f32_16x16x64_bf16 v[48:51], v[56:59], a[16:23], v2
    v_smfmac_f32_16x16x64_bf16 v[52:55], v[56:59], a[24:31], v2
    v_smfmac_f32_16x16x64_bf16 v[40:43], v[60:63], a[32:39], v2
    v_smfmac_f32_16x16x64_bf16 v[44:47], v[60:63], a[40:47], v2
    v_smfmac_f32_16x16x64_bf16 v[48:51], v[60:63], a[48:55], v2
    v_smfmac_f32_16x16x64_bf16 v[52:55], v[60:63], a[56:63], v2
    v_smfmac_f32_16x16x64_bf16 v[40:43], v[64:67], a[64:71], v2
    v_smfmac_f32_16x16x64_bf16 v[44:47], v[64:67], a[72:79], v2
    v_smfmac_f32_16x16x64_bf16 v[48:51], v[64:67], a[80:87], v2
    v_smfmac_f32_16x16x64_bf16 v[52:55], v[64:67], a[88:95], v2
    v_smfmac_f32_16x16x64_bf16 v[40:43], v[68:71], a[96:103], v2
    v_smfmac_f32_16x16x64_bf16 v[44:47], v[68:71], a[104:111], v2
    v_smfmac_f32_16x16x64_bf16 v[48:51], v[68:71], a[112:119], v2
    v_smfmac_f32_16x16x64_bf16 v[52:55], v[68:71], a[120:127], v2
    v_smfmac_f32_16x16x64_bf16 v[40:43], v[72:75], a[128:135], v2
    v_smfmac_f32_16x16x64_bf16 v[44:47], v[72:75], a[136:143], v2
    v_smfmac_f32_16x16x64_bf16 v[48:51], v[72:75], a[144:151], v2
    v_smfmac_f32_16x16x64_bf16 v[52:55], v[72:75], a[152:159], v2
    v_smfmac_f32_16x16x64_bf16 v[40:43], v[76:79], a[160:167], v2
    v_smfmac_f32_16x16x64_bf16 v[44:47], v[76:79], a[168:175], v2
    v_smfmac_f32_16x16x64_bf16 v[48:51], v[76:79], a[176:183], v2
    v_smfmac_f32_16x16x64_bf16 v[52:55], v[76:79], a[184:191], v2
    v_smfmac_f32_16x16x64_bf16 v[40:43], v[80:83], a[192:199], v2
    v_smfmac_f32_16x16x64_bf16 v[44:47], v[80:83], a[200:207], v2
    v_smfmac_f32_16x16x64_bf16 v[48:51], v[80:83], a[208:215], v2
    v_smfmac_f32_16x16x64_bf16 v[52:55], v[80:83], a[216:223], v2
    v_smfmac_f32_16x16x64_bf16 v[40:43], v[84:87], a[224:231], v2
    v_smfmac_f32_16x16x64_bf16 v[44:47], v[84:87], a[232:239], v2
    v_smfmac_f32_16x16x64_bf16 v[48:51], v[84:87], a[240:247], v2
    v_smfmac_f32_16x16x64_bf16 v[52:55], v[84:87], a[248:255], v2
    v_pk_add_f32 v[40:41], v[40:41], v[42:43]
    s_branch L_ro_35x
L_vo_loop1:
    s_add_u32 s4, s70, 0
    s_and_b32 s4, s4, 3
    s_lshl_b32 s4, s4, 15
    s_add_u32 s86, s76, s4
    s_xor_b32 s5, s86, 0x10000
    s_add_u32 s4, s70, 3
    s_and_b32 s4, s4, 3
    s_lshl_b32 s4, s4, 14
    s_add_u32 s87, s71, s4
    v_mov_b32 v0, 0
    s_mov_b32 exec_hi, 0
    s_lshl_b32 s83, s70, 1
L_fp_38:
    s_sub_u32 s65, s65, 1
    s_cmp_gt_i32 s65, 0
    s_cselect_b32 s83, s83, 0
    s_nop 0
    buffer_load_dword v0, v23, s[8:11], 0 offen sc1
    s_waitcnt vmcnt(1)
L_fp_38c:
    v_cmpx_gt_u32 vcc, s83, v0
    s_cbranch_execnz L_fp_38
    s_mov_b64 exec, -1
    buffer_load_dwordx4 v[60:63], v1, s[8:11], s87 offen sc1
    s_add_u32 s88, s87, 4096
    s_add_u32 s89, s87, 8192
    s_add_u32 s90, s87, 12288
    s_add_u32 s4, s70, 3
    s_and_b32 s4, s4, 3
    s_lshl_b32 s4, s4, 15
    s_add_u32 s91, s72, s4
    s_add_u32 s92, s91, 4096
    s_add_u32 s93, s91, 16384
    s_add_u32 s94, s91, 20480
    buffer_load_dwordx4 v[68:71], v1, s[8:11], s88 offen sc1
    ds_read_b128 v[104:107], v3 offset:0
    ds_read_b128 v[108:111], v3 offset:1024
    ds_read_b128 v[112:115], v3 offset:32768
    ds_read_b128 v[116:119], v3 offset:33792
    ds_read_b128 v[120:123], v4 offset:0
    ds_read_b128 v[124:127], v4 offset:1024
    ds_read_b128 v[24:27], v4 offset:32768
    ds_read_b128 v[28:31], v4 offset:33792
    ds_read_b128 v[32:35], v3 offset:2048
    buffer_load_dwordx4 v[76:79], v1, s[8:11], s89 offen sc1
    ds_read_b128 v[36:39], v3 offset:3072
    v_mov_b32 v40, 0
    v_mov_b32 v41, 0
    v_mov_b32 v42, 0
    v_mov_b32 v43, 0
    v_mov_b32 v44, 0
    v_mov_b32 v45, 0
    v_mov_b32 v46, 0
    v_mov_b32 v47, 0
    buffer_load_dwordx4 v[84:87], v1, s[8:11], s90 offen sc1
    s_waitcnt vmcnt(3)
    buffer_load_dwordx4 v[88:91], v1, s[8:11], s91 offen sc1
    v_mov_b32 v6, v60
    v_mfma_f32_4x4x4_16b_bf16 v[56:59], v[20:21], v[60:61], 0
    v_mfma_f32_4x4x4_16b_bf16 v[60:63], v[20:21], v[62:63], 0
    s_waitcnt vmcnt(3)
    buffer_load_dwordx4 v[92:95], v1, s[8:11], s92 offen sc1
    v_max_u32 v6, v6, v68
    v_mfma_f32_4x4x4_16b_bf16 v[64:67], v[20:21], v[68:69], 0
    v_mfma_f32_4x4x4_16b_bf16 v[68:71], v[20:21], v[70:71], 0
    s_waitcnt vmcnt(3)
    buffer_load_dwordx4 v[96:99], v1, s[8:11], s93 offen sc1
    v_max_u32 v6, v6, v76
    v_mfma_f32_4x4x4_16b_bf16 v[72:75], v[20:21], v[76:77], 0
    v_mfma_f32_4x4x4_16b_bf16 v[76:79], v[20:21], v[78:79], 0
    s_waitcnt vmcnt(3)
    buffer_load_dwordx4 v[100:103], v1, s[8:11], s94 offen sc1
    v_max_u32 v6, v6, v84
    v_mfma_f32_4x4x4_16b_bf16 v[80:83], v[20:21], v[84:85], 0
    v_mfma_f32_4x4x4_16b_bf16 v[84:87], v[20:21], v[86:87], 0
L_rl_39:
    s_waitcnt vmcnt(2)
    v_mfma_f32_4x4x4_16b_bf16 v[56:59], v[20:21], v[88:89], v[56:59]
    v_max3_u32 v6, v6, v88, v92
    v_mfma_f32_4x4x4_16b_bf16 v[60:63], v[20:21], v[90:91], v[60:63]
    v_mfma_f32_4x4x4_16b_bf16 v[64:67], v[20:21], v[92:93], v[64:67]
    v_mfma_f32_4x4x4_16b_bf16 v[68:71], v[20:21], v[94:95], v[68:71]
    v_cvt_pk_bf16_f32 v88, v56, v57
    v_cvt_pk_bf16_f32 v89, v58, v59
    v_cvt_pk_bf16_f32 v90, v60, v61
    v_cvt_pk_bf16_f32 v91, v62, v63
    ds_write_b128 v5, v[88:91] offset:0
    s_nop 0
    v_smfmac_f32_16x16x64_bf16 v[40:43], v[88:91], v[128:135], v2
    ds_read_b128 v[48:51], v3 offset:34816
    ds_read_b128 v[52:55], v3 offset:35840
    s_waitcnt lgkmcnt(11)
    v_cvt_pk_bf16_f32 v92, v64, v65
    v_cvt_pk_bf16_f32 v93, v66, v67
    v_smfmac_f32_16x16x64_bf16 v[44:47], v[88:91], v[104:111], v2
    v_cvt_pk_bf16_f32 v94, v68, v69
    v_cvt_pk_bf16_f32 v95, v70, v71
    ds_write_b128 v5, v[92:95] offset:1024
    s_waitcnt vmcnt(0)
    v_mfma_f32_4x4x4_16b_bf16 v[72:75], v[20:21], v[96:97], v[72:75]
    v_max3_u32 v6, v6, v96, v100
    v_mfma_f32_4x4x4_16b_bf16 v[76:79], v[20:21], v[98:99], v[76:79]
    v_mfma_f32_4x4x4_16b_bf16 v[80:83], v[20:21], v[100:101], v[80:83]
    v_mfma_f32_4x4x4_16b_bf16 v[84:87], v[20:21], v[102:103], v[84:87]
    v_cvt_pk_bf16_f32 v96, v72, v73
    v_cvt_pk_bf16_f32 v97, v74, v75
    v_cvt_pk_bf16_f32 v98, v76, v77
    v_cvt_pk_bf16_f32 v99, v78, v79
    ds_write_b128 v5, v[96:99] offset:2048
    v_smfmac_f32_16x16x64_bf16 v[40:43], v[92:95], v[160:167], v2
    ds_read_b128 v[104:107], v4 offset:2048
    ds_read_b128 v[108:111], v4 offset:3072
    s_waitcnt lgkmcnt(13)
    v_cvt_pk_bf16_f32 v100, v80, v81
    v_cvt_pk_bf16_f32 v101, v82, v83
    v_smfmac_f32_16x16x64_bf16 v[44:47], v[92:95], v[112:119], v2
    v_cvt_pk_bf16_f32 v102, v84, v85
    v_cvt_pk_bf16_f32 v103, v86, v87
    ds_write_b128 v5, v[100:103] offset:3072
    v_smfmac_f32_16x16x64_bf16 v[40:43], v[96:99], v[192:199], v2
    ds_read_b128 v[112:115], v4 offset:34816
    ds_read_b128 v[116:119], v4 offset:35840
    s_waitcnt lgkmcnt(14)
    v_cmp_eq_u32 vcc, -1, v6
    v_smfmac_f32_16x16x64_bf16 v[44:47], v[96:99], v[120:127], v2
    v_xor_b32 v5, 4096, v5
    s_cbranch_vccnz L_fix_40
    s_waitcnt lgkmcnt(2)
    s_barrier
    ds_read_b128 v[56:59], v5 offset:0
    v_smfmac_f32_16x16x64_bf16 v[40:43], v[100:103], v[224:231], v2
    ds_read_b128 v[60:63], v5 offset:1024
    ds_read_b128 v[64:67], v5 offset:2048
    v_smfmac_f32_16x16x64_bf16 v[44:47], v[100:103], v[24:31], v2
    ds_read_b128 v[120:123], v3 offset:6144
    ds_read_b128 v[124:127], v3 offset:7168
    s_waitcnt lgkmcnt(4)
    v_smfmac_f32_16x16x64_bf16 v[40:43], v[56:59], v[136:143], v2
    ds_read_b128 v[68:71], v5 offset:3072
    ds_read_b128 v[24:27], v3 offset:38912
    v_smfmac_f32_16x16x64_bf16 v[44:47], v[56:59], v[32:39], v2
    ds_read_b128 v[28:31], v3 offset:39936
    s_waitcnt lgkmcnt(6)
    v_xor_b32 v5, 8192, v5
    v_smfmac_f32_16x16x64_bf16 v[40:43], v[60:63], v[168:175], v2
    ds_read_b128 v[56:59], v5 offset:0
    ds_read_b128 v[32:35], v4 offset:6144
    v_smfmac_f32_16x16x64_bf16 v[44:47], v[60:63], v[48:55], v2
    ds_read_b128 v[36:39], v4 offset:7168
    s_waitcnt lgkmcnt(8)
    v_smfmac_f32_16x16x64_bf16 v[40:43], v[64:67], v[200:207], v2
    ds_read_b128 v[60:63], v5 offset:1024
    ds_read_b128 v[48:51], v4 offset:38912
    v_smfmac_f32_16x16x64_bf16 v[44:47], v[64:67], v[104:111], v2
    ds_read_b128 v[52:55], v4 offset:39936
    s_waitcnt lgkmcnt(8)
    v_smfmac_f32_16x16x64_bf16 v[40:43], v[68:71], v[232:239], v2
    ds_read_b128 v[64:67], v5 offset:2048
    ds_read_b128 v[104:107], v3 offset:4096
    v_smfmac_f32_16x16x64_bf16 v[44:47], v[68:71], v[112:119], v2
    ds_read_b128 v[108:111], v3 offset:5120
    s_waitcnt lgkmcnt(8)
    v_smfmac_f32_16x16x64_bf16 v[40:43], v[56:59], v[152:159], v2
    ds_read_b128 v[68:71], v5 offset:3072
    ds_read_b128 v[112:115], v3 offset:36864
    v_smfmac_f32_16x16x64_bf16 v[44:47], v[56:59], v[120:127], v2
    ds_read_b128 v[116:119], v3 offset:37888
    s_waitcnt lgkmcnt(8)
    v_xor_b32 v5, 4096, v5
    v_smfmac_f32_16x16x64_bf16 v[40:43], v[60:63], v[184:191], v2
    ds_read_b128 v[56:59], v5 offset:0
    ds_read_b128 v[120:123], v4 offset:4096
    v_smfmac_f32_16x16x64_bf16 v[44:47], v[60:63], v[24:31], v2
    ds_read_b128 v[124:127], v4 offset:5120
    s_waitcnt lgkmcnt(8)
    v_smfmac_f32_16x16x64_bf16 v[40:43], v[64:67], v[216:223], v2
    ds_read_b128 v[60:63], v5 offset:1024
    ds_read_b128 v[24:27], v4 offset:36864
    v_smfmac_f32_16x16x64_bf16 v[44:47], v[64:67], v[32:39], v2
    ds_read_b128 v[28:31], v4 offset:37888
    s_waitcnt lgkmcnt(8)
    v_smfmac_f32_16x16x64_bf16 v[40:43], v[68:71], v[248:255], v2
    ds_read_b128 v[64:67], v5 offset:2048
    v_smfmac_f32_16x16x64_bf16 v[44:47], v[68:71], v[48:55], v2
    s_waitcnt lgkmcnt(6)
    v_smfmac_f32_16x16x64_bf16 v[40:43], v[56:59], v[144:151], v2
    ds_read_b128 v[68:71], v5 offset:3072
    v_smfmac_f32_16x16x64_bf16 v[44:47], v[56:59], v[104:111], v2
    s_waitcnt lgkmcnt(4)
    v_xor_b32 v5, 8192, v5
    v_smfmac_f32_16x16x64_bf16 v[40:43], v[60:63], v[176:183], v2
    s_add_u32 s4, s70, 0
    s_and_b32 s4, s4, 3
    v_smfmac_f32_16x16x64_bf16 v[44:47], v[60:63], v[112:119], v2
    s_waitcnt lgkmcnt(1)
    v_smfmac_f32_16x16x64_bf16 v[40:43], v[64:67], v[208:215], v2
    s_lshl_b32 s4, s4, 11
    s_add_u32 s6, s74, s4
    v_smfmac_f32_16x16x64_bf16 v[44:47], v[64:67], v[120:127], v2
    s_waitcnt lgkmcnt(0)
    v_smfmac_f32_16x16x64_bf16 v[40:43], v[68:71], v[240:247], v2
    v_smfmac_f32_16x16x64_bf16 v[44:47], v[68:71], v[24:31], v2
    s_nop 3
    v_pk_add_f32 v[40:41], v[40:41], v[42:43]
    v_cvt_pk_bf16_f32 v40, v40, v41
    s_xor_b32 s7, s6, 0x1000
    s_nop 0
    v_pk_add_f32 v[44:45], v[44:45], v[46:47]
    v_cvt_pk_bf16_f32 v41, v44, v45
    buffer_store_dwordx2 v[40:41], v7, s[8:11], s6 offen sc1
    s_cmp_eq_u32 s70, 63
    s_cbranch_scc1 L_vo_last1
    s_add_u32 s4, s70, 0
    s_and_b32 s4, s4, 3
    s_lshl_b32 s4, s4, 14
    s_add_u32 s85, s75, s4
    buffer_store_dwordx2 v[16:17], v7, s[8:11], s7 offen sc1
    s_xor_b32 s4, s85, 0x8000
    buffer_store_dwordx4 v[16:19], v13, s[8:11], s4 offen sc1
    buffer_store_dwordx4 v[16:19], v13, s[8:11], s5 offen sc1
    s_add_u32 s4, s70, 0
    s_and_b32 s4, s4, 3
    s_lshl_b32 s4, s4, 15
    s_add_u32 s87, s73, s4
    s_cmp_le_u32 s70, 2
    s_cbranch_scc1 L_vo_spec1
L_vo_back1:
    s_add_u32 s4, s99, 128
    s_or_b32 s5, s4, 0x2400
    s_sub_u32 s4, s5, s99
    s_mov_b32 s99, s5
    s_add_u32 s3, s3, s4
    s_mov_b64 exec, 0xffff
    v_add_u32 v23, s4, v23
    s_mov_b64 exec, -1
    s_add_u32 s5, s70, 2
    s_min_u32 s5, s5, 63
    s_cmp_gt_u32 s77, s5
    s_cbranch_scc1 L_ndd_42
    v_lshrrev_b32 v24, 6, v1
    v_min_u32 v24, 2, v24
    v_lshlrev_b32 v24, 12, v24
    v_bfe_u32 v25, v1, 2, 4
    v_add_u32 v24, v24, v25
    s_lshl_b32 s4, s69, 7
    s_add_u32 s4, s4, 104931328
L_nd_41:
    buffer_load_dword v25, v24, s[8:11], s4 offen sc1
    s_waitcnt vmcnt(0)
    v_min_u32_dpp v25, v25, v25 quad_perm:[1,0,3,2] row_mask:0xf bank_mask:0xf
    s_nop 1
    v_min_u32_dpp v25, v25, v25 quad_perm:[2,3,0,1] row_mask:0xf bank_mask:0xf
    s_nop 1
    v_min_u32_dpp v25, v25, v25 row_ror:4 row_mask:0xf bank_mask:0xf
    s_nop 1
    v_min_u32_dpp v25, v25, v25 row_ror:8 row_mask:0xf bank_mask:0xf
    s_nop 0
    v_readfirstlane_b32 s77, v25
    s_nop 0
    s_cmp_gt_u32 s77, s5
    s_cbranch_scc1 L_ndd_42
    s_sub_u32 s65, s65, 1
    s_cmp_gt_i32 s65, 0
    s_cbranch_scc1 L_nd_41
L_ndd_42:
    s_add_u32 s82, s82, 262144
    s_waitcnt vmcnt(0)
    v_mov_b32 v0, 0
    s_mov_b64 exec, 0xffff
    s_lshl_b32 s83, s70, 1
    s_add_u32 s83, s83, 2
L_fp_43:
    s_sub_u32 s65, s65, 1
    s_cmp_gt_i32 s65, 0
    s_cselect_b32 s83, s83, 0
    s_nop 0
    buffer_load_dword v0, v22, s[8:11], 0 offen sc1
    s_waitcnt vmcnt(2)
L_fp_43c:
    v_cmpx_gt_u32 vcc, s83, v0
    s_cbranch_execnz L_fp_43
    s_mov_b64 exec, -1
    buffer_load_dwordx4 v[56:59], v1, s[8:11], s87 offen sc1
    s_add_u32 s88, s87, 4096
    s_add_u32 s89, s87, 8192
    s_add_u32 s90, s87, 12288
    s_add_u32 s91, s87, 16384
    s_add_u32 s92, s87, 20480
    s_add_u32 s93, s87, 24576
    s_add_u32 s94, s87, 28672
    s_lshl1_add_u32 s4, s70, 2
    v_mov_b32 v36, s4
    buffer_load_dwordx4 v[60:63], v1, s[8:11], s88 offen sc1
    v_lshrrev_b32 v37, 1, v7
    v_mov_b32 v40, 0
    v_mov_b32 v41, 0
    v_mov_b32 v42, 0
    v_mov_b32 v43, 0
    v_mov_b32 v44, 0
    v_mov_b32 v45, 0
    v_mov_b32 v46, 0
    v_mov_b32 v47, 0
    buffer_load_dwordx4 v[64:67], v1, s[8:11], s89 offen sc1
    v_mov_b32 v48, 0
    v_mov_b32 v49, 0
    v_mov_b32 v50, 0
    v_mov_b32 v51, 0
    v_mov_b32 v52, 0
    v_mov_b32 v53, 0
    v_mov_b32 v54, 0
    v_mov_b32 v55, 0
    buffer_load_dwordx4 v[68:71], v1, s[8:11], s90 offen sc1
L_ro_44:
    s_waitcnt vmcnt(3)
    v_smfmac_f32_16x16x64_bf16 v[40:43], v[56:59], a[0:7], v2
    buffer_load_dwordx4 v[72:75], v1, s[8:11], s91 offen sc1
    v_smfmac_f32_16x16x64_bf16 v[44:47], v[56:59], a[8:15], v2
    v_smfmac_f32_16x16x64_bf16 v[48:51], v[56:59], a[16:23], v2
    v_smfmac_f32_16x16x64_bf16 v[52:55], v[56:59], a[24:31], v2
    s_waitcnt vmcnt(3)
    v_smfmac_f32_16x16x64_bf16 v[40:43], v[60:63], a[32:39], v2
    buffer_load_dwordx4 v[76:79], v1, s[8:11], s92 offen sc1
    v_max_u32 v6, v56, v60
    v_smfmac_f32_16x16x64_bf16 v[44:47], v[60:63], a[40:47], v2
    v_smfmac_f32_16x16x64_bf16 v[48:51], v[60:63], a[48:55], v2
    v_smfmac_f32_16x16x64_bf16 v[52:55], v[60:63], a[56:63], v2
    s_waitcnt vmcnt(3)
    v_smfmac_f32_16x16x64_bf16 v[40:43], v[64:67], a[64:71], v2
    buffer_load_dwordx4 v[80:83], v1, s[8:11], s93 offen sc1
    v_smfmac_f32_16x16x64_bf16 v[44:47], v[64:67], a[72:79], v2
    v_smfmac_f32_16x16x64_bf16 v[48:51], v[64:67], a[80:87], v2
    v_smfmac_f32_16x16x64_bf16 v[52:55], v[64:67], a[88:95], v2
    s_waitcnt vmcnt(3)
    v_smfmac_f32_16x16x64_bf16 v[40:43], v[68:71], a[96:103], v2
    buffer_load_dwordx4 v[84:87], v1, s[8:11], s94 offen sc1
    v_max3_u32 v6, v6, v64, v68
    v_smfmac_f32_16x16x64_bf16 v[44:47], v[68:71], a[104:111], v2
    v_smfmac_f32_16x16x64_bf16 v[48:51], v[68:71], a[112:119], v2
    v_smfmac_f32_16x16x64_bf16 v[52:55], v[68:71], a[120:127], v2
    s_waitcnt vmcnt(3)
    v_smfmac_f32_16x16x64_bf16 v[40:43], v[72:75], a[128:135], v2
    v_smfmac_f32_16x16x64_bf16 v[44:47], v[72:75], a[136:143], v2
    v_smfmac_f32_16x16x64_bf16 v[48:51], v[72:75], a[144:151], v2
    v_smfmac_f32_16x16x64_bf16 v[52:55], v[72:75], a[152:159], v2
    s_waitcnt vmcnt(2)
    v_smfmac_f32_16x16x64_bf16 v[40:43], v[76:79], a[160:167], v2
    v_max3_u32 v6, v6, v72, v76
    v_smfmac_f32_16x16x64_bf16 v[44:47], v[76:79], a[168:175], v2
    v_smfmac_f32_16x16x64_bf16 v[48:51], v[76:79], a[176:183], v2
    v_smfmac_f32_16x16x64_bf16 v[52:55], v[76:79], a[184:191], v2
    s_waitcnt vmcnt(1)
    v_smfmac_f32_16x16x64_bf16 v[40:43], v[80:83], a[192:199], v2
    v_smfmac_f32_16x16x64_bf16 v[44:47], v[80:83], a[200:207], v2
    v_smfmac_f32_16x16x64_bf16 v[48:51], v[80:83], a[208:215], v2
    v_smfmac_f32_16x16x64_bf16 v[52:55], v[80:83], a[216:223], v2
    s_waitcnt vmcnt(0)
    v_smfmac_f32_16x16x64_bf16 v[40:43], v[84:87], a[224:231], v2
    v_max3_u32 v6, v6, v80, v84
    v_smfmac_f32_16x16x64_bf16 v[44:47], v[84:87], a[232:239], v2
    v_cmp_eq_u32 vcc, -1, v6
    v_smfmac_f32_16x16x64_bf16 v[48:51], v[84:87], a[240:247], v2
    v_pk_add_f32 v[40:41], v[40:41], v[42:43]
    v_smfmac_f32_16x16x64_bf16 v[52:55], v[84:87], a[248:255], v2
    s_cbranch_vccnz L_fix_45
L_ro_44x:
    ds_write_b64 v8, v[40:41] offset:0
    v_pk_add_f32 v[44:45], v[44:45], v[46:47]
    ds_write_b64 v8, v[44:45] offset:640
    v_pk_add_f32 v[48:49], v[48:49], v[50:51]
    ds_write_b64 v8, v[48:49] offset:1280
    s_nop 1
    v_pk_add_f32 v[52:53], v[52:53], v[54:55]
    ds_write_b64 v8, v[52:53] offset:1920
    s_mov_b64 exec, s[32:33]
    buffer_store_dword v36, v15, s[8:11], s3 offen sc1
    s_mov_b64 exec, -1
    s_waitcnt lgkmcnt(0)
    s_barrier
    ds_read2_b32 v[24:25], v9 offset0:0 offset1:10
    ds_read2_b32 v[26:27], v10 offset0:0 offset1:10
    ds_read2_b32 v[28:29], v11 offset0:0 offset1:10
    ds_read2_b32 v[30:31], v12 offset0:0 offset1:10
    buffer_store_dword v36, v15, s[8:11], s84 offen sc1
    s_waitcnt lgkmcnt(2)
    v_pk_add_f32 v[24:25], v[24:25], v[26:27]
    s_waitcnt lgkmcnt(0)
    v_pk_add_f32 v[28:29], v[28:29], v[30:31]
    v_pk_add_f32 v[24:25], v[24:25], v[28:29]
    v_cvt_pk_bf16_f32 v88, v24, v25
    s_nop 1
    v_mov_b32_dpp v89, v88 quad_perm:[1,1,1,1] row_mask:0xf bank_mask:0xf
    v_mov_b32_dpp v90, v88 quad_perm:[2,2,2,2] row_mask:0xf bank_mask:0xf
    v_mov_b32_dpp v91, v88 quad_perm:[3,3,3,3] row_mask:0xf bank_mask:0xf
    buffer_store_dwordx4 v[88:91], v13, s[8:11], s85 offen sc1
    s_barrier
    buffer_store_dwordx4 v[88:91], v13, s[8:11], s86 offen sc1
    s_add_u32 s70, s70, 1
    s_branch L_vo_loop1
L_vo_spec1:
    s_cmp_eq_u32 s70, 2
    s_cbranch_scc1 L_vo_sw1
    s_sub_u32 s4, s70, 1
    s_cmp_lt_u32 s4, 1
    s_cbranch_scc0 L_vo_back1
    s_lshl_b32 s4, s69, 8
    s_lshr_b32 s5, s63, 1
    s_lshl_b32 s5, s5, 13
    s_add_u32 s4, s4, s5
    s_and_b32 s5, s63, 1
    s_lshl_b32 s5, s5, 7
    s_add_u32 s4, s4, s5
    s_add_u32 s4, s4, 105054208
    s_and_b32 s5, s70, 3
    s_lshl_b32 s5, s5, 14
    s_add_u32 s4, s4, s5
    s_lshl_b32 s5, s63, 2
    s_add_u32 s5, s5, 159744
    v_mov_b32 v24, 0
    v_mov_b32 v25, s5
    v_bfe_i32 v27, v25, 2, 1
    v_or_b32 v27, 1, v27
    s_mov_b64 exec, 1
    ds_write_b32 v25, v24
    v_mov_b32 v24, 1
    s_add_u32 s5, s63, 1
    s_bitcmp1_b32 s5, 1
    s_cselect_b64 exec, 1, 0
    s_waitcnt vmcnt(0) lgkmcnt(0)
    s_barrier
    buffer_load_dword v26, v1, s[8:11], s4 offen sc1
    s_barrier
    s_cbranch_scc0 L_race_46
    s_waitcnt vmcnt(0)
    ds_write_b32 v25, v24
    v_xor_b32 v25, 12, v25
    s_waitcnt lgkmcnt(0)
    ds_read_b32 v24, v25
    s_waitcnt lgkmcnt(0)
    v_cmpx_eq_u32 vcc, 0, v24
    buffer_atomic_add v27, v15, s[24:27], 0 offen offset:132 sc1
L_race_46:
    s_mov_b64 exec, -1
    s_branch L_vo_back1
L_vo_sw1:
    buffer_load_dword v0, v15, s[24:27], 0 offen offset:132 sc1
    s_waitcnt vmcnt(0)
    v_readfirstlane_b32 s83, v0
    s_nop 0
    s_cmp_gt_i32 s83, 0
    s_cselect_b32 s83, 8192, 0
    s_add_u32 s76, s76, s83
    s_add_u32 s86, s86, s83
    s_add_u32 s3, s3, s83
    s_add_u32 s72, s72, s83
    s_mov_b64 exec, 0xffff
    v_add_u32 v23, s83, v23
    s_mov_b64 exec, -1
    s_branch L_vo_back1
L_vo_last1:
    s_endpgm
L_fix_40:
    s_nop 7
    buffer_load_dwordx4 v[60:63], v1, s[8:11], s87 offen sc1
    buffer_load_dwordx4 v[68:71], v1, s[8:11], s88 offen sc1
    buffer_load_dwordx4 v[76:79], v1, s[8:11], s89 offen sc1
    buffer_load_dwordx4 v[84:87], v1, s[8:11], s90 offen sc1
    buffer_load_dwordx4 v[88:91], v1, s[8:11], s91 offen sc1
    buffer_load_dwordx4 v[92:95], v1, s[8:11], s92 offen sc1
    buffer_load_dwordx4 v[96:99], v1, s[8:11], s93 offen sc1
    buffer_load_dwordx4 v[100:103], v1, s[8:11], s94 offen sc1
    s_waitcnt vmcnt(0)
    v_max3_u32 v0, v60, v68, v76
    v_max3_u32 v0, v0, v84, v88
    v_max3_u32 v0, v0, v92, v96
    v_max_u32 v0, v0, v100
    v_cmp_eq_u32 vcc, -1, v0
    s_cbranch_vccz L_fix_40d
    s_sub_u32 s65, s65, 1
    s_cmp_gt_i32 s65, 0
    s_cbranch_scc1 L_fix_40
    s_endpgm
L_fix_40d:
    v_mov_b32 v6, 0
    s_waitcnt lgkmcnt(0)
    v_mfma_f32_4x4x4_16b_bf16 v[56:59], v[20:21], v[60:61], 0
    v_mfma_f32_4x4x4_16b_bf16 v[60:63], v[20:21], v[62:63], 0
    v_mfma_f32_4x4x4_16b_bf16 v[64:67], v[20:21], v[68:69], 0
    v_mfma_f32_4x4x4_16b_bf16 v[68:71], v[20:21], v[70:71], 0
    v_mfma_f32_4x4x4_16b_bf16 v[72:75], v[20:21], v[76:77], 0
    v_mfma_f32_4x4x4_16b_bf16 v[76:79], v[20:21], v[78:79], 0
    v_mfma_f32_4x4x4_16b_bf16 v[80:83], v[20:21], v[84:85], 0
    v_mfma_f32_4x4x4_16b_bf16 v[84:87], v[20:21], v[86:87], 0
    ds_read_b128 v[104:107], v3 offset:0
    ds_read_b128 v[108:111], v3 offset:1024
    ds_read_b128 v[112:115], v3 offset:32768
    ds_read_b128 v[116:119], v3 offset:33792
    ds_read_b128 v[120:123], v4 offset:0
    ds_read_b128 v[124:127], v4 offset:1024
    ds_read_b128 v[24:27], v4 offset:32768
    ds_read_b128 v[28:31], v4 offset:33792
    ds_read_b128 v[32:35], v3 offset:2048
    ds_read_b128 v[36:39], v3 offset:3072
    v_mov_b32 v40, 0
    v_mov_b32 v41, 0
    v_mov_b32 v42, 0
    v_mov_b32 v43, 0
    v_mov_b32 v44, 0
    v_mov_b32 v45, 0
    v_mov_b32 v46, 0
    v_mov_b32 v47, 0
    v_xor_b32 v5, 4096, v5
    s_branch L_rl_39
L_fix_45:
    s_nop 7
    buffer_load_dwordx4 v[56:59], v1, s[8:11], s87 offen sc1
    buffer_load_dwordx4 v[60:63], v1, s[8:11], s88 offen sc1
    buffer_load_dwordx4 v[64:67], v1, s[8:11], s89 offen sc1
    buffer_load_dwordx4 v[68:71], v1, s[8:11], s90 offen sc1
    buffer_load_dwordx4 v[72:75], v1, s[8:11], s91 offen sc1
    buffer_load_dwordx4 v[76:79], v1, s[8:11], s92 offen sc1
    buffer_load_dwordx4 v[80:83], v1, s[8:11], s93 offen sc1
    buffer_load_dwordx4 v[84:87], v1, s[8:11], s94 offen sc1
    s_waitcnt vmcnt(0)
    v_max3_u32 v0, v56, v60, v64
    v_max3_u32 v0, v0, v68, v72
    v_max3_u32 v0, v0, v76, v80
    v_max_u32 v0, v0, v84
    v_cmp_eq_u32 vcc, -1, v0
    s_cbranch_vccz L_fix_45d
    s_sub_u32 s65, s65, 1
    s_cmp_gt_i32 s65, 0
    s_cbranch_scc1 L_fix_45
    s_endpgm
L_fix_45d:
    v_mov_b32 v40, 0
    v_mov_b32 v41, 0
    v_mov_b32 v42, 0
    v_mov_b32 v43, 0
    v_mov_b32 v44, 0
    v_mov_b32 v45, 0
    v_mov_b32 v46, 0
    v_mov_b32 v47, 0
    v_mov_b32 v48, 0
    v_mov_b32 v49, 0
    v_mov_b32 v50, 0
    v_mov_b32 v51, 0
    v_mov_b32 v52, 0
    v_mov_b32 v53, 0
    v_mov_b32 v54, 0
    v_mov_b32 v55, 0
    v_smfmac_f32_16x16x64_bf16 v[40:43], v[56:59], a[0:7], v2
    v_smfmac_f32_16x16x64_bf16 v[44:47], v[56:59], a[8:15], v2
    v_smfmac_f32_16x16x64_bf16 v[48:51], v[56:59], a[16:23], v2
    v_smfmac_f32_16x16x64_bf16 v[52:55], v[56:59], a[24:31], v2
    v_smfmac_f32_16x16x64_bf16 v[40:43], v[60:63], a[32:39], v2
    v_smfmac_f32_16x16x64_bf16 v[44:47], v[60:63], a[40:47], v2
    v_smfmac_f32_16x16x64_bf16 v[48:51], v[60:63], a[48:55], v2
    v_smfmac_f32_16x16x64_bf16 v[52:55], v[60:63], a[56:63], v2
    v_smfmac_f32_16x16x64_bf16 v[40:43], v[64:67], a[64:71], v2
    v_smfmac_f32_16x16x64_bf16 v[44:47], v[64:67], a[72:79], v2
    v_smfmac_f32_16x16x64_bf16 v[48:51], v[64:67], a[80:87], v2
    v_smfmac_f32_16x16x64_bf16 v[52:55], v[64:67], a[88:95], v2
    v_smfmac_f32_16x16x64_bf16 v[40:43], v[68:71], a[96:103], v2
    v_smfmac_f32_16x16x64_bf16 v[44:47], v[68:71], a[104:111], v2
    v_smfmac_f32_16x16x64_bf16 v[48:51], v[68:71], a[112:119], v2
    v_smfmac_f32_16x16x64_bf16 v[52:55], v[68:71], a[120:127], v2
    v_smfmac_f32_16x16x64_bf16 v[40:43], v[72:75], a[128:135], v2
    v_smfmac_f32_16x16x64_bf16 v[44:47], v[72:75], a[136:143], v2
    v_smfmac_f32_16x16x64_bf16 v[48:51], v[72:75], a[144:151], v2
    v_smfmac_f32_16x16x64_bf16 v[52:55], v[72:75], a[152:159], v2
    v_smfmac_f32_16x16x64_bf16 v[40:43], v[76:79], a[160:167], v2
    v_smfmac_f32_16x16x64_bf16 v[44:47], v[76:79], a[168:175], v2
    v_smfmac_f32_16x16x64_bf16 v[48:51], v[76:79], a[176:183], v2
    v_smfmac_f32_16x16x64_bf16 v[52:55], v[76:79], a[184:191], v2
    v_smfmac_f32_16x16x64_bf16 v[40:43], v[80:83], a[192:199], v2
    v_smfmac_f32_16x16x64_bf16 v[44:47], v[80:83], a[200:207], v2
    v_smfmac_f32_16x16x64_bf16 v[48:51], v[80:83], a[208:215], v2
    v_smfmac_f32_16x16x64_bf16 v[52:55], v[80:83], a[216:223], v2
    v_smfmac_f32_16x16x64_bf16 v[40:43], v[84:87], a[224:231], v2
    v_smfmac_f32_16x16x64_bf16 v[44:47], v[84:87], a[232:239], v2
    v_smfmac_f32_16x16x64_bf16 v[48:51], v[84:87], a[240:247], v2
    v_smfmac_f32_16x16x64_bf16 v[52:55], v[84:87], a[248:255], v2
    v_pk_add_f32 v[40:41], v[40:41], v[42:43]
    s_branch L_ro_44x
L_nonrec:
    s_cmp_ge_u32 s62, 224
    s_cbranch_scc1 L_late
    s_cmp_ge_u32 s62, 216
    s_cbranch_scc1 L_gate
    s_sub_u32 s7, s62, 64
    s_cmp_lt_u32 s7, 96
    s_cbranch_scc0 L_A_setffn
    s_and_b32 s4, s7, 31
    s_lshr_b32 s5, s7, 5
    s_cmp_eq_u32 s5, 1
    s_cselect_b32 s16, s38, s36
    s_cselect_b32 s17, s39, s37
    s_cmp_eq_u32 s5, 2
    s_cselect_b32 s16, s40, s16
    s_cselect_b32 s17, s41, s17
    s_and_b32 s17, s17, 0xffff
    s_add_u32 s66, s5, 1
    s_lshl_b32 s66, s66, 24
    s_lshl_b32 s6, s4, 13
    s_add_u32 s66, s66, s6
    s_lshl_b32 s6, s63, 11
    s_add_u32 s66, s66, s6
    s_lshl_b32 s4, s4, 8
    s_lshr_b32 s5, s63, 1
    s_lshl_b32 s5, s5, 7
    s_add_u32 s4, s4, s5
    s_mov_b32 s5, 8192
    s_branch L_A_common
L_A_setffn:
    s_sub_u32 s4, s7, 96
    s_cmp_lt_u32 s63, 2
    s_cselect_b32 s16, s48, s50
    s_cselect_b32 s17, s49, s51
    s_and_b32 s17, s17, 0xffff
    s_mov_b32 s18, 7340032
    s_lshl_b32 s66, s4, 2
    s_add_u32 s66, s66, s63
    s_lshl_b32 s66, s66, 10
    s_add_u32 s66, s66, 83886080
    s_lshl_b32 s4, s4, 7
    s_mov_b32 s5, 7168
L_A_common:
    v_lshrrev_b32 v2, 3, v0
    v_and_b32 v3, 7, v0
    v_and_b32 v4, 2, v2
    s_and_b32 s6, s63, 2
    s_lshl_b32 s6, s6, 1
    v_or_b32 v4, s6, v4
    v_xor_b32 v3, v3, v4
    v_lshlrev_b32 v3, 4, v3
    s_and_b32 s6, s63, 1
    s_lshl_b32 s6, s6, 6
    v_add_u32 v2, s6, v2
    v_mul_lo_u32 v2, v2, s5
    v_add3_u32 v8, v2, v3, s4
    s_lshl_b32 s68, s5, 3
    s_mov_b32 s69, 0
    s_lshl_b32 s70, s63, 13
    v_lshrrev_b32 v2, 4, v0
    v_and_b32 v3, 1, v2
    v_lshrrev_b32 v4, 5, v0
    v_bfe_u32 v5, v0, 2, 2
    v_lshl_add_u32 v4, v4, 3, v5
    v_lshlrev_b32 v4, 7, v4
    v_lshl_add_u32 v4, v3, 14, v4
    v_lshrrev_b32 v5, 1, v5
    v_lshl_add_u32 v5, v3, 1, v5
    v_xor_b32 v5, s63, v5
    v_lshl_add_u32 v4, v5, 5, v4
    v_and_b32 v5, 3, v0
    v_lshl_add_u32 v9, v5, 3, v4
    v_add_u32 v10, 0x10000, v9
    s_mov_b32 s71, s63
    s_cmp_lt_u32 s62, 160
    s_cbranch_scc1 L_A_now
    s_mov_b32 s71, 1
    s_waitcnt vmcnt(0)
    s_barrier
    s_cmp_lg_u32 s63, 0
    s_cbranch_scc1 L_arr_47
    v_mov_b32 v2, 1
    buffer_atomic_add v2, v15, s[24:27], 0 offen offset:8 sc1
L_arr_47:
    s_mov_b32 s28, s36
    s_and_b32 s29, s37, 0xffff
    s_mov_b32 s30, 8388608
    s_mov_b32 s31, 0x20000
    s_cmp_ge_u32 s62, 208
    s_cbranch_scc1 L_A_nopf
    s_cmp_ge_u32 s62, 192
    s_cselect_b32 s28, s40, s36
    s_cselect_b32 s29, s41, s37
    s_mov_b32 s7, 1048576
    s_cselect_b32 s5, s7, 2097152
    s_cselect_b32 s6, s7, 4288675968
    s_and_b32 s29, s29, 0xffff
    s_and_b32 s4, s62, 31
    s_lshl2_add_u32 s4, s4, s63
    s_lshl_b32 s4, s4, 14
    v_lshlrev_b32 v3, 8, v0
    buffer_load_dword v4, v3, s[28:31], s4 offen
    s_add_u32 s4, s4, s5
    buffer_load_dword v4, v3, s[28:31], s4 offen
    s_add_u32 s4, s4, s5
    buffer_load_dword v4, v3, s[28:31], s4 offen
    s_add_u32 s4, s4, s5
    buffer_load_dword v4, v3, s[28:31], s4 offen
    s_add_u32 s4, s4, s6
    buffer_load_dword v4, v3, s[28:31], s4 offen
    s_add_u32 s4, s4, s5
    buffer_load_dword v4, v3, s[28:31], s4 offen
    s_add_u32 s4, s4, s5
    buffer_load_dword v4, v3, s[28:31], s4 offen
    s_add_u32 s4, s4, s5
    buffer_load_dword v4, v3, s[28:31], s4 offen
    s_add_u32 s4, s4, s5
L_A_nopf:
    s_cmp_lg_u32 s63, 0
    s_cbranch_scc1 L_walld_49
L_wall_48:
    buffer_load_dword v2, v15, s[24:27], 0 offen offset:8 sc1
    s_waitcnt vmcnt(0)
    v_readfirstlane_b32 s4, v2
    s_nop 0
    s_cmp_ge_u32 s4, 256
    s_cbranch_scc1 L_walld_49
    s_sleep 16
    s_sub_u32 s65, s65, 1
    s_cmp_gt_i32 s65, 0
    s_cbranch_scc1 L_wall_48
L_walld_49:
    s_barrier
L_A_now:
    s_add_u32 m0, s70, 0
    s_nop 0
    buffer_load_dwordx4 v8, s[16:19], s69 offen offset:0 lds
    s_add_u32 s69, s69, s68
    s_add_u32 m0, s70, 1024
    s_nop 0
    buffer_load_dwordx4 v8, s[16:19], s69 offen offset:0 lds
    s_add_u32 s69, s69, s68
    s_add_u32 m0, s70, 2048
    s_nop 0
    buffer_load_dwordx4 v8, s[16:19], s69 offen offset:0 lds
    s_add_u32 s69, s69, s68
    s_add_u32 m0, s70, 3072
    s_nop 0
    buffer_load_dwordx4 v8, s[16:19], s69 offen offset:0 lds
    s_add_u32 s69, s69, s68
    s_add_u32 m0, s70, 4096
    s_nop 0
    buffer_load_dwordx4 v8, s[16:19], s69 offen offset:0 lds
    s_add_u32 s69, s69, s68
    s_add_u32 m0, s70, 5120
    s_nop 0
    buffer_load_dwordx4 v8, s[16:19], s69 offen offset:0 lds
    s_add_u32 s69, s69, s68
    s_add_u32 m0, s70, 6144
    s_nop 0
    buffer_load_dwordx4 v8, s[16:19], s69 offen offset:0 lds
    s_add_u32 s69, s69, s68
    s_add_u32 m0, s70, 7168
    s_nop 0
    buffer_load_dwordx4 v8, s[16:19], s69 offen offset:0 lds
    s_add_u32 s69, s69, s68
    s_lshl_b32 s4, s68, 3
    s_add_u32 s69, s69, s4
    s_add_u32 m0, s70, 32768
    s_nop 0
    buffer_load_dwordx4 v8, s[16:19], s69 offen offset:0 lds
    s_add_u32 s69, s69, s68
    s_add_u32 m0, s70, 33792
    s_nop 0
    buffer_load_dwordx4 v8, s[16:19], s69 offen offset:0 lds
    s_add_u32 s69, s69, s68
    s_add_u32 m0, s70, 34816
    s_nop 0
    buffer_load_dwordx4 v8, s[16:19], s69 offen offset:0 lds
    s_add_u32 s69, s69, s68
    s_add_u32 m0, s70, 35840
    s_nop 0
    buffer_load_dwordx4 v8, s[16:19], s69 offen offset:0 lds
    s_add_u32 s69, s69, s68
    s_add_u32 m0, s70, 36864
    s_nop 0
    buffer_load_dwordx4 v8, s[16:19], s69 offen offset:0 lds
    s_add_u32 s69, s69, s68
    s_add_u32 m0, s70, 37888
    s_nop 0
    buffer_load_dwordx4 v8, s[16:19], s69 offen offset:0 lds
    s_add_u32 s69, s69, s68
    s_add_u32 m0, s70, 38912
    s_nop 0
    buffer_load_dwordx4 v8, s[16:19], s69 offen offset:0 lds
    s_add_u32 s69, s69, s68
    s_add_u32 m0, s70, 39936
    s_nop 0
    buffer_load_dwordx4 v8, s[16:19], s69 offen offset:0 lds
    s_add_u32 s69, s69, s68
    s_lshl_b32 s4, s68, 3
    s_add_u32 s69, s69, s4
    s_add_u32 m0, s70, 65536
    s_nop 0
    buffer_load_dwordx4 v8, s[16:19], s69 offen offset:0 lds
    s_add_u32 s69, s69, s68
    s_add_u32 m0, s70, 66560
    s_nop 0
    buffer_load_dwordx4 v8, s[16:19], s69 offen offset:0 lds
    s_add_u32 s69, s69, s68
    s_add_u32 m0, s70, 67584
    s_nop 0
    buffer_load_dwordx4 v8, s[16:19], s69 offen offset:0 lds
    s_add_u32 s69, s69, s68
    s_add_u32 m0, s70, 68608
    s_nop 0
    buffer_load_dwordx4 v8, s[16:19], s69 offen offset:0 lds
    s_add_u32 s69, s69, s68
    s_add_u32 m0, s70, 69632
    s_nop 0
    buffer_load_dwordx4 v8, s[16:19], s69 offen offset:0 lds
    s_add_u32 s69, s69, s68
    s_add_u32 m0, s70, 70656
    s_nop 0
    buffer_load_dwordx4 v8, s[16:19], s69 offen offset:0 lds
    s_add_u32 s69, s69, s68
    s_add_u32 m0, s70, 71680
    s_nop 0
    buffer_load_dwordx4 v8, s[16:19], s69 offen offset:0 lds
    s_add_u32 s69, s69, s68
    s_add_u32 m0, s70, 72704
    s_nop 0
    buffer_load_dwordx4 v8, s[16:19], s69 offen offset:0 lds
    s_add_u32 s69, s69, s68
    s_lshl_b32 s4, s68, 3
    s_add_u32 s69, s69, s4
    s_waitcnt vmcnt(16)
    s_barrier
    s_add_u32 m0, s70, 98304
    s_nop 0
    buffer_load_dwordx4 v8, s[16:19], s69 offen offset:0 lds
    s_add_u32 s69, s69, s68
    s_add_u32 m0, s70, 99328
    s_nop 0
    buffer_load_dwordx4 v8, s[16:19], s69 offen offset:0 lds
    s_add_u32 s69, s69, s68
    s_add_u32 m0, s70, 100352
    s_nop 0
    buffer_load_dwordx4 v8, s[16:19], s69 offen offset:0 lds
    s_add_u32 s69, s69, s68
    s_add_u32 m0, s70, 101376
    s_nop 0
    buffer_load_dwordx4 v8, s[16:19], s69 offen offset:0 lds
    s_add_u32 s69, s69, s68
    s_add_u32 m0, s70, 102400
    s_nop 0
    buffer_load_dwordx4 v8, s[16:19], s69 offen offset:0 lds
    s_add_u32 s69, s69, s68
    s_add_u32 m0, s70, 103424
    s_nop 0
    buffer_load_dwordx4 v8, s[16:19], s69 offen offset:0 lds
    s_add_u32 s69, s69, s68
    s_add_u32 m0, s70, 104448
    s_nop 0
    buffer_load_dwordx4 v8, s[16:19], s69 offen offset:0 lds
    s_add_u32 s69, s69, s68
    s_add_u32 m0, s70, 105472
    s_nop 0
    buffer_load_dwordx4 v8, s[16:19], s69 offen offset:0 lds
    s_add_u32 s69, s69, s68
    s_lshl_b32 s4, s68, 3
    s_add_u32 s69, s69, s4
    ds_read_b64_tr_b16 a[0:1], v9 offset:0
    ds_read_b64_tr_b16 a[2:3], v9 offset:512
    ds_read_b64_tr_b16 a[4:5], v9 offset:2048
    ds_read_b64_tr_b16 a[6:7], v9 offset:2560
    ds_read_b64_tr_b16 a[8:9], v9 offset:4096
    ds_read_b64_tr_b16 a[10:11], v9 offset:4608
    ds_read_b64_tr_b16 a[12:13], v9 offset:6144
    ds_read_b64_tr_b16 a[14:15], v9 offset:6656
    ds_read_b64_tr_b16 a[16:17], v9 offset:8192
    ds_read_b64_tr_b16 a[18:19], v9 offset:8704
    ds_read_b64_tr_b16 a[20:21], v9 offset:10240
    ds_read_b64_tr_b16 a[22:23], v9 offset:10752
    ds_read_b64_tr_b16 a[24:25], v9 offset:12288
    ds_read_b64_tr_b16 a[26:27], v9 offset:12800
    ds_read_b64_tr_b16 a[28:29], v9 offset:14336
    ds_read_b64_tr_b16 a[30:31], v9 offset:14848
    s_waitcnt lgkmcnt(0)
    s_waitcnt vmcnt(16)
    s_barrier
    s_add_u32 m0, s70, 0
    s_nop 0
    buffer_load_dwordx4 v8, s[16:19], s69 offen offset:0 lds
    s_add_u32 s69, s69, s68
    s_add_u32 m0, s70, 1024
    s_nop 0
    buffer_load_dwordx4 v8, s[16:19], s69 offen offset:0 lds
    s_add_u32 s69, s69, s68
    s_add_u32 m0, s70, 2048
    s_nop 0
    buffer_load_dwordx4 v8, s[16:19], s69 offen offset:0 lds
    s_add_u32 s69, s69, s68
    s_add_u32 m0, s70, 3072
    s_nop 0
    buffer_load_dwordx4 v8, s[16:19], s69 offen offset:0 lds
    s_add_u32 s69, s69, s68
    s_add_u32 m0, s70, 4096
    s_nop 0
    buffer_load_dwordx4 v8, s[16:19], s69 offen offset:0 lds
    s_add_u32 s69, s69, s68
    s_add_u32 m0, s70, 5120
    s_nop 0
    buffer_load_dwordx4 v8, s[16:19], s69 offen offset:0 lds
    s_add_u32 s69, s69, s68
    s_add_u32 m0, s70, 6144
    s_nop 0
    buffer_load_dwordx4 v8, s[16:19], s69 offen offset:0 lds
    s_add_u32 s69, s69, s68
    s_add_u32 m0, s70, 7168
    s_nop 0
    buffer_load_dwordx4 v8, s[16:19], s69 offen offset:0 lds
    s_add_u32 s69, s69, s68
    s_lshl_b32 s4, s68, 3
    s_add_u32 s69, s69, s4
    ds_read_b64_tr_b16 a[32:33], v9 offset:32768
    ds_read_b64_tr_b16 a[34:35], v9 offset:33280
    ds_read_b64_tr_b16 a[36:37], v9 offset:34816
    ds_read_b64_tr_b16 a[38:39], v9 offset:35328
    ds_read_b64_tr_b16 a[40:41], v9 offset:36864
    ds_read_b64_tr_b16 a[42:43], v9 offset:37376
    ds_read_b64_tr_b16 a[44:45], v9 offset:38912
    ds_read_b64_tr_b16 a[46:47], v9 offset:39424
    ds_read_b64_tr_b16 a[48:49], v9 offset:40960
    ds_read_b64_tr_b16 a[50:51], v9 offset:41472
    ds_read_b64_tr_b16 a[52:53], v9 offset:43008
    ds_read_b64_tr_b16 a[54:55], v9 offset:43520
    ds_read_b64_tr_b16 a[56:57], v9 offset:45056
    ds_read_b64_tr_b16 a[58:59], v9 offset:45568
    ds_read_b64_tr_b16 a[60:61], v9 offset:47104
    ds_read_b64_tr_b16 a[62:63], v9 offset:47616
    s_waitcnt lgkmcnt(0)
    s_waitcnt vmcnt(16)
    s_barrier
    s_add_u32 m0, s70, 32768
    s_nop 0
    buffer_load_dwordx4 v8, s[16:19], s69 offen offset:0 lds
    s_add_u32 s69, s69, s68
    s_add_u32 m0, s70, 33792
    s_nop 0
    buffer_load_dwordx4 v8, s[16:19], s69 offen offset:0 lds
    s_add_u32 s69, s69, s68
    s_add_u32 m0, s70, 34816
    s_nop 0
    buffer_load_dwordx4 v8, s[16:19], s69 offen offset:0 lds
    s_add_u32 s69, s69, s68
    s_add_u32 m0, s70, 35840
    s_nop 0
    buffer_load_dwordx4 v8, s[16:19], s69 offen offset:0 lds
    s_add_u32 s69, s69, s68
    s_add_u32 m0, s70, 36864
    s_nop 0
    buffer_load_dwordx4 v8, s[16:19], s69 offen offset:0 lds
    s_add_u32 s69, s69, s68
    s_add_u32 m0, s70, 37888
    s_nop 0
    buffer_load_dwordx4 v8, s[16:19], s69 offen offset:0 lds
    s_add_u32 s69, s69, s68
    s_add_u32 m0, s70, 38912
    s_nop 0
    buffer_load_dwordx4 v8, s[16:19], s69 offen offset:0 lds
    s_add_u32 s69, s69, s68
    s_add_u32 m0, s70, 39936
    s_nop 0
    buffer_load_dwordx4 v8, s[16:19], s69 offen offset:0 lds
    s_add_u32 s69, s69, s68
    s_lshl_b32 s4, s68, 3
    s_add_u32 s69, s69, s4
    ds_read_b64_tr_b16 a[64:65], v10 offset:0
    ds_read_b64_tr_b16 a[66:67], v10 offset:512
    ds_read_b64_tr_b16 a[68:69], v10 offset:2048
    ds_read_b64_tr_b16 a[70:71], v10 offset:2560
    ds_read_b64_tr_b16 a[72:73], v10 offset:4096
    ds_read_b64_tr_b16 a[74:75], v10 offset:4608
    ds_read_b64_tr_b16 a[76:77], v10 offset:6144
    ds_read_b64_tr_b16 a[78:79], v10 offset:6656
    ds_read_b64_tr_b16 a[80:81], v10 offset:8192
    ds_read_b64_tr_b16 a[82:83], v10 offset:8704
    ds_read_b64_tr_b16 a[84:85], v10 offset:10240
    ds_read_b64_tr_b16 a[86:87], v10 offset:10752
    ds_read_b64_tr_b16 a[88:89], v10 offset:12288
    ds_read_b64_tr_b16 a[90:91], v10 offset:12800
    ds_read_b64_tr_b16 a[92:93], v10 offset:14336
    ds_read_b64_tr_b16 a[94:95], v10 offset:14848
    s_waitcnt lgkmcnt(0)
    s_waitcnt vmcnt(16)
    s_barrier
    s_cmp_lg_u32 s71, 0
    s_cbranch_scc1 L_arr_50
    v_mov_b32 v2, 1
    buffer_atomic_add v2, v15, s[24:27], 0 offen offset:8 sc1
L_arr_50:
    s_add_u32 m0, s70, 65536
    s_nop 0
    buffer_load_dwordx4 v8, s[16:19], s69 offen offset:0 lds
    s_add_u32 s69, s69, s68
    s_add_u32 m0, s70, 66560
    s_nop 0
    buffer_load_dwordx4 v8, s[16:19], s69 offen offset:0 lds
    s_add_u32 s69, s69, s68
    s_add_u32 m0, s70, 67584
    s_nop 0
    buffer_load_dwordx4 v8, s[16:19], s69 offen offset:0 lds
    s_add_u32 s69, s69, s68
    s_add_u32 m0, s70, 68608
    s_nop 0
    buffer_load_dwordx4 v8, s[16:19], s69 offen offset:0 lds
    s_add_u32 s69, s69, s68
    s_add_u32 m0, s70, 69632
    s_nop 0
    buffer_load_dwordx4 v8, s[16:19], s69 offen offset:0 lds
    s_add_u32 s69, s69, s68
    s_add_u32 m0, s70, 70656
    s_nop 0
    buffer_load_dwordx4 v8, s[16:19], s69 offen offset:0 lds
    s_add_u32 s69, s69, s68
    s_add_u32 m0, s70, 71680
    s_nop 0
    buffer_load_dwordx4 v8, s[16:19], s69 offen offset:0 lds
    s_add_u32 s69, s69, s68
    s_add_u32 m0, s70, 72704
    s_nop 0
    buffer_load_dwordx4 v8, s[16:19], s69 offen offset:0 lds
    s_add_u32 s69, s69, s68
    s_lshl_b32 s4, s68, 3
    s_add_u32 s69, s69, s4
    ds_read_b64_tr_b16 a[96:97], v10 offset:32768
    ds_read_b64_tr_b16 a[98:99], v10 offset:33280
    ds_read_b64_tr_b16 a[100:101], v10 offset:34816
    ds_read_b64_tr_b16 a[102:103], v10 offset:35328
    ds_read_b64_tr_b16 a[104:105], v10 offset:36864
    ds_read_b64_tr_b16 a[106:107], v10 offset:37376
    ds_read_b64_tr_b16 a[108:109], v10 offset:38912
    ds_read_b64_tr_b16 a[110:111], v10 offset:39424
    ds_read_b64_tr_b16 a[112:113], v10 offset:40960
    ds_read_b64_tr_b16 a[114:115], v10 offset:41472
    ds_read_b64_tr_b16 a[116:117], v10 offset:43008
    ds_read_b64_tr_b16 a[118:119], v10 offset:43520
    ds_read_b64_tr_b16 a[120:121], v10 offset:45056
    ds_read_b64_tr_b16 a[122:123], v10 offset:45568
    ds_read_b64_tr_b16 a[124:125], v10 offset:47104
    ds_read_b64_tr_b16 a[126:127], v10 offset:47616
    s_waitcnt lgkmcnt(0)
    s_waitcnt vmcnt(16)
    s_barrier
    s_add_u32 m0, s70, 98304
    s_nop 0
    buffer_load_dwordx4 v8, s[16:19], s69 offen offset:0 lds
    s_add_u32 s69, s69, s68
    s_add_u32 m0, s70, 99328
    s_nop 0
    buffer_load_dwordx4 v8, s[16:19], s69 offen offset:0 lds
    s_add_u32 s69, s69, s68
    s_add_u32 m0, s70, 100352
    s_nop 0
    buffer_load_dwordx4 v8, s[16:19], s69 offen offset:0 lds
    s_add_u32 s69, s69, s68
    s_add_u32 m0, s70, 101376
    s_nop 0
    buffer_load_dwordx4 v8, s[16:19], s69 offen offset:0 lds
    s_add_u32 s69, s69, s68
    s_add_u32 m0, s70, 102400
    s_nop 0
    buffer_load_dwordx4 v8, s[16:19], s69 offen offset:0 lds
    s_add_u32 s69, s69, s68
    s_add_u32 m0, s70, 103424
    s_nop 0
    buffer_load_dwordx4 v8, s[16:19], s69 offen offset:0 lds
    s_add_u32 s69, s69, s68
    s_add_u32 m0, s70, 104448
    s_nop 0
    buffer_load_dwordx4 v8, s[16:19], s69 offen offset:0 lds
    s_add_u32 s69, s69, s68
    s_add_u32 m0, s70, 105472
    s_nop 0
    buffer_load_dwordx4 v8, s[16:19], s69 offen offset:0 lds
    s_add_u32 s69, s69, s68
    s_lshl_b32 s4, s68, 3
    s_add_u32 s69, s69, s4
    ds_read_b64_tr_b16 a[128:129], v9 offset:0
    ds_read_b64_tr_b16 a[130:131], v9 offset:512
    ds_read_b64_tr_b16 a[132:133], v9 offset:2048
    ds_read_b64_tr_b16 a[134:135], v9 offset:2560
    ds_read_b64_tr_b16 a[136:137], v9 offset:4096
    ds_read_b64_tr_b16 a[138:139], v9 offset:4608
    ds_read_b64_tr_b16 a[140:141], v9 offset:6144
    ds_read_b64_tr_b16 a[142:143], v9 offset:6656
    ds_read_b64_tr_b16 a[144:145], v9 offset:8192
    ds_read_b64_tr_b16 a[146:147], v9 offset:8704
    ds_read_b64_tr_b16 a[148:149], v9 offset:10240
    ds_read_b64_tr_b16 a[150:151], v9 offset:10752
    ds_read_b64_tr_b16 a[152:153], v9 offset:12288
    ds_read_b64_tr_b16 a[154:155], v9 offset:12800
    ds_read_b64_tr_b16 a[156:157], v9 offset:14336
    ds_read_b64_tr_b16 a[158:159], v9 offset:14848
    s_waitcnt lgkmcnt(0)
    s_waitcnt vmcnt(16)
    s_barrier
    ds_read_b64_tr_b16 a[160:161], v9 offset:32768
    ds_read_b64_tr_b16 a[162:163], v9 offset:33280
    ds_read_b64_tr_b16 a[164:165], v9 offset:34816
    ds_read_b64_tr_b16 a[166:167], v9 offset:35328
    ds_read_b64_tr_b16 a[168:169], v9 offset:36864
    ds_read_b64_tr_b16 a[170:171], v9 offset:37376
    ds_read_b64_tr_b16 a[172:173], v9 offset:38912
    ds_read_b64_tr_b16 a[174:175], v9 offset:39424
    ds_read_b64_tr_b16 a[176:177], v9 offset:40960
    ds_read_b64_tr_b16 a[178:179], v9 offset:41472
    ds_read_b64_tr_b16 a[180:181], v9 offset:43008
    ds_read_b64_tr_b16 a[182:183], v9 offset:43520
    ds_read_b64_tr_b16 a[184:185], v9 offset:45056
    ds_read_b64_tr_b16 a[186:187], v9 offset:45568
    ds_read_b64_tr_b16 a[188:189], v9 offset:47104
    ds_read_b64_tr_b16 a[190:191], v9 offset:47616
    s_waitcnt lgkmcnt(0)
    s_waitcnt vmcnt(8)
    s_barrier
    ds_read_b64_tr_b16 a[192:193], v10 offset:0
    ds_read_b64_tr_b16 a[194:195], v10 offset:512
    ds_read_b64_tr_b16 a[196:197], v10 offset:2048
    ds_read_b64_tr_b16 a[198:199], v10 offset:2560
    ds_read_b64_tr_b16 a[200:201], v10 offset:4096
    ds_read_b64_tr_b16 a[202:203], v10 offset:4608
    ds_read_b64_tr_b16 a[204:205], v10 offset:6144
    ds_read_b64_tr_b16 a[206:207], v10 offset:6656
    ds_read_b64_tr_b16 a[208:209], v10 offset:8192
    ds_read_b64_tr_b16 a[210:211], v10 offset:8704
    ds_read_b64_tr_b16 a[212:213], v10 offset:10240
    ds_read_b64_tr_b16 a[214:215], v10 offset:10752
    ds_read_b64_tr_b16 a[216:217], v10 offset:12288
    ds_read_b64_tr_b16 a[218:219], v10 offset:12800
    ds_read_b64_tr_b16 a[220:221], v10 offset:14336
    ds_read_b64_tr_b16 a[222:223], v10 offset:14848
    s_waitcnt lgkmcnt(0)
    s_waitcnt vmcnt(0)
    s_barrier
    ds_read_b64_tr_b16 a[224:225], v10 offset:32768
    ds_read_b64_tr_b16 a[226:227], v10 offset:33280
    ds_read_b64_tr_b16 a[228:229], v10 offset:34816
    ds_read_b64_tr_b16 a[230:231], v10 offset:35328
    ds_read_b64_tr_b16 a[232:233], v10 offset:36864
    ds_read_b64_tr_b16 a[234:235], v10 offset:37376
    ds_read_b64_tr_b16 a[236:237], v10 offset:38912
    ds_read_b64_tr_b16 a[238:239], v10 offset:39424
    ds_read_b64_tr_b16 a[240:241], v10 offset:40960
    ds_read_b64_tr_b16 a[242:243], v10 offset:41472
    ds_read_b64_tr_b16 a[244:245], v10 offset:43008
    ds_read_b64_tr_b16 a[246:247], v10 offset:43520
    ds_read_b64_tr_b16 a[248:249], v10 offset:45056
    ds_read_b64_tr_b16 a[250:251], v10 offset:45568
    ds_read_b64_tr_b16 a[252:253], v10 offset:47104
    ds_read_b64_tr_b16 a[254:255], v10 offset:47616
    s_waitcnt lgkmcnt(0)
    s_barrier
    v_lshrrev_b32 v2, 3, v0
    s_lshl_b32 s4, s63, 3
    v_add_u32 v2, s4, v2
    v_bfe_u32 v3, v2, 1, 3
    v_and_b32 v4, 7, v0
    v_xor_b32 v3, v3, v4
    v_lshlrev_b32 v3, 4, v3
    v_lshl_add_u32 v8, v2, 11, v3
    v_and_b32 v2, 31, v0
    v_bfe_u32 v3, v2, 1, 3
    v_lshrrev_b32 v4, 5, v0
    v_xor_b32 v3, v3, v4
    v_lshlrev_b32 v2, 7, v2
    v_xor_b32 v4, 0, v3
    v_lshl_add_u32 v9, v4, 4, v2
    v_xor_b32 v4, 2, v3
    v_lshl_add_u32 v10, v4, 4, v2
    v_xor_b32 v4, 4, v3
    v_lshl_add_u32 v11, v4, 4, v2
    v_xor_b32 v4, 6, v3
    v_lshl_add_u32 v12, v4, 4, v2
    v_bfe_u32 v2, v0, 4, 1
    v_and_b32 v3, 15, v0
    v_lshrrev_b32 v4, 5, v0
    v_lshl_add_u32 v3, v4, 4, v3
    v_lshlrev_b32 v3, 4, v3
    v_lshl_add_u32 v13, v2, 10, v3
    s_lshl_b32 s70, s63, 10
    s_mov_b32 s68, 0
    s_mov_b32 s69, 0
    s_lshl_b32 s67, s62, 7
    s_lshl_b32 s4, s63, 2
    s_add_u32 s67, s67, s4
    s_add_u32 s67, s67, 104923136
    s_cmp_lt_u32 s62, 128
    s_cbranch_scc1 L_A_qk_pre
    s_cmp_lt_u32 s62, 160
    s_cbranch_scc1 L_A_v_pre
L_A_ffn_pre:
    v_mov_b32 v104, 0xc0135761
    s_mov_b32 s74, 0xbdd2d3e8
    v_mov_b32 v14, 268435456
    s_sub_u32 s66, s66, 229376
    v_mov_b32 v32, 0
    v_mov_b32 v33, 0
    v_mov_b32 v34, 0
    v_mov_b32 v35, 0
    v_mov_b32 v36, 0
    v_mov_b32 v37, 0
    v_mov_b32 v38, 0
    v_mov_b32 v39, 0
    v_mov_b32 v40, 0
    v_mov_b32 v41, 0
    v_mov_b32 v42, 0
    v_mov_b32 v43, 0
    v_mov_b32 v44, 0
    v_mov_b32 v45, 0
    v_mov_b32 v46, 0
    v_mov_b32 v47, 0
    s_add_u32 m0, s70, 0
    s_nop 0
    buffer_load_dwordx4 v8, s[12:15], s68 offen offset:0 lds
    s_add_u32 m0, s70, 3968
    s_nop 0
    buffer_load_dwordx4 v8, s[12:15], s68 offen offset:128 lds
    s_add_u32 m0, s70, 7936
    s_nop 0
    buffer_load_dwordx4 v8, s[12:15], s68 offen offset:256 lds
    s_add_u32 m0, s70, 11904
    s_nop 0
    buffer_load_dwordx4 v8, s[12:15], s68 offen offset:384 lds
    s_add_u32 m0, s70, 15872
    s_nop 0
    buffer_load_dwordx4 v8, s[12:15], s68 offen offset:512 lds
    s_add_u32 m0, s70, 19840
    s_nop 0
    buffer_load_dwordx4 v8, s[12:15], s68 offen offset:640 lds
    s_add_u32 m0, s70, 23808
    s_nop 0
    buffer_load_dwordx4 v8, s[12:15], s68 offen offset:768 lds
    s_add_u32 m0, s70, 27776
    s_nop 0
    buffer_load_dwordx4 v8, s[12:15], s68 offen offset:896 lds
    s_add_u32 s68, s68, 1024
    s_add_u32 s70, s70, 32768
    s_cmp_ge_u32 s70, 163840
    s_cselect_b32 s4, 163840, 0
    s_sub_u32 s70, s70, s4
    s_add_u32 m0, s70, 0
    s_nop 0
    buffer_load_dwordx4 v8, s[12:15], s68 offen offset:0 lds
    s_add_u32 m0, s70, 3968
    s_nop 0
    buffer_load_dwordx4 v8, s[12:15], s68 offen offset:128 lds
    s_add_u32 m0, s70, 7936
    s_nop 0
    buffer_load_dwordx4 v8, s[12:15], s68 offen offset:256 lds
    s_add_u32 m0, s70, 11904
    s_nop 0
    buffer_load_dwordx4 v8, s[12:15], s68 offen offset:384 lds
    s_add_u32 m0, s70, 15872
    s_nop 0
    buffer_load_dwordx4 v8, s[12:15], s68 offen offset:512 lds
    s_add_u32 m0, s70, 19840
    s_nop 0
    buffer_load_dwordx4 v8, s[12:15], s68 offen offset:640 lds
    s_add_u32 m0, s70, 23808
    s_nop 0
    buffer_load_dwordx4 v8, s[12:15], s68 offen offset:768 lds
    s_add_u32 m0, s70, 27776
    s_nop 0
    buffer_load_dwordx4 v8, s[12:15], s68 offen offset:896 lds
    s_add_u32 s68, s68, 64512
    s_add_u32 s70, s70, 32768
    s_cmp_ge_u32 s70, 163840
    s_cselect_b32 s4, 163840, 0
    s_sub_u32 s70, s70, s4
    s_add_u32 m0, s70, 0
    s_nop 0
    buffer_load_dwordx4 v8, s[12:15], s68 offen offset:0 lds
    s_add_u32 m0, s70, 3968
    s_nop 0
    buffer_load_dwordx4 v8, s[12:15], s68 offen offset:128 lds
    s_add_u32 m0, s70, 7936
    s_nop 0
    buffer_load_dwordx4 v8, s[12:15], s68 offen offset:256 lds
    s_add_u32 m0, s70, 11904
    s_nop 0
    buffer_load_dwordx4 v8, s[12:15], s68 offen offset:384 lds
    s_add_u32 m0, s70, 15872
    s_nop 0
    buffer_load_dwordx4 v8, s[12:15], s68 offen offset:512 lds
    s_add_u32 m0, s70, 19840
    s_nop 0
    buffer_load_dwordx4 v8, s[12:15], s68 offen offset:640 lds
    s_add_u32 m0, s70, 23808
    s_nop 0
    buffer_load_dwordx4 v8, s[12:15], s68 offen offset:768 lds
    s_add_u32 m0, s70, 27776
    s_nop 0
    buffer_load_dwordx4 v8, s[12:15], s68 offen offset:896 lds
    s_add_u32 s68, s68, 1024
    s_add_u32 s70, s70, 32768
    s_cmp_ge_u32 s70, 163840
    s_cselect_b32 s4, 163840, 0
    s_sub_u32 s70, s70, s4
    s_waitcnt vmcnt(16)
    s_barrier
    v_add_u32 v4, s69, v9
    v_add_u32 v5, s69, v10
    v_add_u32 v6, s69, v11
    v_add_u32 v7, s69, v12
    s_add_u32 s69, s69, 32768
    s_cmp_ge_u32 s69, 163840
    s_cselect_b32 s69, 0, s69
    ds_read_b128 v[48:51], v4 offset:0
    ds_read_b128 v[52:55], v5 offset:0
    ds_read_b128 v[56:59], v6 offset:0
    ds_read_b128 v[60:63], v7 offset:0
    ds_read_b128 v[64:67], v4 offset:4096
    ds_read_b128 v[68:71], v5 offset:4096
    ds_read_b128 v[72:75], v6 offset:4096
    s_mov_b32 s71, 0
    s_mov_b32 s72, 0
L_A_ffn:
    s_waitcnt lgkmcnt(5)
    v_mfma_f32_32x32x16_bf16 v[16:31], a[0:3], v[48:51], 0
    ds_read_b128 v[76:79], v7 offset:4096
    s_add_u32 m0, s70, 0
    s_nop 0
    buffer_load_dwordx4 v8, s[12:15], s68 offen offset:0 lds
    v_mfma_f32_32x32x16_bf16 v[16:31], a[4:7], v[52:55], v[16:31]
    ds_read_b128 v[48:51], v4 offset:8192
    s_waitcnt lgkmcnt(5)
    v_mfma_f32_32x32x16_bf16 v[16:31], a[8:11], v[56:59], v[16:31]
    ds_read_b128 v[52:55], v5 offset:8192
    s_add_u32 m0, s70, 3968
    s_nop 0
    buffer_load_dwordx4 v8, s[12:15], s68 offen offset:128 lds
    v_mfma_f32_32x32x16_bf16 v[16:31], a[12:15], v[60:63], v[16:31]
    ds_read_b128 v[56:59], v6 offset:8192
    v_mul_f32 v88, v32, v32
    v_mul_f32 v89, v33, v33
    s_waitcnt lgkmcnt(5)
    v_mfma_f32_32x32x16_bf16 v[16:31], a[16:19], v[64:67], v[16:31]
    ds_read_b128 v[60:63], v7 offset:8192
    s_add_u32 m0, s70, 7936
    s_nop 0
    buffer_load_dwordx4 v8, s[12:15], s68 offen offset:256 lds
    v_mul_f32 v90, v34, v34
    v_mfma_f32_32x32x16_bf16 v[16:31], a[20:23], v[68:71], v[16:31]
    ds_read_b128 v[64:67], v4 offset:12288
    v_mul_f32 v91, v35, v35
    v_mul_f32 v92, v36, v36
    s_waitcnt lgkmcnt(5)
    v_mfma_f32_32x32x16_bf16 v[16:31], a[24:27], v[72:75], v[16:31]
    ds_read_b128 v[68:71], v5 offset:12288
    s_add_u32 m0, s70, 11904
    s_nop 0
    buffer_load_dwordx4 v8, s[12:15], s68 offen offset:384 lds
    v_mul_f32 v93, v37, v37
    v_mfma_f32_32x32x16_bf16 v[16:31], a[28:31], v[76:79], v[16:31]
    ds_read_b128 v[72:75], v6 offset:12288
    v_mul_f32 v94, v38, v38
    v_mul_f32 v95, v39, v39
    s_waitcnt lgkmcnt(5)
    v_mfma_f32_32x32x16_bf16 v[16:31], a[32:35], v[48:51], v[16:31]
    ds_read_b128 v[76:79], v7 offset:12288
    s_add_u32 m0, s70, 15872
    s_nop 0
    buffer_load_dwordx4 v8, s[12:15], s68 offen offset:512 lds
    v_fma_f32 v88, v88, s74, v104
    v_mfma_f32_32x32x16_bf16 v[16:31], a[36:39], v[52:55], v[16:31]
    ds_read_b128 v[48:51], v4 offset:16384
    v_fma_f32 v89, v89, s74, v104
    v_fma_f32 v90, v90, s74, v104
    s_waitcnt lgkmcnt(5)
    v_mfma_f32_32x32x16_bf16 v[16:31], a[40:43], v[56:59], v[16:31]
    ds_read_b128 v[52:55], v5 offset:16384
    s_add_u32 m0, s70, 19840
    s_nop 0
    buffer_load_dwordx4 v8, s[12:15], s68 offen offset:640 lds
    v_fma_f32 v91, v91, s74, v104
    v_mfma_f32_32x32x16_bf16 v[16:31], a[44:47], v[60:63], v[16:31]
    ds_read_b128 v[56:59], v6 offset:16384
    v_fma_f32 v92, v92, s74, v104
    v_fma_f32 v93, v93, s74, v104
    s_waitcnt lgkmcnt(5)
    v_mfma_f32_32x32x16_bf16 v[16:31], a[48:51], v[64:67], v[16:31]
    ds_read_b128 v[60:63], v7 offset:16384
    s_add_u32 m0, s70, 23808
    s_nop 0
    buffer_load_dwordx4 v8, s[12:15], s68 offen offset:768 lds
    v_fma_f32 v94, v94, s74, v104
    v_mfma_f32_32x32x16_bf16 v[16:31], a[52:55], v[68:71], v[16:31]
    ds_read_b128 v[64:67], v4 offset:20480
    v_fma_f32 v95, v95, s74, v104
    v_mul_f32 v88, v88, v32
    s_waitcnt lgkmcnt(5)
    v_mfma_f32_32x32x16_bf16 v[16:31], a[56:59], v[72:75], v[16:31]
    ds_read_b128 v[68:71], v5 offset:20480
    s_add_u32 m0, s70, 27776
    s_nop 0
    buffer_load_dwordx4 v8, s[12:15], s68 offen offset:896 lds
    v_mul_f32 v89, v89, v33
    v_mfma_f32_32x32x16_bf16 v[16:31], a[60:63], v[76:79], v[16:31]
    ds_read_b128 v[72:75], v6 offset:20480
    v_mul_f32 v90, v90, v34
    v_mul_f32 v91, v91, v35
    s_waitcnt lgkmcnt(5)
    v_mfma_f32_32x32x16_bf16 v[16:31], a[64:67], v[48:51], v[16:31]
    ds_read_b128 v[76:79], v7 offset:20480
    s_add_u32 s68, s68, 64512
    s_add_u32 s70, s70, 32768
    v_mul_f32 v92, v92, v36
    v_mfma_f32_32x32x16_bf16 v[16:31], a[68:71], v[52:55], v[16:31]
    ds_read_b128 v[48:51], v4 offset:24576
    v_mul_f32 v93, v93, v37
    v_mul_f32 v94, v94, v38
    s_waitcnt lgkmcnt(5)
    v_mfma_f32_32x32x16_bf16 v[16:31], a[72:75], v[56:59], v[16:31]
    ds_read_b128 v[52:55], v5 offset:24576
    s_cmp_ge_u32 s70, 163840
    s_cselect_b32 s4, 163840, 0
    s_sub_u32 s70, s70, s4
    v_mul_f32 v95, v95, v39
    v_mfma_f32_32x32x16_bf16 v[16:31], a[76:79], v[60:63], v[16:31]
    ds_read_b128 v[56:59], v6 offset:24576
    v_exp_f32 v88, v88
    v_mul_f32 v96, v32, v40
    s_waitcnt lgkmcnt(5)
    v_mfma_f32_32x32x16_bf16 v[16:31], a[80:83], v[64:67], v[16:31]
    ds_read_b128 v[60:63], v7 offset:24576
    v_exp_f32 v89, v89
    v_mul_f32 v97, v33, v41
    v_mfma_f32_32x32x16_bf16 v[16:31], a[84:87], v[68:71], v[16:31]
    ds_read_b128 v[64:67], v4 offset:28672
    v_exp_f32 v90, v90
    v_mul_f32 v98, v34, v42
    s_waitcnt lgkmcnt(5)
    v_mfma_f32_32x32x16_bf16 v[16:31], a[88:91], v[72:75], v[16:31]
    ds_read_b128 v[68:71], v5 offset:28672
    v_exp_f32 v91, v91
    v_mul_f32 v99, v35, v43
    v_mfma_f32_32x32x16_bf16 v[16:31], a[92:95], v[76:79], v[16:31]
    ds_read_b128 v[72:75], v6 offset:28672
    v_exp_f32 v92, v92
    v_mul_f32 v100, v36, v44
    s_waitcnt lgkmcnt(5)
    v_mfma_f32_32x32x16_bf16 v[16:31], a[96:99], v[48:51], v[16:31]
    ds_read_b128 v[76:79], v7 offset:28672
    v_exp_f32 v93, v93
    v_mul_f32 v101, v37, v45
    v_mfma_f32_32x32x16_bf16 v[16:31], a[100:103], v[52:55], v[16:31]
    s_waitcnt vmcnt(16)
    s_barrier
    v_add_u32 v4, s69, v9
    v_add_u32 v5, s69, v10
    v_add_u32 v6, s69, v11
    v_add_u32 v7, s69, v12
    s_add_u32 s69, s69, 32768
    s_cmp_ge_u32 s69, 163840
    s_cselect_b32 s69, 0, s69
    ds_read_b128 v[48:51], v4 offset:0
    v_exp_f32 v94, v94
    v_mul_f32 v102, v38, v46
    s_waitcnt lgkmcnt(5)
    v_mfma_f32_32x32x16_bf16 v[16:31], a[104:107], v[56:59], v[16:31]
    ds_read_b128 v[52:55], v5 offset:0
    v_exp_f32 v95, v95
    v_mul_f32 v103, v39, v47
    v_mfma_f32_32x32x16_bf16 v[16:31], a[108:111], v[60:63], v[16:31]
    ds_read_b128 v[56:59], v6 offset:0
    v_add_f32 v88, 1.0, v88
    v_add_f32 v89, 1.0, v89
    s_waitcnt lgkmcnt(5)
    v_mfma_f32_32x32x16_bf16 v[16:31], a[112:115], v[64:67], v[16:31]
    ds_read_b128 v[60:63], v7 offset:0
    v_add_f32 v90, 1.0, v90
    v_add_f32 v91, 1.0, v91
    v_mfma_f32_32x32x16_bf16 v[16:31], a[116:119], v[68:71], v[16:31]
    ds_read_b128 v[64:67], v4 offset:4096
    v_add_f32 v92, 1.0, v92
    v_add_f32 v93, 1.0, v93
    s_waitcnt lgkmcnt(5)
    v_mfma_f32_32x32x16_bf16 v[16:31], a[120:123], v[72:75], v[16:31]
    ds_read_b128 v[68:71], v5 offset:4096
    v_add_f32 v94, 1.0, v94
    v_add_f32 v95, 1.0, v95
    v_mfma_f32_32x32x16_bf16 v[16:31], a[124:127], v[76:79], v[16:31]
    ds_read_b128 v[72:75], v6 offset:4096
    v_rcp_f32 v88, v88
    v_rcp_f32 v89, v89
    s_waitcnt lgkmcnt(5)
    v_mfma_f32_32x32x16_bf16 v[16:31], a[128:131], v[48:51], v[16:31]
    ds_read_b128 v[76:79], v7 offset:4096
    s_add_u32 m0, s70, 0
    s_nop 0
    buffer_load_dwordx4 v8, s[12:15], s68 offen offset:0 lds
    v_mul_f32 v96, v96, v88
    v_mfma_f32_32x32x16_bf16 v[16:31], a[132:135], v[52:55], v[16:31]
    ds_read_b128 v[48:51], v4 offset:8192
    v_rcp_f32 v90, v90
    v_mul_f32 v97, v97, v89
    s_waitcnt lgkmcnt(5)
    v_mfma_f32_32x32x16_bf16 v[16:31], a[136:139], v[56:59], v[16:31]
    ds_read_b128 v[52:55], v5 offset:8192
    s_add_u32 m0, s70, 3968
    s_nop 0
    buffer_load_dwordx4 v8, s[12:15], s68 offen offset:128 lds
    v_rcp_f32 v91, v91
    v_mfma_f32_32x32x16_bf16 v[16:31], a[140:143], v[60:63], v[16:31]
    ds_read_b128 v[56:59], v6 offset:8192
    v_mul_f32 v98, v98, v90
    v_rcp_f32 v92, v92
    s_waitcnt lgkmcnt(5)
    v_mfma_f32_32x32x16_bf16 v[16:31], a[144:147], v[64:67], v[16:31]
    ds_read_b128 v[60:63], v7 offset:8192
    s_add_u32 m0, s70, 7936
    s_nop 0
    buffer_load_dwordx4 v8, s[12:15], s68 offen offset:256 lds
    v_mul_f32 v99, v99, v91
    v_mfma_f32_32x32x16_bf16 v[16:31], a[148:151], v[68:71], v[16:31]
    ds_read_b128 v[64:67], v4 offset:12288
    v_rcp_f32 v93, v93
    v_mul_f32 v100, v100, v92
    s_waitcnt lgkmcnt(5)
    v_mfma_f32_32x32x16_bf16 v[16:31], a[152:155], v[72:75], v[16:31]
    ds_read_b128 v[68:71], v5 offset:12288
    s_add_u32 m0, s70, 11904
    s_nop 0
    buffer_load_dwordx4 v8, s[12:15], s68 offen offset:384 lds
    v_rcp_f32 v94, v94
    v_mfma_f32_32x32x16_bf16 v[16:31], a[156:159], v[76:79], v[16:31]
    ds_read_b128 v[72:75], v6 offset:12288
    v_mul_f32 v101, v101, v93
    v_rcp_f32 v95, v95
    s_waitcnt lgkmcnt(5)
    v_mfma_f32_32x32x16_bf16 v[16:31], a[160:163], v[48:51], v[16:31]
    ds_read_b128 v[76:79], v7 offset:12288
    s_add_u32 m0, s70, 15872
    s_nop 0
    buffer_load_dwordx4 v8, s[12:15], s68 offen offset:512 lds
    v_mul_f32 v102, v102, v94
    v_mfma_f32_32x32x16_bf16 v[16:31], a[164:167], v[52:55], v[16:31]
    ds_read_b128 v[48:51], v4 offset:16384
    v_cvt_pk_bf16_f32 v80, v96, v97
    v_mul_f32 v103, v103, v95
    s_waitcnt lgkmcnt(5)
    v_mfma_f32_32x32x16_bf16 v[16:31], a[168:171], v[56:59], v[16:31]
    ds_read_b128 v[52:55], v5 offset:16384
    s_add_u32 m0, s70, 19840
    s_nop 0
    buffer_load_dwordx4 v8, s[12:15], s68 offen offset:640 lds
    v_cvt_pk_bf16_f32 v81, v98, v99
    v_mfma_f32_32x32x16_bf16 v[16:31], a[172:175], v[60:63], v[16:31]
    ds_read_b128 v[56:59], v6 offset:16384
    v_cvt_pk_bf16_f32 v82, v100, v101
    v_cvt_pk_bf16_f32 v83, v102, v103
    s_waitcnt lgkmcnt(5)
    v_mfma_f32_32x32x16_bf16 v[16:31], a[176:179], v[64:67], v[16:31]
    ds_read_b128 v[60:63], v7 offset:16384
    s_add_u32 m0, s70, 23808
    s_nop 0
    buffer_load_dwordx4 v8, s[12:15], s68 offen offset:768 lds
    buffer_store_dwordx4 v[80:83], v14, s[8:11], s66 offen sc1
    v_mfma_f32_32x32x16_bf16 v[16:31], a[180:183], v[68:71], v[16:31]
    ds_read_b128 v[64:67], v4 offset:20480
    v_mov_b32 v14, v1
    s_add_u32 s66, s66, 229376
    s_waitcnt lgkmcnt(5)
    v_mfma_f32_32x32x16_bf16 v[16:31], a[184:187], v[72:75], v[16:31]
    ds_read_b128 v[68:71], v5 offset:20480
    s_add_u32 m0, s70, 27776
    s_nop 0
    buffer_load_dwordx4 v8, s[12:15], s68 offen offset:896 lds
    v_mfma_f32_32x32x16_bf16 v[16:31], a[188:191], v[76:79], v[16:31]
    ds_read_b128 v[72:75], v6 offset:20480
    s_waitcnt lgkmcnt(5)
    v_mfma_f32_32x32x16_bf16 v[16:31], a[192:195], v[48:51], v[16:31]
    ds_read_b128 v[76:79], v7 offset:20480
    s_add_u32 s68, s68, 1024
    s_add_u32 s70, s70, 32768
    v_mfma_f32_32x32x16_bf16 v[16:31], a[196:199], v[52:55], v[16:31]
    ds_read_b128 v[48:51], v4 offset:24576
    s_waitcnt lgkmcnt(5)
    v_mfma_f32_32x32x16_bf16 v[16:31], a[200:203], v[56:59], v[16:31]
    ds_read_b128 v[52:55], v5 offset:24576
    s_cmp_ge_u32 s70, 163840
    s_cselect_b32 s4, 163840, 0
    s_sub_u32 s70, s70, s4
    v_mfma_f32_32x32x16_bf16 v[16:31], a[204:207], v[60:63], v[16:31]
    ds_read_b128 v[56:59], v6 offset:24576
    s_waitcnt lgkmcnt(5)
    v_mfma_f32_32x32x16_bf16 v[16:31], a[208:211], v[64:67], v[16:31]
    ds_read_b128 v[60:63], v7 offset:24576
    v_mfma_f32_32x32x16_bf16 v[16:31], a[212:215], v[68:71], v[16:31]
    ds_read_b128 v[64:67], v4 offset:28672
    s_waitcnt lgkmcnt(5)
    v_mfma_f32_32x32x16_bf16 v[16:31], a[216:219], v[72:75], v[16:31]
    ds_read_b128 v[68:71], v5 offset:28672
    v_mfma_f32_32x32x16_bf16 v[16:31], a[220:223], v[76:79], v[16:31]
    ds_read_b128 v[72:75], v6 offset:28672
    s_waitcnt lgkmcnt(5)
    v_mfma_f32_32x32x16_bf16 v[16:31], a[224:227], v[48:51], v[16:31]
    ds_read_b128 v[76:79], v7 offset:28672
    v_mfma_f32_32x32x16_bf16 v[16:31], a[228:231], v[52:55], v[16:31]
    s_waitcnt vmcnt(16)
    s_barrier
    v_add_u32 v4, s69, v9
    v_add_u32 v5, s69, v10
    v_add_u32 v6, s69, v11
    v_add_u32 v7, s69, v12
    s_add_u32 s69, s69, 32768
    s_cmp_ge_u32 s69, 163840
    s_cselect_b32 s69, 0, s69
    ds_read_b128 v[48:51], v4 offset:0
    s_waitcnt lgkmcnt(5)
    v_mfma_f32_32x32x16_bf16 v[16:31], a[232:235], v[56:59], v[16:31]
    ds_read_b128 v[52:55], v5 offset:0
    v_mfma_f32_32x32x16_bf16 v[16:31], a[236:239], v[60:63], v[16:31]
    ds_read_b128 v[56:59], v6 offset:0
    s_waitcnt lgkmcnt(5)
    v_mfma_f32_32x32x16_bf16 v[16:31], a[240:243], v[64:67], v[16:31]
    ds_read_b128 v[60:63], v7 offset:0
    v_mfma_f32_32x32x16_bf16 v[16:31], a[244:247], v[68:71], v[16:31]
    ds_read_b128 v[64:67], v4 offset:4096
    s_waitcnt lgkmcnt(5)
    v_mfma_f32_32x32x16_bf16 v[16:31], a[248:251], v[72:75], v[16:31]
    ds_read_b128 v[68:71], v5 offset:4096
    v_mov_b32 v2, s72
    buffer_store_dword v2, v15, s[8:11], s67 offen sc1
    v_mfma_f32_32x32x16_bf16 v[16:31], a[252:255], v[76:79], v[16:31]
    ds_read_b128 v[72:75], v6 offset:4096
    s_add_u32 s72, s71, 0
    s_waitcnt lgkmcnt(5)
    v_mfma_f32_32x32x16_bf16 v[32:47], a[0:3], v[48:51], 0
    ds_read_b128 v[76:79], v7 offset:4096
    s_add_u32 m0, s70, 0
    s_nop 0
    buffer_load_dwordx4 v8, s[12:15], s68 offen offset:0 lds
    v_mfma_f32_32x32x16_bf16 v[32:47], a[4:7], v[52:55], v[32:47]
    ds_read_b128 v[48:51], v4 offset:8192
    s_waitcnt lgkmcnt(5)
    v_mfma_f32_32x32x16_bf16 v[32:47], a[8:11], v[56:59], v[32:47]
    ds_read_b128 v[52:55], v5 offset:8192
    s_add_u32 m0, s70, 3968
    s_nop 0
    buffer_load_dwordx4 v8, s[12:15], s68 offen offset:128 lds
    v_mfma_f32_32x32x16_bf16 v[32:47], a[12:15], v[60:63], v[32:47]
    ds_read_b128 v[56:59], v6 offset:8192
    v_mul_f32 v88, v16, v16
    v_mul_f32 v89, v17, v17
    s_waitcnt lgkmcnt(5)
    v_mfma_f32_32x32x16_bf16 v[32:47], a[16:19], v[64:67], v[32:47]
    ds_read_b128 v[60:63], v7 offset:8192
    s_add_u32 m0, s70, 7936
    s_nop 0
    buffer_load_dwordx4 v8, s[12:15], s68 offen offset:256 lds
    v_mul_f32 v90, v18, v18
    v_mfma_f32_32x32x16_bf16 v[32:47], a[20:23], v[68:71], v[32:47]
    ds_read_b128 v[64:67], v4 offset:12288
    v_mul_f32 v91, v19, v19
    v_mul_f32 v92, v20, v20
    s_waitcnt lgkmcnt(5)
    v_mfma_f32_32x32x16_bf16 v[32:47], a[24:27], v[72:75], v[32:47]
    ds_read_b128 v[68:71], v5 offset:12288
    s_add_u32 m0, s70, 11904
    s_nop 0
    buffer_load_dwordx4 v8, s[12:15], s68 offen offset:384 lds
    v_mul_f32 v93, v21, v21
    v_mfma_f32_32x32x16_bf16 v[32:47], a[28:31], v[76:79], v[32:47]
    ds_read_b128 v[72:75], v6 offset:12288
    v_mul_f32 v94, v22, v22
    v_mul_f32 v95, v23, v23
    s_waitcnt lgkmcnt(5)
    v_mfma_f32_32x32x16_bf16 v[32:47], a[32:35], v[48:51], v[32:47]
    ds_read_b128 v[76:79], v7 offset:12288
    s_add_u32 m0, s70, 15872
    s_nop 0
    buffer_load_dwordx4 v8, s[12:15], s68 offen offset:512 lds
    v_fma_f32 v88, v88, s74, v104
    v_mfma_f32_32x32x16_bf16 v[32:47], a[36:39], v[52:55], v[32:47]
    ds_read_b128 v[48:51], v4 offset:16384
    v_fma_f32 v89, v89, s74, v104
    v_fma_f32 v90, v90, s74, v104
    s_waitcnt lgkmcnt(5)
    v_mfma_f32_32x32x16_bf16 v[32:47], a[40:43], v[56:59], v[32:47]
    ds_read_b128 v[52:55], v5 offset:16384
    s_add_u32 m0, s70, 19840
    s_nop 0
    buffer_load_dwordx4 v8, s[12:15], s68 offen offset:640 lds
    v_fma_f32 v91, v91, s74, v104
    v_mfma_f32_32x32x16_bf16 v[32:47], a[44:47], v[60:63], v[32:47]
    ds_read_b128 v[56:59], v6 offset:16384
    v_fma_f32 v92, v92, s74, v104
    v_fma_f32 v93, v93, s74, v104
    s_waitcnt lgkmcnt(5)
    v_mfma_f32_32x32x16_bf16 v[32:47], a[48:51], v[64:67], v[32:47]
    ds_read_b128 v[60:63], v7 offset:16384
    s_add_u32 m0, s70, 23808
    s_nop 0
    buffer_load_dwordx4 v8, s[12:15], s68 offen offset:768 lds
    v_fma_f32 v94, v94, s74, v104
    v_mfma_f32_32x32x16_bf16 v[32:47], a[52:55], v[68:71], v[32:47]
    ds_read_b128 v[64:67], v4 offset:20480
    v_fma_f32 v95, v95, s74, v104
    v_mul_f32 v88, v88, v16
    s_waitcnt lgkmcnt(5)
    v_mfma_f32_32x32x16_bf16 v[32:47], a[56:59], v[72:75], v[32:47]
    ds_read_b128 v[68:71], v5 offset:20480
    s_add_u32 m0, s70, 27776
    s_nop 0
    buffer_load_dwordx4 v8, s[12:15], s68 offen offset:896 lds
    v_mul_f32 v89, v89, v17
    v_mfma_f32_32x32x16_bf16 v[32:47], a[60:63], v[76:79], v[32:47]
    ds_read_b128 v[72:75], v6 offset:20480
    v_mul_f32 v90, v90, v18
    v_mul_f32 v91, v91, v19
    s_waitcnt lgkmcnt(5)
    v_mfma_f32_32x32x16_bf16 v[32:47], a[64:67], v[48:51], v[32:47]
    ds_read_b128 v[76:79], v7 offset:20480
    s_add_u32 s68, s68, 64512
    s_add_u32 s70, s70, 32768
    v_mul_f32 v92, v92, v20
    v_mfma_f32_32x32x16_bf16 v[32:47], a[68:71], v[52:55], v[32:47]
    ds_read_b128 v[48:51], v4 offset:24576
    v_mul_f32 v93, v93, v21
    v_mul_f32 v94, v94, v22
    s_waitcnt lgkmcnt(5)
    v_mfma_f32_32x32x16_bf16 v[32:47], a[72:75], v[56:59], v[32:47]
    ds_read_b128 v[52:55], v5 offset:24576
    s_cmp_ge_u32 s70, 163840
    s_cselect_b32 s4, 163840, 0
    s_sub_u32 s70, s70, s4
    v_mul_f32 v95, v95, v23
    v_mfma_f32_32x32x16_bf16 v[32:47], a[76:79], v[60:63], v[32:47]
    ds_read_b128 v[56:59], v6 offset:24576
    v_exp_f32 v88, v88
    v_mul_f32 v96, v16, v24
    s_waitcnt lgkmcnt(5)
    v_mfma_f32_32x32x16_bf16 v[32:47], a[80:83], v[64:67], v[32:47]
    ds_read_b128 v[60:63], v7 offset:24576
    v_exp_f32 v89, v89
    v_mul_f32 v97, v17, v25
    v_mfma_f32_32x32x16_bf16 v[32:47], a[84:87], v[68:71], v[32:47]
    ds_read_b128 v[64:67], v4 offset:28672
    v_exp_f32 v90, v90
    v_mul_f32 v98, v18, v26
    s_waitcnt lgkmcnt(5)
    v_mfma_f32_32x32x16_bf16 v[32:47], a[88:91], v[72:75], v[32:47]
    ds_read_b128 v[68:71], v5 offset:28672
    v_exp_f32 v91, v91
    v_mul_f32 v99, v19, v27
    v_mfma_f32_32x32x16_bf16 v[32:47], a[92:95], v[76:79], v[32:47]
    ds_read_b128 v[72:75], v6 offset:28672
    v_exp_f32 v92, v92
    v_mul_f32 v100, v20, v28
    s_waitcnt lgkmcnt(5)
    v_mfma_f32_32x32x16_bf16 v[32:47], a[96:99], v[48:51], v[32:47]
    ds_read_b128 v[76:79], v7 offset:28672
    v_exp_f32 v93, v93
    v_mul_f32 v101, v21, v29
    v_mfma_f32_32x32x16_bf16 v[32:47], a[100:103], v[52:55], v[32:47]
    s_waitcnt vmcnt(16)
    s_barrier
    v_add_u32 v4, s69, v9
    v_add_u32 v5, s69, v10
    v_add_u32 v6, s69, v11
    v_add_u32 v7, s69, v12
    s_add_u32 s69, s69, 32768
    s_cmp_ge_u32 s69, 163840
    s_cselect_b32 s69, 0, s69
    ds_read_b128 v[48:51], v4 offset:0
    v_exp_f32 v94, v94
    v_mul_f32 v102, v22, v30
    s_waitcnt lgkmcnt(5)
    v_mfma_f32_32x32x16_bf16 v[32:47], a[104:107], v[56:59], v[32:47]
    ds_read_b128 v[52:55], v5 offset:0
    v_exp_f32 v95, v95
    v_mul_f32 v103, v23, v31
    v_mfma_f32_32x32x16_bf16 v[32:47], a[108:111], v[60:63], v[32:47]
    ds_read_b128 v[56:59], v6 offset:0
    v_add_f32 v88, 1.0, v88
    v_add_f32 v89, 1.0, v89
    s_waitcnt lgkmcnt(5)
    v_mfma_f32_32x32x16_bf16 v[32:47], a[112:115], v[64:67], v[32:47]
    ds_read_b128 v[60:63], v7 offset:0
    v_add_f32 v90, 1.0, v90
    v_add_f32 v91, 1.0, v91
    v_mfma_f32_32x32x16_bf16 v[32:47], a[116:119], v[68:71], v[32:47]
    ds_read_b128 v[64:67], v4 offset:4096
    v_add_f32 v92, 1.0, v92
    v_add_f32 v93, 1.0, v93
    s_waitcnt lgkmcnt(5)
    v_mfma_f32_32x32x16_bf16 v[32:47], a[120:123], v[72:75], v[32:47]
    ds_read_b128 v[68:71], v5 offset:4096
    v_add_f32 v94, 1.0, v94
    v_add_f32 v95, 1.0, v95
    v_mfma_f32_32x32x16_bf16 v[32:47], a[124:127], v[76:79], v[32:47]
    ds_read_b128 v[72:75], v6 offset:4096
    v_rcp_f32 v88, v88
    v_rcp_f32 v89, v89
    s_waitcnt lgkmcnt(5)
    v_mfma_f32_32x32x16_bf16 v[32:47], a[128:131], v[48:51], v[32:47]
    ds_read_b128 v[76:79], v7 offset:4096
    s_add_u32 m0, s70, 0
    s_nop 0
    buffer_load_dwordx4 v8, s[12:15], s68 offen offset:0 lds
    v_mul_f32 v96, v96, v88
    v_mfma_f32_32x32x16_bf16 v[32:47], a[132:135], v[52:55], v[32:47]
    ds_read_b128 v[48:51], v4 offset:8192
    v_rcp_f32 v90, v90
    v_mul_f32 v97, v97, v89
    s_waitcnt lgkmcnt(5)
    v_mfma_f32_32x32x16_bf16 v[32:47], a[136:139], v[56:59], v[32:47]
    ds_read_b128 v[52:55], v5 offset:8192
    s_add_u32 m0, s70, 3968
    s_nop 0
    buffer_load_dwordx4 v8, s[12:15], s68 offen offset:128 lds
    v_rcp_f32 v91, v91
    v_mfma_f32_32x32x16_bf16 v[32:47], a[140:143], v[60:63], v[32:47]
    ds_read_b128 v[56:59], v6 offset:8192
    v_mul_f32 v98, v98, v90
    v_rcp_f32 v92, v92
    s_waitcnt lgkmcnt(5)
    v_mfma_f32_32x32x16_bf16 v[32:47], a[144:147], v[64:67], v[32:47]
    ds_read_b128 v[60:63], v7 offset:8192
    s_add_u32 m0, s70, 7936
    s_nop 0
    buffer_load_dwordx4 v8, s[12:15], s68 offen offset:256 lds
    v_mul_f32 v99, v99, v91
    v_mfma_f32_32x32x16_bf16 v[32:47], a[148:151], v[68:71], v[32:47]
    ds_read_b128 v[64:67], v4 offset:12288
    v_rcp_f32 v93, v93
    v_mul_f32 v100, v100, v92
    s_waitcnt lgkmcnt(5)
    v_mfma_f32_32x32x16_bf16 v[32:47], a[152:155], v[72:75], v[32:47]
    ds_read_b128 v[68:71], v5 offset:12288
    s_add_u32 m0, s70, 11904
    s_nop 0
    buffer_load_dwordx4 v8, s[12:15], s68 offen offset:384 lds
    v_rcp_f32 v94, v94
    v_mfma_f32_32x32x16_bf16 v[32:47], a[156:159], v[76:79], v[32:47]
    ds_read_b128 v[72:75], v6 offset:12288
    v_mul_f32 v101, v101, v93
    v_rcp_f32 v95, v95
    s_waitcnt lgkmcnt(5)
    v_mfma_f32_32x32x16_bf16 v[32:47], a[160:163], v[48:51], v[32:47]
    ds_read_b128 v[76:79], v7 offset:12288
    s_add_u32 m0, s70, 15872
    s_nop 0
    buffer_load_dwordx4 v8, s[12:15], s68 offen offset:512 lds
    v_mul_f32 v102, v102, v94
    v_mfma_f32_32x32x16_bf16 v[32:47], a[164:167], v[52:55], v[32:47]
    ds_read_b128 v[48:51], v4 offset:16384
    v_cvt_pk_bf16_f32 v80, v96, v97
    v_mul_f32 v103, v103, v95
    s_waitcnt lgkmcnt(5)
    v_mfma_f32_32x32x16_bf16 v[32:47], a[168:171], v[56:59], v[32:47]
    ds_read_b128 v[52:55], v5 offset:16384
    s_add_u32 m0, s70, 19840
    s_nop 0
    buffer_load_dwordx4 v8, s[12:15], s68 offen offset:640 lds
    v_cvt_pk_bf16_f32 v81, v98, v99
    v_mfma_f32_32x32x16_bf16 v[32:47], a[172:175], v[60:63], v[32:47]
    ds_read_b128 v[56:59], v6 offset:16384
    v_cvt_pk_bf16_f32 v82, v100, v101
    v_cvt_pk_bf16_f32 v83, v102, v103
    s_waitcnt lgkmcnt(5)
    v_mfma_f32_32x32x16_bf16 v[32:47], a[176:179], v[64:67], v[32:47]
    ds_read_b128 v[60:63], v7 offset:16384
    s_add_u32 m0, s70, 23808
    s_nop 0
    buffer_load_dwordx4 v8, s[12:15], s68 offen offset:768 lds
    buffer_store_dwordx4 v[80:83], v14, s[8:11], s66 offen sc1
    v_mfma_f32_32x32x16_bf16 v[32:47], a[180:183], v[68:71], v[32:47]
    ds_read_b128 v[64:67], v4 offset:20480
    v_mov_b32 v14, v1
    s_add_u32 s66, s66, 229376
    s_waitcnt lgkmcnt(5)
    v_mfma_f32_32x32x16_bf16 v[32:47], a[184:187], v[72:75], v[32:47]
    ds_read_b128 v[68:71], v5 offset:20480
    s_add_u32 m0, s70, 27776
    s_nop 0
    buffer_load_dwordx4 v8, s[12:15], s68 offen offset:896 lds
    v_mfma_f32_32x32x16_bf16 v[32:47], a[188:191], v[76:79], v[32:47]
    ds_read_b128 v[72:75], v6 offset:20480
    s_waitcnt lgkmcnt(5)
    v_mfma_f32_32x32x16_bf16 v[32:47], a[192:195], v[48:51], v[32:47]
    ds_read_b128 v[76:79], v7 offset:20480
    s_add_u32 s68, s68, 1024
    s_add_u32 s70, s70, 32768
    v_mfma_f32_32x32x16_bf16 v[32:47], a[196:199], v[52:55], v[32:47]
    ds_read_b128 v[48:51], v4 offset:24576
    s_waitcnt lgkmcnt(5)
    v_mfma_f32_32x32x16_bf16 v[32:47], a[200:203], v[56:59], v[32:47]
    ds_read_b128 v[52:55], v5 offset:24576
    s_cmp_ge_u32 s70, 163840
    s_cselect_b32 s4, 163840, 0
    s_sub_u32 s70, s70, s4
    v_mfma_f32_32x32x16_bf16 v[32:47], a[204:207], v[60:63], v[32:47]
    ds_read_b128 v[56:59], v6 offset:24576
    s_waitcnt lgkmcnt(5)
    v_mfma_f32_32x32x16_bf16 v[32:47], a[208:211], v[64:67], v[32:47]
    ds_read_b128 v[60:63], v7 offset:24576
    v_mfma_f32_32x32x16_bf16 v[32:47], a[212:215], v[68:71], v[32:47]
    ds_read_b128 v[64:67], v4 offset:28672
    s_waitcnt lgkmcnt(5)
    v_mfma_f32_32x32x16_bf16 v[32:47], a[216:219], v[72:75], v[32:47]
    ds_read_b128 v[68:71], v5 offset:28672
    v_mfma_f32_32x32x16_bf16 v[32:47], a[220:223], v[76:79], v[32:47]
    ds_read_b128 v[72:75], v6 offset:28672
    s_waitcnt lgkmcnt(5)
    v_mfma_f32_32x32x16_bf16 v[32:47], a[224:227], v[48:51], v[32:47]
    ds_read_b128 v[76:79], v7 offset:28672
    v_mfma_f32_32x32x16_bf16 v[32:47], a[228:231], v[52:55], v[32:47]
    s_waitcnt vmcnt(16)
    s_barrier
    v_add_u32 v4, s69, v9
    v_add_u32 v5, s69, v10
    v_add_u32 v6, s69, v11
    v_add_u32 v7, s69, v12
    s_add_u32 s69, s69, 32768
    s_cmp_ge_u32 s69, 163840
    s_cselect_b32 s69, 0, s69
    ds_read_b128 v[48:51], v4 offset:0
    s_waitcnt lgkmcnt(5)
    v_mfma_f32_32x32x16_bf16 v[32:47], a[232:235], v[56:59], v[32:47]
    ds_read_b128 v[52:55], v5 offset:0
    v_mfma_f32_32x32x16_bf16 v[32:47], a[236:239], v[60:63], v[32:47]
    ds_read_b128 v[56:59], v6 offset:0
    s_waitcnt lgkmcnt(5)
    v_mfma_f32_32x32x16_bf16 v[32:47], a[240:243], v[64:67], v[32:47]
    ds_read_b128 v[60:63], v7 offset:0
    v_mfma_f32_32x32x16_bf16 v[32:47], a[244:247], v[68:71], v[32:47]
    ds_read_b128 v[64:67], v4 offset:4096
    s_waitcnt lgkmcnt(5)
    v_mfma_f32_32x32x16_bf16 v[32:47], a[248:251], v[72:75], v[32:47]
    ds_read_b128 v[68:71], v5 offset:4096
    v_mov_b32 v2, s72
    buffer_store_dword v2, v15, s[8:11], s67 offen sc1
    v_mfma_f32_32x32x16_bf16 v[32:47], a[252:255], v[76:79], v[32:47]
    ds_read_b128 v[72:75], v6 offset:4096
    s_add_u32 s72, s71, 1
    s_add_u32 s71, s71, 2
    s_cmp_lt_u32 s71, 64
    s_cbranch_scc1 L_A_ffn
    s_nop 6
    v_mul_f32 v88, v32, v32
    v_mul_f32 v89, v33, v33
    v_mul_f32 v90, v34, v34
    v_mul_f32 v91, v35, v35
    v_mul_f32 v92, v36, v36
    v_mul_f32 v93, v37, v37
    v_mul_f32 v94, v38, v38
    v_mul_f32 v95, v39, v39
    v_fma_f32 v88, v88, s74, v104
    v_fma_f32 v89, v89, s74, v104
    v_fma_f32 v90, v90, s74, v104
    v_fma_f32 v91, v91, s74, v104
    v_fma_f32 v92, v92, s74, v104
    v_fma_f32 v93, v93, s74, v104
    v_fma_f32 v94, v94, s74, v104
    v_fma_f32 v95, v95, s74, v104
    v_mul_f32 v88, v88, v32
    v_mul_f32 v89, v89, v33
    v_mul_f32 v90, v90, v34
    v_mul_f32 v91, v91, v35
    v_mul_f32 v92, v92, v36
    v_mul_f32 v93, v93, v37
    v_mul_f32 v94, v94, v38
    v_mul_f32 v95, v95, v39
    v_exp_f32 v88, v88
    v_mul_f32 v96, v32, v40
    v_exp_f32 v89, v89
    v_mul_f32 v97, v33, v41
    v_exp_f32 v90, v90
    v_mul_f32 v98, v34, v42
    v_exp_f32 v91, v91
    v_mul_f32 v99, v35, v43
    v_exp_f32 v92, v92
    v_mul_f32 v100, v36, v44
    v_exp_f32 v93, v93
    v_mul_f32 v101, v37, v45
    v_exp_f32 v94, v94
    v_mul_f32 v102, v38, v46
    v_exp_f32 v95, v95
    v_mul_f32 v103, v39, v47
    v_add_f32 v88, 1.0, v88
    v_add_f32 v89, 1.0, v89
    v_add_f32 v90, 1.0, v90
    v_add_f32 v91, 1.0, v91
    v_add_f32 v92, 1.0, v92
    v_add_f32 v93, 1.0, v93
    v_add_f32 v94, 1.0, v94
    v_add_f32 v95, 1.0, v95
    v_rcp_f32 v88, v88
    v_rcp_f32 v89, v89
    v_mul_f32 v96, v96, v88
    v_rcp_f32 v90, v90
    v_mul_f32 v97, v97, v89
    v_rcp_f32 v91, v91
    v_mul_f32 v98, v98, v90
    v_rcp_f32 v92, v92
    v_mul_f32 v99, v99, v91
    v_rcp_f32 v93, v93
    v_mul_f32 v100, v100, v92
    v_rcp_f32 v94, v94
    v_mul_f32 v101, v101, v93
    v_rcp_f32 v95, v95
    v_mul_f32 v102, v102, v94
    v_cvt_pk_bf16_f32 v80, v96, v97
    v_mul_f32 v103, v103, v95
    v_cvt_pk_bf16_f32 v81, v98, v99
    v_cvt_pk_bf16_f32 v82, v100, v101
    v_cvt_pk_bf16_f32 v83, v102, v103
    buffer_store_dwordx4 v[80:83], v14, s[8:11], s66 offen sc1
    v_mov_b32 v14, v1
    s_add_u32 s66, s66, 229376
    s_waitcnt vmcnt(0) lgkmcnt(0)
    v_mov_b32 v2, 64
    buffer_store_dword v2, v15, s[8:11], s67 offen sc1
    s_branch L_phase2
L_A_qk_pre:
    v_mov_b32 v14, 268435456
    s_sub_u32 s66, s66, 262144
    v_mov_b32 v32, 0
    v_mov_b32 v33, 0
    v_mov_b32 v34, 0
    v_mov_b32 v35, 0
    v_mov_b32 v36, 0
    v_mov_b32 v37, 0
    v_mov_b32 v38, 0
    v_mov_b32 v39, 0
    v_mov_b32 v40, 0
    v_mov_b32 v41, 0
    v_mov_b32 v42, 0
    v_mov_b32 v43, 0
    v_mov_b32 v44, 0
    v_mov_b32 v45, 0
    v_mov_b32 v46, 0
    v_mov_b32 v47, 0
    s_add_u32 m0, s70, 0
    s_nop 0
    buffer_load_dwordx4 v8, s[12:15], s68 offen offset:0 lds
    s_add_u32 m0, s70, 3968
    s_nop 0
    buffer_load_dwordx4 v8, s[12:15], s68 offen offset:128 lds
    s_add_u32 m0, s70, 7936
    s_nop 0
    buffer_load_dwordx4 v8, s[12:15], s68 offen offset:256 lds
    s_add_u32 m0, s70, 11904
    s_nop 0
    buffer_load_dwordx4 v8, s[12:15], s68 offen offset:384 lds
    s_add_u32 m0, s70, 15872
    s_nop 0
    buffer_load_dwordx4 v8, s[12:15], s68 offen offset:512 lds
    s_add_u32 m0, s70, 19840
    s_nop 0
    buffer_load_dwordx4 v8, s[12:15], s68 offen offset:640 lds
    s_add_u32 m0, s70, 23808
    s_nop 0
    buffer_load_dwordx4 v8, s[12:15], s68 offen offset:768 lds
    s_add_u32 m0, s70, 27776
    s_nop 0
    buffer_load_dwordx4 v8, s[12:15], s68 offen offset:896 lds
    s_add_u32 s68, s68, 1024
    s_add_u32 s70, s70, 32768
    s_cmp_ge_u32 s70, 163840
    s_cselect_b32 s4, 163840, 0
    s_sub_u32 s70, s70, s4
    s_add_u32 m0, s70, 0
    s_nop 0
    buffer_load_dwordx4 v8, s[12:15], s68 offen offset:0 lds
    s_add_u32 m0, s70, 3968
    s_nop 0
    buffer_load_dwordx4 v8, s[12:15], s68 offen offset:128 lds
    s_add_u32 m0, s70, 7936
    s_nop 0
    buffer_load_dwordx4 v8, s[12:15], s68 offen offset:256 lds
    s_add_u32 m0, s70, 11904
    s_nop 0
    buffer_load_dwordx4 v8, s[12:15], s68 offen offset:384 lds
    s_add_u32 m0, s70, 15872
    s_nop 0
    buffer_load_dwordx4 v8, s[12:15], s68 offen offset:512 lds
    s_add_u32 m0, s70, 19840
    s_nop 0
    buffer_load_dwordx4 v8, s[12:15], s68 offen offset:640 lds
    s_add_u32 m0, s70, 23808
    s_nop 0
    buffer_load_dwordx4 v8, s[12:15], s68 offen offset:768 lds
    s_add_u32 m0, s70, 27776
    s_nop 0
    buffer_load_dwordx4 v8, s[12:15], s68 offen offset:896 lds
    s_add_u32 s68, s68, 64512
    s_add_u32 s70, s70, 32768
    s_cmp_ge_u32 s70, 163840
    s_cselect_b32 s4, 163840, 0
    s_sub_u32 s70, s70, s4
    s_add_u32 m0, s70, 0
    s_nop 0
    buffer_load_dwordx4 v8, s[12:15], s68 offen offset:0 lds
    s_add_u32 m0, s70, 3968
    s_nop 0
    buffer_load_dwordx4 v8, s[12:15], s68 offen offset:128 lds
    s_add_u32 m0, s70, 7936
    s_nop 0
    buffer_load_dwordx4 v8, s[12:15], s68 offen offset:256 lds
    s_add_u32 m0, s70, 11904
    s_nop 0
    buffer_load_dwordx4 v8, s[12:15], s68 offen offset:384 lds
    s_add_u32 m0, s70, 15872
    s_nop 0
    buffer_load_dwordx4 v8, s[12:15], s68 offen offset:512 lds
    s_add_u32 m0, s70, 19840
    s_nop 0
    buffer_load_dwordx4 v8, s[12:15], s68 offen offset:640 lds
    s_add_u32 m0, s70, 23808
    s_nop 0
    buffer_load_dwordx4 v8, s[12:15], s68 offen offset:768 lds
    s_add_u32 m0, s70, 27776
    s_nop 0
    buffer_load_dwordx4 v8, s[12:15], s68 offen offset:896 lds
    s_add_u32 s68, s68, 1024
    s_add_u32 s70, s70, 32768
    s_cmp_ge_u32 s70, 163840
    s_cselect_b32 s4, 163840, 0
    s_sub_u32 s70, s70, s4
    s_waitcnt vmcnt(16)
    s_barrier
    v_add_u32 v4, s69, v9
    v_add_u32 v5, s69, v10
    v_add_u32 v6, s69, v11
    v_add_u32 v7, s69, v12
    s_add_u32 s69, s69, 32768
    s_cmp_ge_u32 s69, 163840
    s_cselect_b32 s69, 0, s69
    ds_read_b128 v[48:51], v4 offset:0
    ds_read_b128 v[52:55], v5 offset:0
    ds_read_b128 v[56:59], v6 offset:0
    ds_read_b128 v[60:63], v7 offset:0
    ds_read_b128 v[64:67], v4 offset:4096
    ds_read_b128 v[68:71], v5 offset:4096
    ds_read_b128 v[72:75], v6 offset:4096
    s_mov_b32 s71, 0
    s_mov_b32 s72, 0
L_A_qk:
    s_waitcnt lgkmcnt(5)
    v_mfma_f32_32x32x16_bf16 v[16:31], a[0:3], v[48:51], 0
    ds_read_b128 v[76:79], v7 offset:4096
    s_add_u32 m0, s70, 0
    s_nop 0
    buffer_load_dwordx4 v8, s[12:15], s68 offen offset:0 lds
    v_mfma_f32_32x32x16_bf16 v[16:31], a[4:7], v[52:55], v[16:31]
    ds_read_b128 v[48:51], v4 offset:8192
    s_waitcnt lgkmcnt(5)
    v_mfma_f32_32x32x16_bf16 v[16:31], a[8:11], v[56:59], v[16:31]
    ds_read_b128 v[52:55], v5 offset:8192
    s_add_u32 m0, s70, 3968
    s_nop 0
    buffer_load_dwordx4 v8, s[12:15], s68 offen offset:128 lds
    v_mfma_f32_32x32x16_bf16 v[16:31], a[12:15], v[60:63], v[16:31]
    ds_read_b128 v[56:59], v6 offset:8192
    v_cvt_pk_bf16_f32 v80, v32, v33
    s_waitcnt lgkmcnt(5)
    v_mfma_f32_32x32x16_bf16 v[16:31], a[16:19], v[64:67], v[16:31]
    ds_read_b128 v[60:63], v7 offset:8192
    s_add_u32 m0, s70, 7936
    s_nop 0
    buffer_load_dwordx4 v8, s[12:15], s68 offen offset:256 lds
    v_cvt_pk_bf16_f32 v81, v34, v35
    v_mfma_f32_32x32x16_bf16 v[16:31], a[20:23], v[68:71], v[16:31]
    ds_read_b128 v[64:67], v4 offset:12288
    v_cvt_pk_bf16_f32 v82, v40, v41
    s_waitcnt lgkmcnt(5)
    v_mfma_f32_32x32x16_bf16 v[16:31], a[24:27], v[72:75], v[16:31]
    ds_read_b128 v[68:71], v5 offset:12288
    s_add_u32 m0, s70, 11904
    s_nop 0
    buffer_load_dwordx4 v8, s[12:15], s68 offen offset:384 lds
    v_cvt_pk_bf16_f32 v83, v42, v43
    v_mfma_f32_32x32x16_bf16 v[16:31], a[28:31], v[76:79], v[16:31]
    ds_read_b128 v[72:75], v6 offset:12288
    v_cvt_pk_bf16_f32 v84, v36, v37
    s_waitcnt lgkmcnt(5)
    v_mfma_f32_32x32x16_bf16 v[16:31], a[32:35], v[48:51], v[16:31]
    ds_read_b128 v[76:79], v7 offset:12288
    s_add_u32 m0, s70, 15872
    s_nop 0
    buffer_load_dwordx4 v8, s[12:15], s68 offen offset:512 lds
    v_cvt_pk_bf16_f32 v85, v38, v39
    v_mfma_f32_32x32x16_bf16 v[16:31], a[36:39], v[52:55], v[16:31]
    ds_read_b128 v[48:51], v4 offset:16384
    v_cvt_pk_bf16_f32 v86, v44, v45
    s_waitcnt lgkmcnt(5)
    v_mfma_f32_32x32x16_bf16 v[16:31], a[40:43], v[56:59], v[16:31]
    ds_read_b128 v[52:55], v5 offset:16384
    s_add_u32 m0, s70, 19840
    s_nop 0
    buffer_load_dwordx4 v8, s[12:15], s68 offen offset:640 lds
    v_cvt_pk_bf16_f32 v87, v46, v47
    v_mfma_f32_32x32x16_bf16 v[16:31], a[44:47], v[60:63], v[16:31]
    ds_read_b128 v[56:59], v6 offset:16384
    buffer_store_dwordx4 v[80:83], v14, s[8:11], s66 offen sc1
    s_waitcnt lgkmcnt(5)
    v_mfma_f32_32x32x16_bf16 v[16:31], a[48:51], v[64:67], v[16:31]
    ds_read_b128 v[60:63], v7 offset:16384
    s_add_u32 m0, s70, 23808
    s_nop 0
    buffer_load_dwordx4 v8, s[12:15], s68 offen offset:768 lds
    buffer_store_dwordx4 v[84:87], v14, s[8:11], s66 offen offset:512 sc1
    v_mfma_f32_32x32x16_bf16 v[16:31], a[52:55], v[68:71], v[16:31]
    ds_read_b128 v[64:67], v4 offset:20480
    v_mov_b32 v14, v13
    s_waitcnt lgkmcnt(5)
    v_mfma_f32_32x32x16_bf16 v[16:31], a[56:59], v[72:75], v[16:31]
    ds_read_b128 v[68:71], v5 offset:20480
    s_add_u32 m0, s70, 27776
    s_nop 0
    buffer_load_dwordx4 v8, s[12:15], s68 offen offset:896 lds
    s_add_u32 s66, s66, 262144
    v_mfma_f32_32x32x16_bf16 v[16:31], a[60:63], v[76:79], v[16:31]
    ds_read_b128 v[72:75], v6 offset:20480
    s_waitcnt lgkmcnt(5)
    v_mfma_f32_32x32x16_bf16 v[16:31], a[64:67], v[48:51], v[16:31]
    ds_read_b128 v[76:79], v7 offset:20480
    s_add_u32 s68, s68, 64512
    s_add_u32 s70, s70, 32768
    v_mfma_f32_32x32x16_bf16 v[16:31], a[68:71], v[52:55], v[16:31]
    ds_read_b128 v[48:51], v4 offset:24576
    s_waitcnt lgkmcnt(5)
    v_mfma_f32_32x32x16_bf16 v[16:31], a[72:75], v[56:59], v[16:31]
    ds_read_b128 v[52:55], v5 offset:24576
    s_cmp_ge_u32 s70, 163840
    s_cselect_b32 s4, 163840, 0
    s_sub_u32 s70, s70, s4
    v_mfma_f32_32x32x16_bf16 v[16:31], a[76:79], v[60:63], v[16:31]
    ds_read_b128 v[56:59], v6 offset:24576
    s_waitcnt lgkmcnt(5)
    v_mfma_f32_32x32x16_bf16 v[16:31], a[80:83], v[64:67], v[16:31]
    ds_read_b128 v[60:63], v7 offset:24576
    v_mfma_f32_32x32x16_bf16 v[16:31], a[84:87], v[68:71], v[16:31]
    ds_read_b128 v[64:67], v4 offset:28672
    s_waitcnt lgkmcnt(5)
    v_mfma_f32_32x32x16_bf16 v[16:31], a[88:91], v[72:75], v[16:31]
    ds_read_b128 v[68:71], v5 offset:28672
    v_mfma_f32_32x32x16_bf16 v[16:31], a[92:95], v[76:79], v[16:31]
    ds_read_b128 v[72:75], v6 offset:28672
    s_waitcnt lgkmcnt(5)
    v_mfma_f32_32x32x16_bf16 v[16:31], a[96:99], v[48:51], v[16:31]
    ds_read_b128 v[76:79], v7 offset:28672
    v_mfma_f32_32x32x16_bf16 v[16:31], a[100:103], v[52:55], v[16:31]
    s_waitcnt vmcnt(16)
    s_barrier
    v_add_u32 v4, s69, v9
    v_add_u32 v5, s69, v10
    v_add_u32 v6, s69, v11
    v_add_u32 v7, s69, v12
    s_add_u32 s69, s69, 32768
    s_cmp_ge_u32 s69, 163840
    s_cselect_b32 s69, 0, s69
    ds_read_b128 v[48:51], v4 offset:0
    s_waitcnt lgkmcnt(5)
    v_mfma_f32_32x32x16_bf16 v[16:31], a[104:107], v[56:59], v[16:31]
    ds_read_b128 v[52:55], v5 offset:0
    v_mfma_f32_32x32x16_bf16 v[16:31], a[108:111], v[60:63], v[16:31]
    ds_read_b128 v[56:59], v6 offset:0
    v_mov_b32 v2, s72
    buffer_store_dword v2, v15, s[8:11], s67 offen sc1
    s_waitcnt lgkmcnt(5)
    v_mfma_f32_32x32x16_bf16 v[16:31], a[112:115], v[64:67], v[16:31]
    ds_read_b128 v[60:63], v7 offset:0
    v_mfma_f32_32x32x16_bf16 v[16:31], a[116:119], v[68:71], v[16:31]
    ds_read_b128 v[64:67], v4 offset:4096
    s_waitcnt lgkmcnt(5)
    v_mfma_f32_32x32x16_bf16 v[16:31], a[120:123], v[72:75], v[16:31]
    ds_read_b128 v[68:71], v5 offset:4096
    v_mfma_f32_32x32x16_bf16 v[16:31], a[124:127], v[76:79], v[16:31]
    ds_read_b128 v[72:75], v6 offset:4096
    s_waitcnt lgkmcnt(5)
    v_mfma_f32_32x32x16_bf16 v[16:31], a[128:131], v[48:51], v[16:31]
    ds_read_b128 v[76:79], v7 offset:4096
    s_add_u32 m0, s70, 0
    s_nop 0
    buffer_load_dwordx4 v8, s[12:15], s68 offen offset:0 lds
    v_mfma_f32_32x32x16_bf16 v[16:31], a[132:135], v[52:55], v[16:31]
    ds_read_b128 v[48:51], v4 offset:8192
    s_waitcnt lgkmcnt(5)
    v_mfma_f32_32x32x16_bf16 v[16:31], a[136:139], v[56:59], v[16:31]
    ds_read_b128 v[52:55], v5 offset:8192
    s_add_u32 m0, s70, 3968
    s_nop 0
    buffer_load_dwordx4 v8, s[12:15], s68 offen offset:128 lds
    v_mfma_f32_32x32x16_bf16 v[16:31], a[140:143], v[60:63], v[16:31]
    ds_read_b128 v[56:59], v6 offset:8192
    s_waitcnt lgkmcnt(5)
    v_mfma_f32_32x32x16_bf16 v[16:31], a[144:147], v[64:67], v[16:31]
    ds_read_b128 v[60:63], v7 offset:8192
    s_add_u32 m0, s70, 7936
    s_nop 0
    buffer_load_dwordx4 v8, s[12:15], s68 offen offset:256 lds
    v_mfma_f32_32x32x16_bf16 v[16:31], a[148:151], v[68:71], v[16:31]
    ds_read_b128 v[64:67], v4 offset:12288
    s_waitcnt lgkmcnt(5)
    v_mfma_f32_32x32x16_bf16 v[16:31], a[152:155], v[72:75], v[16:31]
    ds_read_b128 v[68:71], v5 offset:12288
    s_add_u32 m0, s70, 11904
    s_nop 0
    buffer_load_dwordx4 v8, s[12:15], s68 offen offset:384 lds
    v_mfma_f32_32x32x16_bf16 v[16:31], a[156:159], v[76:79], v[16:31]
    ds_read_b128 v[72:75], v6 offset:12288
    s_waitcnt lgkmcnt(5)
    v_mfma_f32_32x32x16_bf16 v[16:31], a[160:163], v[48:51], v[16:31]
    ds_read_b128 v[76:79], v7 offset:12288
    s_add_u32 m0, s70, 15872
    s_nop 0
    buffer_load_dwordx4 v8, s[12:15], s68 offen offset:512 lds
    v_mfma_f32_32x32x16_bf16 v[16:31], a[164:167], v[52:55], v[16:31]
    ds_read_b128 v[48:51], v4 offset:16384
    s_waitcnt lgkmcnt(5)
    v_mfma_f32_32x32x16_bf16 v[16:31], a[168:171], v[56:59], v[16:31]
    ds_read_b128 v[52:55], v5 offset:16384
    s_add_u32 m0, s70, 19840
    s_nop 0
    buffer_load_dwordx4 v8, s[12:15], s68 offen offset:640 lds
    v_mfma_f32_32x32x16_bf16 v[16:31], a[172:175], v[60:63], v[16:31]
    ds_read_b128 v[56:59], v6 offset:16384
    s_waitcnt lgkmcnt(5)
    v_mfma_f32_32x32x16_bf16 v[16:31], a[176:179], v[64:67], v[16:31]
    ds_read_b128 v[60:63], v7 offset:16384
    s_add_u32 m0, s70, 23808
    s_nop 0
    buffer_load_dwordx4 v8, s[12:15], s68 offen offset:768 lds
    v_mfma_f32_32x32x16_bf16 v[16:31], a[180:183], v[68:71], v[16:31]
    ds_read_b128 v[64:67], v4 offset:20480
    s_waitcnt lgkmcnt(5)
    v_mfma_f32_32x32x16_bf16 v[16:31], a[184:187], v[72:75], v[16:31]
    ds_read_b128 v[68:71], v5 offset:20480
    s_add_u32 m0, s70, 27776
    s_nop 0
    buffer_load_dwordx4 v8, s[12:15], s68 offen offset:896 lds
    v_mfma_f32_32x32x16_bf16 v[16:31], a[188:191], v[76:79], v[16:31]
    ds_read_b128 v[72:75], v6 offset:20480
    s_waitcnt lgkmcnt(5)
    v_mfma_f32_32x32x16_bf16 v[16:31], a[192:195], v[48:51], v[16:31]
    ds_read_b128 v[76:79], v7 offset:20480
    s_add_u32 s68, s68, 1024
    s_add_u32 s70, s70, 32768
    v_mfma_f32_32x32x16_bf16 v[16:31], a[196:199], v[52:55], v[16:31]
    ds_read_b128 v[48:51], v4 offset:24576
    s_waitcnt lgkmcnt(5)
    v_mfma_f32_32x32x16_bf16 v[16:31], a[200:203], v[56:59], v[16:31]
    ds_read_b128 v[52:55], v5 offset:24576
    s_cmp_ge_u32 s70, 163840
    s_cselect_b32 s4, 163840, 0
    s_sub_u32 s70, s70, s4
    v_mfma_f32_32x32x16_bf16 v[16:31], a[204:207], v[60:63], v[16:31]
    ds_read_b128 v[56:59], v6 offset:24576
    s_waitcnt lgkmcnt(5)
    v_mfma_f32_32x32x16_bf16 v[16:31], a[208:211], v[64:67], v[16:31]
    ds_read_b128 v[60:63], v7 offset:24576
    v_mfma_f32_32x32x16_bf16 v[16:31], a[212:215], v[68:71], v[16:31]
    ds_read_b128 v[64:67], v4 offset:28672
    s_waitcnt lgkmcnt(5)
    v_mfma_f32_32x32x16_bf16 v[16:31], a[216:219], v[72:75], v[16:31]
    ds_read_b128 v[68:71], v5 offset:28672
    v_mfma_f32_32x32x16_bf16 v[16:31], a[220:223], v[76:79], v[16:31]
    ds_read_b128 v[72:75], v6 offset:28672
    s_waitcnt lgkmcnt(5)
    v_mfma_f32_32x32x16_bf16 v[16:31], a[224:227], v[48:51], v[16:31]
    ds_read_b128 v[76:79], v7 offset:28672
    v_mfma_f32_32x32x16_bf16 v[16:31], a[228:231], v[52:55], v[16:31]
    s_waitcnt vmcnt(16)
    s_barrier
    v_add_u32 v4, s69, v9
    v_add_u32 v5, s69, v10
    v_add_u32 v6, s69, v11
    v_add_u32 v7, s69, v12
    s_add_u32 s69, s69, 32768
    s_cmp_ge_u32 s69, 163840
    s_cselect_b32 s69, 0, s69
    ds_read_b128 v[48:51], v4 offset:0
    s_waitcnt lgkmcnt(5)
    v_mfma_f32_32x32x16_bf16 v[16:31], a[232:235], v[56:59], v[16:31]
    ds_read_b128 v[52:55], v5 offset:0
    v_mfma_f32_32x32x16_bf16 v[16:31], a[236:239], v[60:63], v[16:31]
    ds_read_b128 v[56:59], v6 offset:0
    s_waitcnt lgkmcnt(5)
    v_mfma_f32_32x32x16_bf16 v[16:31], a[240:243], v[64:67], v[16:31]
    ds_read_b128 v[60:63], v7 offset:0
    v_mfma_f32_32x32x16_bf16 v[16:31], a[244:247], v[68:71], v[16:31]
    ds_read_b128 v[64:67], v4 offset:4096
    s_waitcnt lgkmcnt(5)
    v_mfma_f32_32x32x16_bf16 v[16:31], a[248:251], v[72:75], v[16:31]
    ds_read_b128 v[68:71], v5 offset:4096
    v_mfma_f32_32x32x16_bf16 v[16:31], a[252:255], v[76:79], v[16:31]
    ds_read_b128 v[72:75], v6 offset:4096
    s_add_u32 s72, s71, 0
    s_waitcnt lgkmcnt(5)
    v_mfma_f32_32x32x16_bf16 v[32:47], a[0:3], v[48:51], 0
    ds_read_b128 v[76:79], v7 offset:4096
    s_add_u32 m0, s70, 0
    s_nop 0
    buffer_load_dwordx4 v8, s[12:15], s68 offen offset:0 lds
    v_mfma_f32_32x32x16_bf16 v[32:47], a[4:7], v[52:55], v[32:47]
    ds_read_b128 v[48:51], v4 offset:8192
    s_waitcnt lgkmcnt(5)
    v_mfma_f32_32x32x16_bf16 v[32:47], a[8:11], v[56:59], v[32:47]
    ds_read_b128 v[52:55], v5 offset:8192
    s_add_u32 m0, s70, 3968
    s_nop 0
    buffer_load_dwordx4 v8, s[12:15], s68 offen offset:128 lds
    v_mfma_f32_32x32x16_bf16 v[32:47], a[12:15], v[60:63], v[32:47]
    ds_read_b128 v[56:59], v6 offset:8192
    v_cvt_pk_bf16_f32 v80, v16, v17
    s_waitcnt lgkmcnt(5)
    v_mfma_f32_32x32x16_bf16 v[32:47], a[16:19], v[64:67], v[32:47]
    ds_read_b128 v[60:63], v7 offset:8192
    s_add_u32 m0, s70, 7936
    s_nop 0
    buffer_load_dwordx4 v8, s[12:15], s68 offen offset:256 lds
    v_cvt_pk_bf16_f32 v81, v18, v19
    v_mfma_f32_32x32x16_bf16 v[32:47], a[20:23], v[68:71], v[32:47]
    ds_read_b128 v[64:67], v4 offset:12288
    v_cvt_pk_bf16_f32 v82, v24, v25
    s_waitcnt lgkmcnt(5)
    v_mfma_f32_32x32x16_bf16 v[32:47], a[24:27], v[72:75], v[32:47]
    ds_read_b128 v[68:71], v5 offset:12288
    s_add_u32 m0, s70, 11904
    s_nop 0
    buffer_load_dwordx4 v8, s[12:15], s68 offen offset:384 lds
    v_cvt_pk_bf16_f32 v83, v26, v27
    v_mfma_f32_32x32x16_bf16 v[32:47], a[28:31], v[76:79], v[32:47]
    ds_read_b128 v[72:75], v6 offset:12288
    v_cvt_pk_bf16_f32 v84, v20, v21
    s_waitcnt lgkmcnt(5)
    v_mfma_f32_32x32x16_bf16 v[32:47], a[32:35], v[48:51], v[32:47]
    ds_read_b128 v[76:79], v7 offset:12288
    s_add_u32 m0, s70, 15872
    s_nop 0
    buffer_load_dwordx4 v8, s[12:15], s68 offen offset:512 lds
    v_cvt_pk_bf16_f32 v85, v22, v23
    v_mfma_f32_32x32x16_bf16 v[32:47], a[36:39], v[52:55], v[32:47]
    ds_read_b128 v[48:51], v4 offset:16384
    v_cvt_pk_bf16_f32 v86, v28, v29
    s_waitcnt lgkmcnt(5)
    v_mfma_f32_32x32x16_bf16 v[32:47], a[40:43], v[56:59], v[32:47]
    ds_read_b128 v[52:55], v5 offset:16384
    s_add_u32 m0, s70, 19840
    s_nop 0
    buffer_load_dwordx4 v8, s[12:15], s68 offen offset:640 lds
    v_cvt_pk_bf16_f32 v87, v30, v31
    v_mfma_f32_32x32x16_bf16 v[32:47], a[44:47], v[60:63], v[32:47]
    ds_read_b128 v[56:59], v6 offset:16384
    buffer_store_dwordx4 v[80:83], v14, s[8:11], s66 offen sc1
    s_waitcnt lgkmcnt(5)
    v_mfma_f32_32x32x16_bf16 v[32:47], a[48:51], v[64:67], v[32:47]
    ds_read_b128 v[60:63], v7 offset:16384
    s_add_u32 m0, s70, 23808
    s_nop 0
    buffer_load_dwordx4 v8, s[12:15], s68 offen offset:768 lds
    buffer_store_dwordx4 v[84:87], v14, s[8:11], s66 offen offset:512 sc1
    v_mfma_f32_32x32x16_bf16 v[32:47], a[52:55], v[68:71], v[32:47]
    ds_read_b128 v[64:67], v4 offset:20480
    v_mov_b32 v14, v13
    s_waitcnt lgkmcnt(5)
    v_mfma_f32_32x32x16_bf16 v[32:47], a[56:59], v[72:75], v[32:47]
    ds_read_b128 v[68:71], v5 offset:20480
    s_add_u32 m0, s70, 27776
    s_nop 0
    buffer_load_dwordx4 v8, s[12:15], s68 offen offset:896 lds
    s_add_u32 s66, s66, 262144
    v_mfma_f32_32x32x16_bf16 v[32:47], a[60:63], v[76:79], v[32:47]
    ds_read_b128 v[72:75], v6 offset:20480
    s_waitcnt lgkmcnt(5)
    v_mfma_f32_32x32x16_bf16 v[32:47], a[64:67], v[48:51], v[32:47]
    ds_read_b128 v[76:79], v7 offset:20480
    s_add_u32 s68, s68, 64512
    s_add_u32 s70, s70, 32768
    v_mfma_f32_32x32x16_bf16 v[32:47], a[68:71], v[52:55], v[32:47]
    ds_read_b128 v[48:51], v4 offset:24576
    s_waitcnt lgkmcnt(5)
    v_mfma_f32_32x32x16_bf16 v[32:47], a[72:75], v[56:59], v[32:47]
    ds_read_b128 v[52:55], v5 offset:24576
    s_cmp_ge_u32 s70, 163840
    s_cselect_b32 s4, 163840, 0
    s_sub_u32 s70, s70, s4
    v_mfma_f32_32x32x16_bf16 v[32:47], a[76:79], v[60:63], v[32:47]
    ds_read_b128 v[56:59], v6 offset:24576
    s_waitcnt lgkmcnt(5)
    v_mfma_f32_32x32x16_bf16 v[32:47], a[80:83], v[64:67], v[32:47]
    ds_read_b128 v[60:63], v7 offset:24576
    v_mfma_f32_32x32x16_bf16 v[32:47], a[84:87], v[68:71], v[32:47]
    ds_read_b128 v[64:67], v4 offset:28672
    s_waitcnt lgkmcnt(5)
    v_mfma_f32_32x32x16_bf16 v[32:47], a[88:91], v[72:75], v[32:47]
    ds_read_b128 v[68:71], v5 offset:28672
    v_mfma_f32_32x32x16_bf16 v[32:47], a[92:95], v[76:79], v[32:47]
    ds_read_b128 v[72:75], v6 offset:28672
    s_waitcnt lgkmcnt(5)
    v_mfma_f32_32x32x16_bf16 v[32:47], a[96:99], v[48:51], v[32:47]
    ds_read_b128 v[76:79], v7 offset:28672
    v_mfma_f32_32x32x16_bf16 v[32:47], a[100:103], v[52:55], v[32:47]
    s_waitcnt vmcnt(16)
    s_barrier
    v_add_u32 v4, s69, v9
    v_add_u32 v5, s69, v10
    v_add_u32 v6, s69, v11
    v_add_u32 v7, s69, v12
    s_add_u32 s69, s69, 32768
    s_cmp_ge_u32 s69, 163840
    s_cselect_b32 s69, 0, s69
    ds_read_b128 v[48:51], v4 offset:0
    s_waitcnt lgkmcnt(5)
    v_mfma_f32_32x32x16_bf16 v[32:47], a[104:107], v[56:59], v[32:47]
    ds_read_b128 v[52:55], v5 offset:0
    v_mfma_f32_32x32x16_bf16 v[32:47], a[108:111], v[60:63], v[32:47]
    ds_read_b128 v[56:59], v6 offset:0
    v_mov_b32 v2, s72
    buffer_store_dword v2, v15, s[8:11], s67 offen sc1
    s_waitcnt lgkmcnt(5)
    v_mfma_f32_32x32x16_bf16 v[32:47], a[112:115], v[64:67], v[32:47]
    ds_read_b128 v[60:63], v7 offset:0
    v_mfma_f32_32x32x16_bf16 v[32:47], a[116:119], v[68:71], v[32:47]
    ds_read_b128 v[64:67], v4 offset:4096
    s_waitcnt lgkmcnt(5)
    v_mfma_f32_32x32x16_bf16 v[32:47], a[120:123], v[72:75], v[32:47]
    ds_read_b128 v[68:71], v5 offset:4096
    v_mfma_f32_32x32x16_bf16 v[32:47], a[124:127], v[76:79], v[32:47]
    ds_read_b128 v[72:75], v6 offset:4096
    s_waitcnt lgkmcnt(5)
    v_mfma_f32_32x32x16_bf16 v[32:47], a[128:131], v[48:51], v[32:47]
    ds_read_b128 v[76:79], v7 offset:4096
    s_add_u32 m0, s70, 0
    s_nop 0
    buffer_load_dwordx4 v8, s[12:15], s68 offen offset:0 lds
    v_mfma_f32_32x32x16_bf16 v[32:47], a[132:135], v[52:55], v[32:47]
    ds_read_b128 v[48:51], v4 offset:8192
    s_waitcnt lgkmcnt(5)
    v_mfma_f32_32x32x16_bf16 v[32:47], a[136:139], v[56:59], v[32:47]
    ds_read_b128 v[52:55], v5 offset:8192
    s_add_u32 m0, s70, 3968
    s_nop 0
    buffer_load_dwordx4 v8, s[12:15], s68 offen offset:128 lds
    v_mfma_f32_32x32x16_bf16 v[32:47], a[140:143], v[60:63], v[32:47]
    ds_read_b128 v[56:59], v6 offset:8192
    s_waitcnt lgkmcnt(5)
    v_mfma_f32_32x32x16_bf16 v[32:47], a[144:147], v[64:67], v[32:47]
    ds_read_b128 v[60:63], v7 offset:8192
    s_add_u32 m0, s70, 7936
    s_nop 0
    buffer_load_dwordx4 v8, s[12:15], s68 offen offset:256 lds
    v_mfma_f32_32x32x16_bf16 v[32:47], a[148:151], v[68:71], v[32:47]
    ds_read_b128 v[64:67], v4 offset:12288
    s_waitcnt lgkmcnt(5)
    v_mfma_f32_32x32x16_bf16 v[32:47], a[152:155], v[72:75], v[32:47]
    ds_read_b128 v[68:71], v5 offset:12288
    s_add_u32 m0, s70, 11904
    s_nop 0
    buffer_load_dwordx4 v8, s[12:15], s68 offen offset:384 lds
    v_mfma_f32_32x32x16_bf16 v[32:47], a[156:159], v[76:79], v[32:47]
    ds_read_b128 v[72:75], v6 offset:12288
    s_waitcnt lgkmcnt(5)
    v_mfma_f32_32x32x16_bf16 v[32:47], a[160:163], v[48:51], v[32:47]
    ds_read_b128 v[76:79], v7 offset:12288
    s_add_u32 m0, s70, 15872
    s_nop 0
    buffer_load_dwordx4 v8, s[12:15], s68 offen offset:512 lds
    v_mfma_f32_32x32x16_bf16 v[32:47], a[164:167], v[52:55], v[32:47]
    ds_read_b128 v[48:51], v4 offset:16384
    s_waitcnt lgkmcnt(5)
    v_mfma_f32_32x32x16_bf16 v[32:47], a[168:171], v[56:59], v[32:47]
    ds_read_b128 v[52:55], v5 offset:16384
    s_add_u32 m0, s70, 19840
    s_nop 0
    buffer_load_dwordx4 v8, s[12:15], s68 offen offset:640 lds
    v_mfma_f32_32x32x16_bf16 v[32:47], a[172:175], v[60:63], v[32:47]
    ds_read_b128 v[56:59], v6 offset:16384
    s_waitcnt lgkmcnt(5)
    v_mfma_f32_32x32x16_bf16 v[32:47], a[176:179], v[64:67], v[32:47]
    ds_read_b128 v[60:63], v7 offset:16384
    s_add_u32 m0, s70, 23808
    s_nop 0
    buffer_load_dwordx4 v8, s[12:15], s68 offen offset:768 lds
    v_mfma_f32_32x32x16_bf16 v[32:47], a[180:183], v[68:71], v[32:47]
    ds_read_b128 v[64:67], v4 offset:20480
    s_waitcnt lgkmcnt(5)
    v_mfma_f32_32x32x16_bf16 v[32:47], a[184:187], v[72:75], v[32:47]
    ds_read_b128 v[68:71], v5 offset:20480
    s_add_u32 m0, s70, 27776
    s_nop 0
    buffer_load_dwordx4 v8, s[12:15], s68 offen offset:896 lds
    v_mfma_f32_32x32x16_bf16 v[32:47], a[188:191], v[76:79], v[32:47]
    ds_read_b128 v[72:75], v6 offset:20480
    s_waitcnt lgkmcnt(5)
    v_mfma_f32_32x32x16_bf16 v[32:47], a[192:195], v[48:51], v[32:47]
    ds_read_b128 v[76:79], v7 offset:20480
    s_add_u32 s68, s68, 1024
    s_add_u32 s70, s70, 32768
    v_mfma_f32_32x32x16_bf16 v[32:47], a[196:199], v[52:55], v[32:47]
    ds_read_b128 v[48:51], v4 offset:24576
    s_waitcnt lgkmcnt(5)
    v_mfma_f32_32x32x16_bf16 v[32:47], a[200:203], v[56:59], v[32:47]
    ds_read_b128 v[52:55], v5 offset:24576
    s_cmp_ge_u32 s70, 163840
    s_cselect_b32 s4, 163840, 0
    s_sub_u32 s70, s70, s4
    v_mfma_f32_32x32x16_bf16 v[32:47], a[204:207], v[60:63], v[32:47]
    ds_read_b128 v[56:59], v6 offset:24576
    s_waitcnt lgkmcnt(5)
    v_mfma_f32_32x32x16_bf16 v[32:47], a[208:211], v[64:67], v[32:47]
    ds_read_b128 v[60:63], v7 offset:24576
    v_mfma_f32_32x32x16_bf16 v[32:47], a[212:215], v[68:71], v[32:47]
    ds_read_b128 v[64:67], v4 offset:28672
    s_waitcnt lgkmcnt(5)
    v_mfma_f32_32x32x16_bf16 v[32:47], a[216:219], v[72:75], v[32:47]
    ds_read_b128 v[68:71], v5 offset:28672
    v_mfma_f32_32x32x16_bf16 v[32:47], a[220:223], v[76:79], v[32:47]
    ds_read_b128 v[72:75], v6 offset:28672
    s_waitcnt lgkmcnt(5)
    v_mfma_f32_32x32x16_bf16 v[32:47], a[224:227], v[48:51], v[32:47]
    ds_read_b128 v[76:79], v7 offset:28672
    v_mfma_f32_32x32x16_bf16 v[32:47], a[228:231], v[52:55], v[32:47]
    s_waitcnt vmcnt(16)
    s_barrier
    v_add_u32 v4, s69, v9
    v_add_u32 v5, s69, v10
    v_add_u32 v6, s69, v11
    v_add_u32 v7, s69, v12
    s_add_u32 s69, s69, 32768
    s_cmp_ge_u32 s69, 163840
    s_cselect_b32 s69, 0, s69
    ds_read_b128 v[48:51], v4 offset:0
    s_waitcnt lgkmcnt(5)
    v_mfma_f32_32x32x16_bf16 v[32:47], a[232:235], v[56:59], v[32:47]
    ds_read_b128 v[52:55], v5 offset:0
    v_mfma_f32_32x32x16_bf16 v[32:47], a[236:239], v[60:63], v[32:47]
    ds_read_b128 v[56:59], v6 offset:0
    s_waitcnt lgkmcnt(5)
    v_mfma_f32_32x32x16_bf16 v[32:47], a[240:243], v[64:67], v[32:47]
    ds_read_b128 v[60:63], v7 offset:0
    v_mfma_f32_32x32x16_bf16 v[32:47], a[244:247], v[68:71], v[32:47]
    ds_read_b128 v[64:67], v4 offset:4096
    s_waitcnt lgkmcnt(5)
    v_mfma_f32_32x32x16_bf16 v[32:47], a[248:251], v[72:75], v[32:47]
    ds_read_b128 v[68:71], v5 offset:4096
    v_mfma_f32_32x32x16_bf16 v[32:47], a[252:255], v[76:79], v[32:47]
    ds_read_b128 v[72:75], v6 offset:4096
    s_add_u32 s72, s71, 1
    s_add_u32 s71, s71, 2
    s_cmp_lt_u32 s71, 64
    s_cbranch_scc1 L_A_qk
    s_nop 6
    v_cvt_pk_bf16_f32 v80, v32, v33
    v_cvt_pk_bf16_f32 v81, v34, v35
    v_cvt_pk_bf16_f32 v82, v40, v41
    v_cvt_pk_bf16_f32 v83, v42, v43
    v_cvt_pk_bf16_f32 v84, v36, v37
    v_cvt_pk_bf16_f32 v85, v38, v39
    v_cvt_pk_bf16_f32 v86, v44, v45
    v_cvt_pk_bf16_f32 v87, v46, v47
    buffer_store_dwordx4 v[80:83], v14, s[8:11], s66 offen sc1
    buffer_store_dwordx4 v[84:87], v14, s[8:11], s66 offen offset:512 sc1
    v_mov_b32 v14, v13
    s_add_u32 s66, s66, 262144
    s_waitcnt vmcnt(0) lgkmcnt(0)
    v_mov_b32 v2, 64
    buffer_store_dword v2, v15, s[8:11], s67 offen sc1
    s_branch L_phase2
L_A_v_pre:
    v_mov_b32 v14, 268435456
    s_sub_u32 s66, s66, 262144
    v_mov_b32 v32, 0
    v_mov_b32 v33, 0
    v_mov_b32 v34, 0
    v_mov_b32 v35, 0
    v_mov_b32 v36, 0
    v_mov_b32 v37, 0
    v_mov_b32 v38, 0
    v_mov_b32 v39, 0
    v_mov_b32 v40, 0
    v_mov_b32 v41, 0
    v_mov_b32 v42, 0
    v_mov_b32 v43, 0
    v_mov_b32 v44, 0
    v_mov_b32 v45, 0
    v_mov_b32 v46, 0
    v_mov_b32 v47, 0
    s_add_u32 m0, s70, 0
    s_nop 0
    buffer_load_dwordx4 v8, s[12:15], s68 offen offset:0 lds
    s_add_u32 m0, s70, 3968
    s_nop 0
    buffer_load_dwordx4 v8, s[12:15], s68 offen offset:128 lds
    s_add_u32 m0, s70, 7936
    s_nop 0
    buffer_load_dwordx4 v8, s[12:15], s68 offen offset:256 lds
    s_add_u32 m0, s70, 11904
    s_nop 0
    buffer_load_dwordx4 v8, s[12:15], s68 offen offset:384 lds
    s_add_u32 m0, s70, 15872
    s_nop 0
    buffer_load_dwordx4 v8, s[12:15], s68 offen offset:512 lds
    s_add_u32 m0, s70, 19840
    s_nop 0
    buffer_load_dwordx4 v8, s[12:15], s68 offen offset:640 lds
    s_add_u32 m0, s70, 23808
    s_nop 0
    buffer_load_dwordx4 v8, s[12:15], s68 offen offset:768 lds
    s_add_u32 m0, s70, 27776
    s_nop 0
    buffer_load_dwordx4 v8, s[12:15], s68 offen offset:896 lds
    s_add_u32 s68, s68, 1024
    s_add_u32 s70, s70, 32768
    s_cmp_ge_u32 s70, 163840
    s_cselect_b32 s4, 163840, 0
    s_sub_u32 s70, s70, s4
    s_add_u32 m0, s70, 0
    s_nop 0
    buffer_load_dwordx4 v8, s[12:15], s68 offen offset:0 lds
    s_add_u32 m0, s70, 3968
    s_nop 0
    buffer_load_dwordx4 v8, s[12:15], s68 offen offset:128 lds
    s_add_u32 m0, s70, 7936
    s_nop 0
    buffer_load_dwordx4 v8, s[12:15], s68 offen offset:256 lds
    s_add_u32 m0, s70, 11904
    s_nop 0
    buffer_load_dwordx4 v8, s[12:15], s68 offen offset:384 lds
    s_add_u32 m0, s70, 15872
    s_nop 0
    buffer_load_dwordx4 v8, s[12:15], s68 offen offset:512 lds
    s_add_u32 m0, s70, 19840
    s_nop 0
    buffer_load_dwordx4 v8, s[12:15], s68 offen offset:640 lds
    s_add_u32 m0, s70, 23808
    s_nop 0
    buffer_load_dwordx4 v8, s[12:15], s68 offen offset:768 lds
    s_add_u32 m0, s70, 27776
    s_nop 0
    buffer_load_dwordx4 v8, s[12:15], s68 offen offset:896 lds
    s_add_u32 s68, s68, 64512
    s_add_u32 s70, s70, 32768
    s_cmp_ge_u32 s70, 163840
    s_cselect_b32 s4, 163840, 0
    s_sub_u32 s70, s70, s4
    s_add_u32 m0, s70, 0
    s_nop 0
    buffer_load_dwordx4 v8, s[12:15], s68 offen offset:0 lds
    s_add_u32 m0, s70, 3968
    s_nop 0
    buffer_load_dwordx4 v8, s[12:15], s68 offen offset:128 lds
    s_add_u32 m0, s70, 7936
    s_nop 0
    buffer_load_dwordx4 v8, s[12:15], s68 offen offset:256 lds
    s_add_u32 m0, s70, 11904
    s_nop 0
    buffer_load_dwordx4 v8, s[12:15], s68 offen offset:384 lds
    s_add_u32 m0, s70, 15872
    s_nop 0
    buffer_load_dwordx4 v8, s[12:15], s68 offen offset:512 lds
    s_add_u32 m0, s70, 19840
    s_nop 0
    buffer_load_dwordx4 v8, s[12:15], s68 offen offset:640 lds
    s_add_u32 m0, s70, 23808
    s_nop 0
    buffer_load_dwordx4 v8, s[12:15], s68 offen offset:768 lds
    s_add_u32 m0, s70, 27776
    s_nop 0
    buffer_load_dwordx4 v8, s[12:15], s68 offen offset:896 lds
    s_add_u32 s68, s68, 1024
    s_add_u32 s70, s70, 32768
    s_cmp_ge_u32 s70, 163840
    s_cselect_b32 s4, 163840, 0
    s_sub_u32 s70, s70, s4
    s_waitcnt vmcnt(16)
    s_barrier
    v_add_u32 v4, s69, v9
    v_add_u32 v5, s69, v10
    v_add_u32 v6, s69, v11
    v_add_u32 v7, s69, v12
    s_add_u32 s69, s69, 32768
    s_cmp_ge_u32 s69, 163840
    s_cselect_b32 s69, 0, s69
    ds_read_b128 v[48:51], v4 offset:0
    ds_read_b128 v[52:55], v5 offset:0
    ds_read_b128 v[56:59], v6 offset:0
    ds_read_b128 v[60:63], v7 offset:0
    ds_read_b128 v[64:67], v4 offset:4096
    ds_read_b128 v[68:71], v5 offset:4096
    ds_read_b128 v[72:75], v6 offset:4096
    s_mov_b32 s71, 0
    s_mov_b32 s72, 0
L_A_v:
    s_waitcnt lgkmcnt(5)
    v_mfma_f32_32x32x16_bf16 v[16:31], v[48:51], a[0:3], 0
    ds_read_b128 v[76:79], v7 offset:4096
    s_add_u32 m0, s70, 0
    s_nop 0
    buffer_load_dwordx4 v8, s[12:15], s68 offen offset:0 lds
    v_mfma_f32_32x32x16_bf16 v[16:31], v[52:55], a[4:7], v[16:31]
    ds_read_b128 v[48:51], v4 offset:8192
    s_waitcnt lgkmcnt(5)
    v_mfma_f32_32x32x16_bf16 v[16:31], v[56:59], a[8:11], v[16:31]
    ds_read_b128 v[52:55], v5 offset:8192
    s_add_u32 m0, s70, 3968
    s_nop 0
    buffer_load_dwordx4 v8, s[12:15], s68 offen offset:128 lds
    v_mfma_f32_32x32x16_bf16 v[16:31], v[60:63], a[12:15], v[16:31]
    ds_read_b128 v[56:59], v6 offset:8192
    v_cvt_pk_bf16_f32 v80, v32, v33
    s_waitcnt lgkmcnt(5)
    v_mfma_f32_32x32x16_bf16 v[16:31], v[64:67], a[16:19], v[16:31]
    ds_read_b128 v[60:63], v7 offset:8192
    s_add_u32 m0, s70, 7936
    s_nop 0
    buffer_load_dwordx4 v8, s[12:15], s68 offen offset:256 lds
    v_cvt_pk_bf16_f32 v81, v34, v35
    v_mfma_f32_32x32x16_bf16 v[16:31], v[68:71], a[20:23], v[16:31]
    ds_read_b128 v[64:67], v4 offset:12288
    v_cvt_pk_bf16_f32 v82, v40, v41
    s_waitcnt lgkmcnt(5)
    v_mfma_f32_32x32x16_bf16 v[16:31], v[72:75], a[24:27], v[16:31]
    ds_read_b128 v[68:71], v5 offset:12288
    s_add_u32 m0, s70, 11904
    s_nop 0
    buffer_load_dwordx4 v8, s[12:15], s68 offen offset:384 lds
    v_cvt_pk_bf16_f32 v83, v42, v43
    v_mfma_f32_32x32x16_bf16 v[16:31], v[76:79], a[28:31], v[16:31]
    ds_read_b128 v[72:75], v6 offset:12288
    v_cvt_pk_bf16_f32 v84, v36, v37
    s_waitcnt lgkmcnt(5)
    v_mfma_f32_32x32x16_bf16 v[16:31], v[48:51], a[32:35], v[16:31]
    ds_read_b128 v[76:79], v7 offset:12288
    s_add_u32 m0, s70, 15872
    s_nop 0
    buffer_load_dwordx4 v8, s[12:15], s68 offen offset:512 lds
    v_cvt_pk_bf16_f32 v85, v38, v39
    v_mfma_f32_32x32x16_bf16 v[16:31], v[52:55], a[36:39], v[16:31]
    ds_read_b128 v[48:51], v4 offset:16384
    v_cvt_pk_bf16_f32 v86, v44, v45
    s_waitcnt lgkmcnt(5)
    v_mfma_f32_32x32x16_bf16 v[16:31], v[56:59], a[40:43], v[16:31]
    ds_read_b128 v[52:55], v5 offset:16384
    s_add_u32 m0, s70, 19840
    s_nop 0
    buffer_load_dwordx4 v8, s[12:15], s68 offen offset:640 lds
    v_cvt_pk_bf16_f32 v87, v46, v47
    v_mfma_f32_32x32x16_bf16 v[16:31], v[60:63], a[44:47], v[16:31]
    ds_read_b128 v[56:59], v6 offset:16384
    buffer_store_dwordx4 v[80:83], v14, s[8:11], s66 offen sc1
    s_waitcnt lgkmcnt(5)
    v_mfma_f32_32x32x16_bf16 v[16:31], v[64:67], a[48:51], v[16:31]
    ds_read_b128 v[60:63], v7 offset:16384
    s_add_u32 m0, s70, 23808
    s_nop 0
    buffer_load_dwordx4 v8, s[12:15], s68 offen offset:768 lds
    buffer_store_dwordx4 v[84:87], v14, s[8:11], s66 offen offset:512 sc1
    v_mfma_f32_32x32x16_bf16 v[16:31], v[68:71], a[52:55], v[16:31]
    ds_read_b128 v[64:67], v4 offset:20480
    v_mov_b32 v14, v13
    s_waitcnt lgkmcnt(5)
    v_mfma_f32_32x32x16_bf16 v[16:31], v[72:75], a[56:59], v[16:31]
    ds_read_b128 v[68:71], v5 offset:20480
    s_add_u32 m0, s70, 27776
    s_nop 0
    buffer_load_dwordx4 v8, s[12:15], s68 offen offset:896 lds
    s_add_u32 s66, s66, 262144
    v_mfma_f32_32x32x16_bf16 v[16:31], v[76:79], a[60:63], v[16:31]
    ds_read_b128 v[72:75], v6 offset:20480
    s_waitcnt lgkmcnt(5)
    v_mfma_f32_32x32x16_bf16 v[16:31], v[48:51], a[64:67], v[16:31]
    ds_read_b128 v[76:79], v7 offset:20480
    s_add_u32 s68, s68, 64512
    s_add_u32 s70, s70, 32768
    v_mfma_f32_32x32x16_bf16 v[16:31], v[52:55], a[68:71], v[16:31]
    ds_read_b128 v[48:51], v4 offset:24576
    s_waitcnt lgkmcnt(5)
    v_mfma_f32_32x32x16_bf16 v[16:31], v[56:59], a[72:75], v[16:31]
    ds_read_b128 v[52:55], v5 offset:24576
    s_cmp_ge_u32 s70, 163840
    s_cselect_b32 s4, 163840, 0
    s_sub_u32 s70, s70, s4
    v_mfma_f32_32x32x16_bf16 v[16:31], v[60:63], a[76:79], v[16:31]
    ds_read_b128 v[56:59], v6 offset:24576
    s_waitcnt lgkmcnt(5)
    v_mfma_f32_32x32x16_bf16 v[16:31], v[64:67], a[80:83], v[16:31]
    ds_read_b128 v[60:63], v7 offset:24576
    v_mfma_f32_32x32x16_bf16 v[16:31], v[68:71], a[84:87], v[16:31]
    ds_read_b128 v[64:67], v4 offset:28672
    s_waitcnt lgkmcnt(5)
    v_mfma_f32_32x32x16_bf16 v[16:31], v[72:75], a[88:91], v[16:31]
    ds_read_b128 v[68:71], v5 offset:28672
    v_mfma_f32_32x32x16_bf16 v[16:31], v[76:79], a[92:95], v[16:31]
    ds_read_b128 v[72:75], v6 offset:28672
    s_waitcnt lgkmcnt(5)
    v_mfma_f32_32x32x16_bf16 v[16:31], v[48:51], a[96:99], v[16:31]
    ds_read_b128 v[76:79], v7 offset:28672
    v_mfma_f32_32x32x16_bf16 v[16:31], v[52:55], a[100:103], v[16:31]
    s_waitcnt vmcnt(16)
    s_barrier
    v_add_u32 v4, s69, v9
    v_add_u32 v5, s69, v10
    v_add_u32 v6, s69, v11
    v_add_u32 v7, s69, v12
    s_add_u32 s69, s69, 32768
    s_cmp_ge_u32 s69, 163840
    s_cselect_b32 s69, 0, s69
    ds_read_b128 v[48:51], v4 offset:0
    s_waitcnt lgkmcnt(5)
    v_mfma_f32_32x32x16_bf16 v[16:31], v[56:59], a[104:107], v[16:31]
    ds_read_b128 v[52:55], v5 offset:0
    v_mfma_f32_32x32x16_bf16 v[16:31], v[60:63], a[108:111], v[16:31]
    ds_read_b128 v[56:59], v6 offset:0
    v_mov_b32 v2, s72
    buffer_store_dword v2, v15, s[8:11], s67 offen sc1
    s_waitcnt lgkmcnt(5)
    v_mfma_f32_32x32x16_bf16 v[16:31], v[64:67], a[112:115], v[16:31]
    ds_read_b128 v[60:63], v7 offset:0
    v_mfma_f32_32x32x16_bf16 v[16:31], v[68:71], a[116:119], v[16:31]
    ds_read_b128 v[64:67], v4 offset:4096
    s_waitcnt lgkmcnt(5)
    v_mfma_f32_32x32x16_bf16 v[16:31], v[72:75], a[120:123], v[16:31]
    ds_read_b128 v[68:71], v5 offset:4096
    v_mfma_f32_32x32x16_bf16 v[16:31], v[76:79], a[124:127], v[16:31]
    ds_read_b128 v[72:75], v6 offset:4096
    s_waitcnt lgkmcnt(5)
    v_mfma_f32_32x32x16_bf16 v[16:31], v[48:51], a[128:131], v[16:31]
    ds_read_b128 v[76:79], v7 offset:4096
    s_add_u32 m0, s70, 0
    s_nop 0
    buffer_load_dwordx4 v8, s[12:15], s68 offen offset:0 lds
    v_mfma_f32_32x32x16_bf16 v[16:31], v[52:55], a[132:135], v[16:31]
    ds_read_b128 v[48:51], v4 offset:8192
    s_waitcnt lgkmcnt(5)
    v_mfma_f32_32x32x16_bf16 v[16:31], v[56:59], a[136:139], v[16:31]
    ds_read_b128 v[52:55], v5 offset:8192
    s_add_u32 m0, s70, 3968
    s_nop 0
    buffer_load_dwordx4 v8, s[12:15], s68 offen offset:128 lds
    v_mfma_f32_32x32x16_bf16 v[16:31], v[60:63], a[140:143], v[16:31]
    ds_read_b128 v[56:59], v6 offset:8192
    s_waitcnt lgkmcnt(5)
    v_mfma_f32_32x32x16_bf16 v[16:31], v[64:67], a[144:147], v[16:31]
    ds_read_b128 v[60:63], v7 offset:8192
    s_add_u32 m0, s70, 7936
    s_nop 0
    buffer_load_dwordx4 v8, s[12:15], s68 offen offset:256 lds
    v_mfma_f32_32x32x16_bf16 v[16:31], v[68:71], a[148:151], v[16:31]
    ds_read_b128 v[64:67], v4 offset:12288
    s_waitcnt lgkmcnt(5)
    v_mfma_f32_32x32x16_bf16 v[16:31], v[72:75], a[152:155], v[16:31]
    ds_read_b128 v[68:71], v5 offset:12288
    s_add_u32 m0, s70, 11904
    s_nop 0
    buffer_load_dwordx4 v8, s[12:15], s68 offen offset:384 lds
    v_mfma_f32_32x32x16_bf16 v[16:31], v[76:79], a[156:159], v[16:31]
    ds_read_b128 v[72:75], v6 offset:12288
    s_waitcnt lgkmcnt(5)
    v_mfma_f32_32x32x16_bf16 v[16:31], v[48:51], a[160:163], v[16:31]
    ds_read_b128 v[76:79], v7 offset:12288
    s_add_u32 m0, s70, 15872
    s_nop 0
    buffer_load_dwordx4 v8, s[12:15], s68 offen offset:512 lds
    v_mfma_f32_32x32x16_bf16 v[16:31], v[52:55], a[164:167], v[16:31]
    ds_read_b128 v[48:51], v4 offset:16384
    s_waitcnt lgkmcnt(5)
    v_mfma_f32_32x32x16_bf16 v[16:31], v[56:59], a[168:171], v[16:31]
    ds_read_b128 v[52:55], v5 offset:16384
    s_add_u32 m0, s70, 19840
    s_nop 0
    buffer_load_dwordx4 v8, s[12:15], s68 offen offset:640 lds
    v_mfma_f32_32x32x16_bf16 v[16:31], v[60:63], a[172:175], v[16:31]
    ds_read_b128 v[56:59], v6 offset:16384
    s_waitcnt lgkmcnt(5)
    v_mfma_f32_32x32x16_bf16 v[16:31], v[64:67], a[176:179], v[16:31]
    ds_read_b128 v[60:63], v7 offset:16384
    s_add_u32 m0, s70, 23808
    s_nop 0
    buffer_load_dwordx4 v8, s[12:15], s68 offen offset:768 lds
    v_mfma_f32_32x32x16_bf16 v[16:31], v[68:71], a[180:183], v[16:31]
    ds_read_b128 v[64:67], v4 offset:20480
    s_waitcnt lgkmcnt(5)
    v_mfma_f32_32x32x16_bf16 v[16:31], v[72:75], a[184:187], v[16:31]
    ds_read_b128 v[68:71], v5 offset:20480
    s_add_u32 m0, s70, 27776
    s_nop 0
    buffer_load_dwordx4 v8, s[12:15], s68 offen offset:896 lds
    v_mfma_f32_32x32x16_bf16 v[16:31], v[76:79], a[188:191], v[16:31]
    ds_read_b128 v[72:75], v6 offset:20480
    s_waitcnt lgkmcnt(5)
    v_mfma_f32_32x32x16_bf16 v[16:31], v[48:51], a[192:195], v[16:31]
    ds_read_b128 v[76:79], v7 offset:20480
    s_add_u32 s68, s68, 1024
    s_add_u32 s70, s70, 32768
    v_mfma_f32_32x32x16_bf16 v[16:31], v[52:55], a[196:199], v[16:31]
    ds_read_b128 v[48:51], v4 offset:24576
    s_waitcnt lgkmcnt(5)
    v_mfma_f32_32x32x16_bf16 v[16:31], v[56:59], a[200:203], v[16:31]
    ds_read_b128 v[52:55], v5 offset:24576
    s_cmp_ge_u32 s70, 163840
    s_cselect_b32 s4, 163840, 0
    s_sub_u32 s70, s70, s4
    v_mfma_f32_32x32x16_bf16 v[16:31], v[60:63], a[204:207], v[16:31]
    ds_read_b128 v[56:59], v6 offset:24576
    s_waitcnt lgkmcnt(5)
    v_mfma_f32_32x32x16_bf16 v[16:31], v[64:67], a[208:211], v[16:31]
    ds_read_b128 v[60:63], v7 offset:24576
    v_mfma_f32_32x32x16_bf16 v[16:31], v[68:71], a[212:215], v[16:31]
    ds_read_b128 v[64:67], v4 offset:28672
    s_waitcnt lgkmcnt(5)
    v_mfma_f32_32x32x16_bf16 v[16:31], v[72:75], a[216:219], v[16:31]
    ds_read_b128 v[68:71], v5 offset:28672
    v_mfma_f32_32x32x16_bf16 v[16:31], v[76:79], a[220:223], v[16:31]
    ds_read_b128 v[72:75], v6 offset:28672
    s_waitcnt lgkmcnt(5)
    v_mfma_f32_32x32x16_bf16 v[16:31], v[48:51], a[224:227], v[16:31]
    ds_read_b128 v[76:79], v7 offset:28672
    v_mfma_f32_32x32x16_bf16 v[16:31], v[52:55], a[228:231], v[16:31]
    s_waitcnt vmcnt(16)
    s_barrier
    v_add_u32 v4, s69, v9
    v_add_u32 v5, s69, v10
    v_add_u32 v6, s69, v11
    v_add_u32 v7, s69, v12
    s_add_u32 s69, s69, 32768
    s_cmp_ge_u32 s69, 163840
    s_cselect_b32 s69, 0, s69
    ds_read_b128 v[48:51], v4 offset:0
    s_waitcnt lgkmcnt(5)
    v_mfma_f32_32x32x16_bf16 v[16:31], v[56:59], a[232:235], v[16:31]
    ds_read_b128 v[52:55], v5 offset:0
    v_mfma_f32_32x32x16_bf16 v[16:31], v[60:63], a[236:239], v[16:31]
    ds_read_b128 v[56:59], v6 offset:0
    s_waitcnt lgkmcnt(5)
    v_mfma_f32_32x32x16_bf16 v[16:31], v[64:67], a[240:243], v[16:31]
    ds_read_b128 v[60:63], v7 offset:0
    v_mfma_f32_32x32x16_bf16 v[16:31], v[68:71], a[244:247], v[16:31]
    ds_read_b128 v[64:67], v4 offset:4096
    s_waitcnt lgkmcnt(5)
    v_mfma_f32_32x32x16_bf16 v[16:31], v[72:75], a[248:251], v[16:31]
    ds_read_b128 v[68:71], v5 offset:4096
    v_mfma_f32_32x32x16_bf16 v[16:31], v[76:79], a[252:255], v[16:31]
    ds_read_b128 v[72:75], v6 offset:4096
    s_add_u32 s72, s71, 0
    s_waitcnt lgkmcnt(5)
    v_mfma_f32_32x32x16_bf16 v[32:47], v[48:51], a[0:3], 0
    ds_read_b128 v[76:79], v7 offset:4096
    s_add_u32 m0, s70, 0
    s_nop 0
    buffer_load_dwordx4 v8, s[12:15], s68 offen offset:0 lds
    v_mfma_f32_32x32x16_bf16 v[32:47], v[52:55], a[4:7], v[32:47]
    ds_read_b128 v[48:51], v4 offset:8192
    s_waitcnt lgkmcnt(5)
    v_mfma_f32_32x32x16_bf16 v[32:47], v[56:59], a[8:11], v[32:47]
    ds_read_b128 v[52:55], v5 offset:8192
    s_add_u32 m0, s70, 3968
    s_nop 0
    buffer_load_dwordx4 v8, s[12:15], s68 offen offset:128 lds
    v_mfma_f32_32x32x16_bf16 v[32:47], v[60:63], a[12:15], v[32:47]
    ds_read_b128 v[56:59], v6 offset:8192
    v_cvt_pk_bf16_f32 v80, v16, v17
    s_waitcnt lgkmcnt(5)
    v_mfma_f32_32x32x16_bf16 v[32:47], v[64:67], a[16:19], v[32:47]
    ds_read_b128 v[60:63], v7 offset:8192
    s_add_u32 m0, s70, 7936
    s_nop 0
    buffer_load_dwordx4 v8, s[12:15], s68 offen offset:256 lds
    v_cvt_pk_bf16_f32 v81, v18, v19
    v_mfma_f32_32x32x16_bf16 v[32:47], v[68:71], a[20:23], v[32:47]
    ds_read_b128 v[64:67], v4 offset:12288
    v_cvt_pk_bf16_f32 v82, v24, v25
    s_waitcnt lgkmcnt(5)
    v_mfma_f32_32x32x16_bf16 v[32:47], v[72:75], a[24:27], v[32:47]
    ds_read_b128 v[68:71], v5 offset:12288
    s_add_u32 m0, s70, 11904
    s_nop 0
    buffer_load_dwordx4 v8, s[12:15], s68 offen offset:384 lds
    v_cvt_pk_bf16_f32 v83, v26, v27
    v_mfma_f32_32x32x16_bf16 v[32:47], v[76:79], a[28:31], v[32:47]
    ds_read_b128 v[72:75], v6 offset:12288
    v_cvt_pk_bf16_f32 v84, v20, v21
    s_waitcnt lgkmcnt(5)
    v_mfma_f32_32x32x16_bf16 v[32:47], v[48:51], a[32:35], v[32:47]
    ds_read_b128 v[76:79], v7 offset:12288
    s_add_u32 m0, s70, 15872
    s_nop 0
    buffer_load_dwordx4 v8, s[12:15], s68 offen offset:512 lds
    v_cvt_pk_bf16_f32 v85, v22, v23
    v_mfma_f32_32x32x16_bf16 v[32:47], v[52:55], a[36:39], v[32:47]
    ds_read_b128 v[48:51], v4 offset:16384
    v_cvt_pk_bf16_f32 v86, v28, v29
    s_waitcnt lgkmcnt(5)
    v_mfma_f32_32x32x16_bf16 v[32:47], v[56:59], a[40:43], v[32:47]
    ds_read_b128 v[52:55], v5 offset:16384
    s_add_u32 m0, s70, 19840
    s_nop 0
    buffer_load_dwordx4 v8, s[12:15], s68 offen offset:640 lds
    v_cvt_pk_bf16_f32 v87, v30, v31
    v_mfma_f32_32x32x16_bf16 v[32:47], v[60:63], a[44:47], v[32:47]
    ds_read_b128 v[56:59], v6 offset:16384
    buffer_store_dwordx4 v[80:83], v14, s[8:11], s66 offen sc1
    s_waitcnt lgkmcnt(5)
    v_mfma_f32_32x32x16_bf16 v[32:47], v[64:67], a[48:51], v[32:47]
    ds_read_b128 v[60:63], v7 offset:16384
    s_add_u32 m0, s70, 23808
    s_nop 0
    buffer_load_dwordx4 v8, s[12:15], s68 offen offset:768 lds
    buffer_store_dwordx4 v[84:87], v14, s[8:11], s66 offen offset:512 sc1
    v_mfma_f32_32x32x16_bf16 v[32:47], v[68:71], a[52:55], v[32:47]
    ds_read_b128 v[64:67], v4 offset:20480
    v_mov_b32 v14, v13
    s_waitcnt lgkmcnt(5)
    v_mfma_f32_32x32x16_bf16 v[32:47], v[72:75], a[56:59], v[32:47]
    ds_read_b128 v[68:71], v5 offset:20480
    s_add_u32 m0, s70, 27776
    s_nop 0
    buffer_load_dwordx4 v8, s[12:15], s68 offen offset:896 lds
    s_add_u32 s66, s66, 262144
    v_mfma_f32_32x32x16_bf16 v[32:47], v[76:79], a[60:63], v[32:47]
    ds_read_b128 v[72:75], v6 offset:20480
    s_waitcnt lgkmcnt(5)
    v_mfma_f32_32x32x16_bf16 v[32:47], v[48:51], a[64:67], v[32:47]
    ds_read_b128 v[76:79], v7 offset:20480
    s_add_u32 s68, s68, 64512
    s_add_u32 s70, s70, 32768
    v_mfma_f32_32x32x16_bf16 v[32:47], v[52:55], a[68:71], v[32:47]
    ds_read_b128 v[48:51], v4 offset:24576
    s_waitcnt lgkmcnt(5)
    v_mfma_f32_32x32x16_bf16 v[32:47], v[56:59], a[72:75], v[32:47]
    ds_read_b128 v[52:55], v5 offset:24576
    s_cmp_ge_u32 s70, 163840
    s_cselect_b32 s4, 163840, 0
    s_sub_u32 s70, s70, s4
    v_mfma_f32_32x32x16_bf16 v[32:47], v[60:63], a[76:79], v[32:47]
    ds_read_b128 v[56:59], v6 offset:24576
    s_waitcnt lgkmcnt(5)
    v_mfma_f32_32x32x16_bf16 v[32:47], v[64:67], a[80:83], v[32:47]
    ds_read_b128 v[60:63], v7 offset:24576
    v_mfma_f32_32x32x16_bf16 v[32:47], v[68:71], a[84:87], v[32:47]
    ds_read_b128 v[64:67], v4 offset:28672
    s_waitcnt lgkmcnt(5)
    v_mfma_f32_32x32x16_bf16 v[32:47], v[72:75], a[88:91], v[32:47]
    ds_read_b128 v[68:71], v5 offset:28672
    v_mfma_f32_32x32x16_bf16 v[32:47], v[76:79], a[92:95], v[32:47]
    ds_read_b128 v[72:75], v6 offset:28672
    s_waitcnt lgkmcnt(5)
    v_mfma_f32_32x32x16_bf16 v[32:47], v[48:51], a[96:99], v[32:47]
    ds_read_b128 v[76:79], v7 offset:28672
    v_mfma_f32_32x32x16_bf16 v[32:47], v[52:55], a[100:103], v[32:47]
    s_waitcnt vmcnt(16)
    s_barrier
    v_add_u32 v4, s69, v9
    v_add_u32 v5, s69, v10
    v_add_u32 v6, s69, v11
    v_add_u32 v7, s69, v12
    s_add_u32 s69, s69, 32768
    s_cmp_ge_u32 s69, 163840
    s_cselect_b32 s69, 0, s69
    ds_read_b128 v[48:51], v4 offset:0
    s_waitcnt lgkmcnt(5)
    v_mfma_f32_32x32x16_bf16 v[32:47], v[56:59], a[104:107], v[32:47]
    ds_read_b128 v[52:55], v5 offset:0
    v_mfma_f32_32x32x16_bf16 v[32:47], v[60:63], a[108:111], v[32:47]
    ds_read_b128 v[56:59], v6 offset:0
    v_mov_b32 v2, s72
    buffer_store_dword v2, v15, s[8:11], s67 offen sc1
    s_waitcnt lgkmcnt(5)
    v_mfma_f32_32x32x16_bf16 v[32:47], v[64:67], a[112:115], v[32:47]
    ds_read_b128 v[60:63], v7 offset:0
    v_mfma_f32_32x32x16_bf16 v[32:47], v[68:71], a[116:119], v[32:47]
    ds_read_b128 v[64:67], v4 offset:4096
    s_waitcnt lgkmcnt(5)
    v_mfma_f32_32x32x16_bf16 v[32:47], v[72:75], a[120:123], v[32:47]
    ds_read_b128 v[68:71], v5 offset:4096
    v_mfma_f32_32x32x16_bf16 v[32:47], v[76:79], a[124:127], v[32:47]
    ds_read_b128 v[72:75], v6 offset:4096
    s_waitcnt lgkmcnt(5)
    v_mfma_f32_32x32x16_bf16 v[32:47], v[48:51], a[128:131], v[32:47]
    ds_read_b128 v[76:79], v7 offset:4096
    s_add_u32 m0, s70, 0
    s_nop 0
    buffer_load_dwordx4 v8, s[12:15], s68 offen offset:0 lds
    v_mfma_f32_32x32x16_bf16 v[32:47], v[52:55], a[132:135], v[32:47]
    ds_read_b128 v[48:51], v4 offset:8192
    s_waitcnt lgkmcnt(5)
    v_mfma_f32_32x32x16_bf16 v[32:47], v[56:59], a[136:139], v[32:47]
    ds_read_b128 v[52:55], v5 offset:8192
    s_add_u32 m0, s70, 3968
    s_nop 0
    buffer_load_dwordx4 v8, s[12:15], s68 offen offset:128 lds
    v_mfma_f32_32x32x16_bf16 v[32:47], v[60:63], a[140:143], v[32:47]
    ds_read_b128 v[56:59], v6 offset:8192
    s_waitcnt lgkmcnt(5)
    v_mfma_f32_32x32x16_bf16 v[32:47], v[64:67], a[144:147], v[32:47]
    ds_read_b128 v[60:63], v7 offset:8192
    s_add_u32 m0, s70, 7936
    s_nop 0
    buffer_load_dwordx4 v8, s[12:15], s68 offen offset:256 lds
    v_mfma_f32_32x32x16_bf16 v[32:47], v[68:71], a[148:151], v[32:47]
    ds_read_b128 v[64:67], v4 offset:12288
    s_waitcnt lgkmcnt(5)
    v_mfma_f32_32x32x16_bf16 v[32:47], v[72:75], a[152:155], v[32:47]
    ds_read_b128 v[68:71], v5 offset:12288
    s_add_u32 m0, s70, 11904
    s_nop 0
    buffer_load_dwordx4 v8, s[12:15], s68 offen offset:384 lds
    v_mfma_f32_32x32x16_bf16 v[32:47], v[76:79], a[156:159], v[32:47]
    ds_read_b128 v[72:75], v6 offset:12288
    s_waitcnt lgkmcnt(5)
    v_mfma_f32_32x32x16_bf16 v[32:47], v[48:51], a[160:163], v[32:47]
    ds_read_b128 v[76:79], v7 offset:12288
    s_add_u32 m0, s70, 15872
    s_nop 0
    buffer_load_dwordx4 v8, s[12:15], s68 offen offset:512 lds
    v_mfma_f32_32x32x16_bf16 v[32:47], v[52:55], a[164:167], v[32:47]
    ds_read_b128 v[48:51], v4 offset:16384
    s_waitcnt lgkmcnt(5)
    v_mfma_f32_32x32x16_bf16 v[32:47], v[56:59], a[168:171], v[32:47]
    ds_read_b128 v[52:55], v5 offset:16384
    s_add_u32 m0, s70, 19840
    s_nop 0
    buffer_load_dwordx4 v8, s[12:15], s68 offen offset:640 lds
    v_mfma_f32_32x32x16_bf16 v[32:47], v[60:63], a[172:175], v[32:47]
    ds_read_b128 v[56:59], v6 offset:16384
    s_waitcnt lgkmcnt(5)
    v_mfma_f32_32x32x16_bf16 v[32:47], v[64:67], a[176:179], v[32:47]
    ds_read_b128 v[60:63], v7 offset:16384
    s_add_u32 m0, s70, 23808
    s_nop 0
    buffer_load_dwordx4 v8, s[12:15], s68 offen offset:768 lds
    v_mfma_f32_32x32x16_bf16 v[32:47], v[68:71], a[180:183], v[32:47]
    ds_read_b128 v[64:67], v4 offset:20480
    s_waitcnt lgkmcnt(5)
    v_mfma_f32_32x32x16_bf16 v[32:47], v[72:75], a[184:187], v[32:47]
    ds_read_b128 v[68:71], v5 offset:20480
    s_add_u32 m0, s70, 27776
    s_nop 0
    buffer_load_dwordx4 v8, s[12:15], s68 offen offset:896 lds
    v_mfma_f32_32x32x16_bf16 v[32:47], v[76:79], a[188:191], v[32:47]
    ds_read_b128 v[72:75], v6 offset:20480
    s_waitcnt lgkmcnt(5)
    v_mfma_f32_32x32x16_bf16 v[32:47], v[48:51], a[192:195], v[32:47]
    ds_read_b128 v[76:79], v7 offset:20480
    s_add_u32 s68, s68, 1024
    s_add_u32 s70, s70, 32768
    v_mfma_f32_32x32x16_bf16 v[32:47], v[52:55], a[196:199], v[32:47]
    ds_read_b128 v[48:51], v4 offset:24576
    s_waitcnt lgkmcnt(5)
    v_mfma_f32_32x32x16_bf16 v[32:47], v[56:59], a[200:203], v[32:47]
    ds_read_b128 v[52:55], v5 offset:24576
    s_cmp_ge_u32 s70, 163840
    s_cselect_b32 s4, 163840, 0
    s_sub_u32 s70, s70, s4
    v_mfma_f32_32x32x16_bf16 v[32:47], v[60:63], a[204:207], v[32:47]
    ds_read_b128 v[56:59], v6 offset:24576
    s_waitcnt lgkmcnt(5)
    v_mfma_f32_32x32x16_bf16 v[32:47], v[64:67], a[208:211], v[32:47]
    ds_read_b128 v[60:63], v7 offset:24576
    v_mfma_f32_32x32x16_bf16 v[32:47], v[68:71], a[212:215], v[32:47]
    ds_read_b128 v[64:67], v4 offset:28672
    s_waitcnt lgkmcnt(5)
    v_mfma_f32_32x32x16_bf16 v[32:47], v[72:75], a[216:219], v[32:47]
    ds_read_b128 v[68:71], v5 offset:28672
    v_mfma_f32_32x32x16_bf16 v[32:47], v[76:79], a[220:223], v[32:47]
    ds_read_b128 v[72:75], v6 offset:28672
    s_waitcnt lgkmcnt(5)
    v_mfma_f32_32x32x16_bf16 v[32:47], v[48:51], a[224:227], v[32:47]
    ds_read_b128 v[76:79], v7 offset:28672
    v_mfma_f32_32x32x16_bf16 v[32:47], v[52:55], a[228:231], v[32:47]
    s_waitcnt vmcnt(16)
    s_barrier
    v_add_u32 v4, s69, v9
    v_add_u32 v5, s69, v10
    v_add_u32 v6, s69, v11
    v_add_u32 v7, s69, v12
    s_add_u32 s69, s69, 32768
    s_cmp_ge_u32 s69, 163840
    s_cselect_b32 s69, 0, s69
    ds_read_b128 v[48:51], v4 offset:0
    s_waitcnt lgkmcnt(5)
    v_mfma_f32_32x32x16_bf16 v[32:47], v[56:59], a[232:235], v[32:47]
    ds_read_b128 v[52:55], v5 offset:0
    v_mfma_f32_32x32x16_bf16 v[32:47], v[60:63], a[236:239], v[32:47]
    ds_read_b128 v[56:59], v6 offset:0
    s_waitcnt lgkmcnt(5)
    v_mfma_f32_32x32x16_bf16 v[32:47], v[64:67], a[240:243], v[32:47]
    ds_read_b128 v[60:63], v7 offset:0
    v_mfma_f32_32x32x16_bf16 v[32:47], v[68:71], a[244:247], v[32:47]
    ds_read_b128 v[64:67], v4 offset:4096
    s_waitcnt lgkmcnt(5)
    v_mfma_f32_32x32x16_bf16 v[32:47], v[72:75], a[248:251], v[32:47]
    ds_read_b128 v[68:71], v5 offset:4096
    v_mfma_f32_32x32x16_bf16 v[32:47], v[76:79], a[252:255], v[32:47]
    ds_read_b128 v[72:75], v6 offset:4096
    s_add_u32 s72, s71, 1
    s_add_u32 s71, s71, 2
    s_cmp_lt_u32 s71, 64
    s_cbranch_scc1 L_A_v
    s_nop 6
    v_cvt_pk_bf16_f32 v80, v32, v33
    v_cvt_pk_bf16_f32 v81, v34, v35
    v_cvt_pk_bf16_f32 v82, v40, v41
    v_cvt_pk_bf16_f32 v83, v42, v43
    v_cvt_pk_bf16_f32 v84, v36, v37
    v_cvt_pk_bf16_f32 v85, v38, v39
    v_cvt_pk_bf16_f32 v86, v44, v45
    v_cvt_pk_bf16_f32 v87, v46, v47
    buffer_store_dwordx4 v[80:83], v14, s[8:11], s66 offen sc1
    buffer_store_dwordx4 v[84:87], v14, s[8:11], s66 offen offset:512 sc1
    v_mov_b32 v14, v13
    s_add_u32 s66, s66, 262144
    s_waitcnt vmcnt(0) lgkmcnt(0)
    v_mov_b32 v2, 64
    buffer_store_dword v2, v15, s[8:11], s67 offen sc1
    s_branch L_phase2
L_gate:
    s_mov_b32 s28, s54
    s_and_b32 s29, s55, 0xffff
    s_mov_b32 s30, 2048
    s_mov_b32 s31, 0x20000
    s_waitcnt vmcnt(0)
    s_barrier
    s_cmp_lg_u32 s63, 0
    s_cbranch_scc1 L_arr_51
    v_mov_b32 v2, 1
    buffer_atomic_add v2, v15, s[24:27], 0 offen offset:8 sc1
L_arr_51:
    s_lshl_b32 s67, s62, 7
    s_lshl_b32 s4, s63, 2
    s_add_u32 s67, s67, s4
    s_add_u32 s67, s67, 104923136
    buffer_load_dwordx4 v[16:19], v1, s[28:31], 0 offen
    buffer_load_dwordx4 v[20:23], v1, s[28:31], 0 offen offset:1024
    s_sub_u32 s66, s62, 216
    s_lshl_b32 s66, s66, 2
    s_add_u32 s66, s66, s63
    s_lshl_b32 s68, s66, 17
    s_lshl_b32 s66, s66, 8
    s_add_u32 s66, s66, 104857600
    s_mov_b32 s71, 0
    v_mov_b32 v8, 0
    s_waitcnt vmcnt(0)
    v_lshlrev_b32 v24, 16, v16
    v_and_b32 v25, 0xffff0000, v16
    v_lshlrev_b32 v26, 16, v17
    v_and_b32 v27, 0xffff0000, v17
    v_lshlrev_b32 v28, 16, v18
    v_and_b32 v29, 0xffff0000, v18
    v_lshlrev_b32 v30, 16, v19
    v_and_b32 v31, 0xffff0000, v19
    v_lshlrev_b32 v32, 16, v20
    v_and_b32 v33, 0xffff0000, v20
    v_lshlrev_b32 v34, 16, v21
    v_and_b32 v35, 0xffff0000, v21
    v_lshlrev_b32 v36, 16, v22
    v_and_b32 v37, 0xffff0000, v22
    v_lshlrev_b32 v38, 16, v23
    v_and_b32 v39, 0xffff0000, v23
L_gate_loop:
    buffer_load_dwordx4 v[48:51], v1, s[12:15], s68 offen offset:0
    buffer_load_dwordx4 v[52:55], v1, s[12:15], s68 offen offset:1024
    buffer_load_dwordx4 v[56:59], v1, s[12:15], s68 offen offset:2048
    buffer_load_dwordx4 v[60:63], v1, s[12:15], s68 offen offset:3072
    s_add_u32 s68, s68, 4096
    buffer_load_dwordx4 v[64:67], v1, s[12:15], s68 offen offset:0
    buffer_load_dwordx4 v[68:71], v1, s[12:15], s68 offen offset:1024
    buffer_load_dwordx4 v[72:75], v1, s[12:15], s68 offen offset:2048
    buffer_load_dwordx4 v[76:79], v1, s[12:15], s68 offen offset:3072
    s_add_u32 s68, s68, 4096
    s_waitcnt vmcnt(6)
    v_mov_b32 v4, 0
    v_mov_b32 v5, 0
    v_lshlrev_b32 v2, 16, v48
    v_and_b32 v3, 0xffff0000, v48
    v_mul_f32 v2, v2, v24
    v_mul_f32 v3, v3, v25
    v_cvt_pk_bf16_f32 v3, v2, v3
    v_lshlrev_b32 v2, 16, v3
    v_and_b32 v3, 0xffff0000, v3
    v_add_f32 v4, v4, v2
    v_add_f32 v5, v5, v3
    v_lshlrev_b32 v2, 16, v49
    v_and_b32 v3, 0xffff0000, v49
    v_mul_f32 v2, v2, v26
    v_mul_f32 v3, v3, v27
    v_cvt_pk_bf16_f32 v3, v2, v3
    v_lshlrev_b32 v2, 16, v3
    v_and_b32 v3, 0xffff0000, v3
    v_add_f32 v4, v4, v2
    v_add_f32 v5, v5, v3
    v_lshlrev_b32 v2, 16, v50
    v_and_b32 v3, 0xffff0000, v50
    v_mul_f32 v2, v2, v28
    v_mul_f32 v3, v3, v29
    v_cvt_pk_bf16_f32 v3, v2, v3
    v_lshlrev_b32 v2, 16, v3
    v_and_b32 v3, 0xffff0000, v3
    v_add_f32 v4, v4, v2
    v_add_f32 v5, v5, v3
    v_lshlrev_b32 v2, 16, v51
    v_and_b32 v3, 0xffff0000, v51
    v_mul_f32 v2, v2, v30
    v_mul_f32 v3, v3, v31
    v_cvt_pk_bf16_f32 v3, v2, v3
    v_lshlrev_b32 v2, 16, v3
    v_and_b32 v3, 0xffff0000, v3
    v_add_f32 v4, v4, v2
    v_add_f32 v5, v5, v3
    v_lshlrev_b32 v2, 16, v52
    v_and_b32 v3, 0xffff0000, v52
    v_mul_f32 v2, v2, v32
    v_mul_f32 v3, v3, v33
    v_cvt_pk_bf16_f32 v3, v2, v3
    v_lshlrev_b32 v2, 16, v3
    v_and_b32 v3, 0xffff0000, v3
    v_add_f32 v4, v4, v2
    v_add_f32 v5, v5, v3
    v_lshlrev_b32 v2, 16, v53
    v_and_b32 v3, 0xffff0000, v53
    v_mul_f32 v2, v2, v34
    v_mul_f32 v3, v3, v35
    v_cvt_pk_bf16_f32 v3, v2, v3
    v_lshlrev_b32 v2, 16, v3
    v_and_b32 v3, 0xffff0000, v3
    v_add_f32 v4, v4, v2
    v_add_f32 v5, v5, v3
    v_lshlrev_b32 v2, 16, v54
    v_and_b32 v3, 0xffff0000, v54
    v_mul_f32 v2, v2, v36
    v_mul_f32 v3, v3, v37
    v_cvt_pk_bf16_f32 v3, v2, v3
    v_lshlrev_b32 v2, 16, v3
    v_and_b32 v3, 0xffff0000, v3
    v_add_f32 v4, v4, v2
    v_add_f32 v5, v5, v3
    v_lshlrev_b32 v2, 16, v55
    v_and_b32 v3, 0xffff0000, v55
    v_mul_f32 v2, v2, v38
    v_mul_f32 v3, v3, v39
    v_cvt_pk_bf16_f32 v3, v2, v3
    v_lshlrev_b32 v2, 16, v3
    v_and_b32 v3, 0xffff0000, v3
    v_add_f32 v4, v4, v2
    v_add_f32 v5, v5, v3
    v_add_f32 v4, v4, v5
    s_nop 1
    v_add_f32_dpp v4, v4, v4 quad_perm:[1,0,3,2] row_mask:0xf bank_mask:0xf
    s_nop 1
    v_add_f32_dpp v4, v4, v4 quad_perm:[2,3,0,1] row_mask:0xf bank_mask:0xf
    s_nop 1
    v_add_f32_dpp v4, v4, v4 row_ror:4 row_mask:0xf bank_mask:0xf
    s_nop 1
    v_add_f32_dpp v4, v4, v4 row_ror:8 row_mask:0xf bank_mask:0xf
    v_mov_b32 v5, v4
    s_nop 1
    v_permlane16_swap_b32 v5, v4
    v_add_f32 v4, v4, v5
    v_mov_b32 v5, v4
    s_nop 1
    v_permlane32_swap_b32 v5, v4
    v_add_f32 v4, v4, v5
    v_cmp_eq_u32 vcc, s71, v0
    s_nop 1
    v_cndmask_b32 v8, v8, v4, vcc
    s_add_u32 s71, s71, 1
    s_waitcnt vmcnt(4)
    v_mov_b32 v4, 0
    v_mov_b32 v5, 0
    v_lshlrev_b32 v2, 16, v56
    v_and_b32 v3, 0xffff0000, v56
    v_mul_f32 v2, v2, v24
    v_mul_f32 v3, v3, v25
    v_cvt_pk_bf16_f32 v3, v2, v3
    v_lshlrev_b32 v2, 16, v3
    v_and_b32 v3, 0xffff0000, v3
    v_add_f32 v4, v4, v2
    v_add_f32 v5, v5, v3
    v_lshlrev_b32 v2, 16, v57
    v_and_b32 v3, 0xffff0000, v57
    v_mul_f32 v2, v2, v26
    v_mul_f32 v3, v3, v27
    v_cvt_pk_bf16_f32 v3, v2, v3
    v_lshlrev_b32 v2, 16, v3
    v_and_b32 v3, 0xffff0000, v3
    v_add_f32 v4, v4, v2
    v_add_f32 v5, v5, v3
    v_lshlrev_b32 v2, 16, v58
    v_and_b32 v3, 0xffff0000, v58
    v_mul_f32 v2, v2, v28
    v_mul_f32 v3, v3, v29
    v_cvt_pk_bf16_f32 v3, v2, v3
    v_lshlrev_b32 v2, 16, v3
    v_and_b32 v3, 0xffff0000, v3
    v_add_f32 v4, v4, v2
    v_add_f32 v5, v5, v3
    v_lshlrev_b32 v2, 16, v59
    v_and_b32 v3, 0xffff0000, v59
    v_mul_f32 v2, v2, v30
    v_mul_f32 v3, v3, v31
    v_cvt_pk_bf16_f32 v3, v2, v3
    v_lshlrev_b32 v2, 16, v3
    v_and_b32 v3, 0xffff0000, v3
    v_add_f32 v4, v4, v2
    v_add_f32 v5, v5, v3
    v_lshlrev_b32 v2, 16, v60
    v_and_b32 v3, 0xffff0000, v60
    v_mul_f32 v2, v2, v32
    v_mul_f32 v3, v3, v33
    v_cvt_pk_bf16_f32 v3, v2, v3
    v_lshlrev_b32 v2, 16, v3
    v_and_b32 v3, 0xffff0000, v3
    v_add_f32 v4, v4, v2
    v_add_f32 v5, v5, v3
    v_lshlrev_b32 v2, 16, v61
    v_and_b32 v3, 0xffff0000, v61
    v_mul_f32 v2, v2, v34
    v_mul_f32 v3, v3, v35
    v_cvt_pk_bf16_f32 v3, v2, v3
    v_lshlrev_b32 v2, 16, v3
    v_and_b32 v3, 0xffff0000, v3
    v_add_f32 v4, v4, v2
    v_add_f32 v5, v5, v3
    v_lshlrev_b32 v2, 16, v62
    v_and_b32 v3, 0xffff0000, v62
    v_mul_f32 v2, v2, v36
    v_mul_f32 v3, v3, v37
    v_cvt_pk_bf16_f32 v3, v2, v3
    v_lshlrev_b32 v2, 16, v3
    v_and_b32 v3, 0xffff0000, v3
    v_add_f32 v4, v4, v2
    v_add_f32 v5, v5, v3
    v_lshlrev_b32 v2, 16, v63
    v_and_b32 v3, 0xffff0000, v63
    v_mul_f32 v2, v2, v38
    v_mul_f32 v3, v3, v39
    v_cvt_pk_bf16_f32 v3, v2, v3
    v_lshlrev_b32 v2, 16, v3
    v_and_b32 v3, 0xffff0000, v3
    v_add_f32 v4, v4, v2
    v_add_f32 v5, v5, v3
    v_add_f32 v4, v4, v5
    s_nop 1
    v_add_f32_dpp v4, v4, v4 quad_perm:[1,0,3,2] row_mask:0xf bank_mask:0xf
    s_nop 1
    v_add_f32_dpp v4, v4, v4 quad_perm:[2,3,0,1] row_mask:0xf bank_mask:0xf
    s_nop 1
    v_add_f32_dpp v4, v4, v4 row_ror:4 row_mask:0xf bank_mask:0xf
    s_nop 1
    v_add_f32_dpp v4, v4, v4 row_ror:8 row_mask:0xf bank_mask:0xf
    v_mov_b32 v5, v4
    s_nop 1
    v_permlane16_swap_b32 v5, v4
    v_add_f32 v4, v4, v5
    v_mov_b32 v5, v4
    s_nop 1
    v_permlane32_swap_b32 v5, v4
    v_add_f32 v4, v4, v5
    v_cmp_eq_u32 vcc, s71, v0
    s_nop 1
    v_cndmask_b32 v8, v8, v4, vcc
    s_add_u32 s71, s71, 1
    s_waitcnt vmcnt(2)
    v_mov_b32 v4, 0
    v_mov_b32 v5, 0
    v_lshlrev_b32 v2, 16, v64
    v_and_b32 v3, 0xffff0000, v64
    v_mul_f32 v2, v2, v24
    v_mul_f32 v3, v3, v25
    v_cvt_pk_bf16_f32 v3, v2, v3
    v_lshlrev_b32 v2, 16, v3
    v_and_b32 v3, 0xffff0000, v3
    v_add_f32 v4, v4, v2
    v_add_f32 v5, v5, v3
    v_lshlrev_b32 v2, 16, v65
    v_and_b32 v3, 0xffff0000, v65
    v_mul_f32 v2, v2, v26
    v_mul_f32 v3, v3, v27
    v_cvt_pk_bf16_f32 v3, v2, v3
    v_lshlrev_b32 v2, 16, v3
    v_and_b32 v3, 0xffff0000, v3
    v_add_f32 v4, v4, v2
    v_add_f32 v5, v5, v3
    v_lshlrev_b32 v2, 16, v66
    v_and_b32 v3, 0xffff0000, v66
    v_mul_f32 v2, v2, v28
    v_mul_f32 v3, v3, v29
    v_cvt_pk_bf16_f32 v3, v2, v3
    v_lshlrev_b32 v2, 16, v3
    v_and_b32 v3, 0xffff0000, v3
    v_add_f32 v4, v4, v2
    v_add_f32 v5, v5, v3
    v_lshlrev_b32 v2, 16, v67
    v_and_b32 v3, 0xffff0000, v67
    v_mul_f32 v2, v2, v30
    v_mul_f32 v3, v3, v31
    v_cvt_pk_bf16_f32 v3, v2, v3
    v_lshlrev_b32 v2, 16, v3
    v_and_b32 v3, 0xffff0000, v3
    v_add_f32 v4, v4, v2
    v_add_f32 v5, v5, v3
    v_lshlrev_b32 v2, 16, v68
    v_and_b32 v3, 0xffff0000, v68
    v_mul_f32 v2, v2, v32
    v_mul_f32 v3, v3, v33
    v_cvt_pk_bf16_f32 v3, v2, v3
    v_lshlrev_b32 v2, 16, v3
    v_and_b32 v3, 0xffff0000, v3
    v_add_f32 v4, v4, v2
    v_add_f32 v5, v5, v3
    v_lshlrev_b32 v2, 16, v69
    v_and_b32 v3, 0xffff0000, v69
    v_mul_f32 v2, v2, v34
    v_mul_f32 v3, v3, v35
    v_cvt_pk_bf16_f32 v3, v2, v3
    v_lshlrev_b32 v2, 16, v3
    v_and_b32 v3, 0xffff0000, v3
    v_add_f32 v4, v4, v2
    v_add_f32 v5, v5, v3
    v_lshlrev_b32 v2, 16, v70
    v_and_b32 v3, 0xffff0000, v70
    v_mul_f32 v2, v2, v36
    v_mul_f32 v3, v3, v37
    v_cvt_pk_bf16_f32 v3, v2, v3
    v_lshlrev_b32 v2, 16, v3
    v_and_b32 v3, 0xffff0000, v3
    v_add_f32 v4, v4, v2
    v_add_f32 v5, v5, v3
    v_lshlrev_b32 v2, 16, v71
    v_and_b32 v3, 0xffff0000, v71
    v_mul_f32 v2, v2, v38
    v_mul_f32 v3, v3, v39
    v_cvt_pk_bf16_f32 v3, v2, v3
    v_lshlrev_b32 v2, 16, v3
    v_and_b32 v3, 0xffff0000, v3
    v_add_f32 v4, v4, v2
    v_add_f32 v5, v5, v3
    v_add_f32 v4, v4, v5
    s_nop 1
    v_add_f32_dpp v4, v4, v4 quad_perm:[1,0,3,2] row_mask:0xf bank_mask:0xf
    s_nop 1
    v_add_f32_dpp v4, v4, v4 quad_perm:[2,3,0,1] row_mask:0xf bank_mask:0xf
    s_nop 1
    v_add_f32_dpp v4, v4, v4 row_ror:4 row_mask:0xf bank_mask:0xf
    s_nop 1
    v_add_f32_dpp v4, v4, v4 row_ror:8 row_mask:0xf bank_mask:0xf
    v_mov_b32 v5, v4
    s_nop 1
    v_permlane16_swap_b32 v5, v4
    v_add_f32 v4, v4, v5
    v_mov_b32 v5, v4
    s_nop 1
    v_permlane32_swap_b32 v5, v4
    v_add_f32 v4, v4, v5
    v_cmp_eq_u32 vcc, s71, v0
    s_nop 1
    v_cndmask_b32 v8, v8, v4, vcc
    s_add_u32 s71, s71, 1
    s_waitcnt vmcnt(0)
    v_mov_b32 v4, 0
    v_mov_b32 v5, 0
    v_lshlrev_b32 v2, 16, v72
    v_and_b32 v3, 0xffff0000, v72
    v_mul_f32 v2, v2, v24
    v_mul_f32 v3, v3, v25
    v_cvt_pk_bf16_f32 v3, v2, v3
    v_lshlrev_b32 v2, 16, v3
    v_and_b32 v3, 0xffff0000, v3
    v_add_f32 v4, v4, v2
    v_add_f32 v5, v5, v3
    v_lshlrev_b32 v2, 16, v73
    v_and_b32 v3, 0xffff0000, v73
    v_mul_f32 v2, v2, v26
    v_mul_f32 v3, v3, v27
    v_cvt_pk_bf16_f32 v3, v2, v3
    v_lshlrev_b32 v2, 16, v3
    v_and_b32 v3, 0xffff0000, v3
    v_add_f32 v4, v4, v2
    v_add_f32 v5, v5, v3
    v_lshlrev_b32 v2, 16, v74
    v_and_b32 v3, 0xffff0000, v74
    v_mul_f32 v2, v2, v28
    v_mul_f32 v3, v3, v29
    v_cvt_pk_bf16_f32 v3, v2, v3
    v_lshlrev_b32 v2, 16, v3
    v_and_b32 v3, 0xffff0000, v3
    v_add_f32 v4, v4, v2
    v_add_f32 v5, v5, v3
    v_lshlrev_b32 v2, 16, v75
    v_and_b32 v3, 0xffff0000, v75
    v_mul_f32 v2, v2, v30
    v_mul_f32 v3, v3, v31
    v_cvt_pk_bf16_f32 v3, v2, v3
    v_lshlrev_b32 v2, 16, v3
    v_and_b32 v3, 0xffff0000, v3
    v_add_f32 v4, v4, v2
    v_add_f32 v5, v5, v3
    v_lshlrev_b32 v2, 16, v76
    v_and_b32 v3, 0xffff0000, v76
    v_mul_f32 v2, v2, v32
    v_mul_f32 v3, v3, v33
    v_cvt_pk_bf16_f32 v3, v2, v3
    v_lshlrev_b32 v2, 16, v3
    v_and_b32 v3, 0xffff0000, v3
    v_add_f32 v4, v4, v2
    v_add_f32 v5, v5, v3
    v_lshlrev_b32 v2, 16, v77
    v_and_b32 v3, 0xffff0000, v77
    v_mul_f32 v2, v2, v34
    v_mul_f32 v3, v3, v35
    v_cvt_pk_bf16_f32 v3, v2, v3
    v_lshlrev_b32 v2, 16, v3
    v_and_b32 v3, 0xffff0000, v3
    v_add_f32 v4, v4, v2
    v_add_f32 v5, v5, v3
    v_lshlrev_b32 v2, 16, v78
    v_and_b32 v3, 0xffff0000, v78
    v_mul_f32 v2, v2, v36
    v_mul_f32 v3, v3, v37
    v_cvt_pk_bf16_f32 v3, v2, v3
    v_lshlrev_b32 v2, 16, v3
    v_and_b32 v3, 0xffff0000, v3
    v_add_f32 v4, v4, v2
    v_add_f32 v5, v5, v3
    v_lshlrev_b32 v2, 16, v79
    v_and_b32 v3, 0xffff0000, v79
    v_mul_f32 v2, v2, v38
    v_mul_f32 v3, v3, v39
    v_cvt_pk_bf16_f32 v3, v2, v3
    v_lshlrev_b32 v2, 16, v3
    v_and_b32 v3, 0xffff0000, v3
    v_add_f32 v4, v4, v2
    v_add_f32 v5, v5, v3
    v_add_f32 v4, v4, v5
    s_nop 1
    v_add_f32_dpp v4, v4, v4 quad_perm:[1,0,3,2] row_mask:0xf bank_mask:0xf
    s_nop 1
    v_add_f32_dpp v4, v4, v4 quad_perm:[2,3,0,1] row_mask:0xf bank_mask:0xf
    s_nop 1
    v_add_f32_dpp v4, v4, v4 row_ror:4 row_mask:0xf bank_mask:0xf
    s_nop 1
    v_add_f32_dpp v4, v4, v4 row_ror:8 row_mask:0xf bank_mask:0xf
    v_mov_b32 v5, v4
    s_nop 1
    v_permlane16_swap_b32 v5, v4
    v_add_f32 v4, v4, v5
    v_mov_b32 v5, v4
    s_nop 1
    v_permlane32_swap_b32 v5, v4
    v_add_f32 v4, v4, v5
    v_cmp_eq_u32 vcc, s71, v0
    s_nop 1
    v_cndmask_b32 v8, v8, v4, vcc
    s_add_u32 s71, s71, 1
    s_cmp_lt_u32 s71, 64
    s_cbranch_scc1 L_gate_loop
    v_cvt_pk_bf16_f32 v8, v8, v8
    v_and_b32 v8, 0xffff0000, v8
    v_mul_f32 v8, 0xbfb8aa3b, v8
    v_exp_f32 v8, v8
    s_nop 0
    v_add_f32 v8, 1.0, v8
    v_rcp_f32 v8, v8
    s_nop 0
    v_cvt_pk_bf16_f32 v8, v8, v8
    v_and_b32 v8, 0xffff0000, v8
    v_lshlrev_b32 v2, 2, v0
    buffer_store_dword v8, v2, s[8:11], s66 offen sc1
    s_waitcnt vmcnt(0)
    v_mov_b32 v2, 64
    buffer_store_dword v2, v15, s[8:11], s67 offen sc1
    s_branch L_phase2
L_late:
    s_waitcnt vmcnt(0)
    s_barrier
    s_cmp_lg_u32 s63, 0
    s_cbranch_scc1 L_arr_52
    v_mov_b32 v2, 1
    buffer_atomic_add v2, v15, s[24:27], 0 offen offset:8 sc1
L_arr_52:
    s_mov_b32 s16, s42
    s_and_b32 s17, s43, 0xffff
    s_mov_b32 s18, 8388608
    s_mov_b32 s19, 0x20000
    s_and_b32 s4, s62, 31
    s_lshl2_add_u32 s4, s4, s63
    s_lshr_b32 s5, s4, 4
    s_lshl_b32 s5, s5, 20
    s_and_b32 s6, s4, 7
    s_lshl_b32 s6, s6, 13
    s_add_u32 s5, s5, s6
    s_and_b32 s6, s4, 8
    s_lshl_b32 s6, s6, 14
    s_add_u32 s5, s5, s6
    v_lshlrev_b32 v3, 7, v0
    s_add_u32 s4, s5, 0
    buffer_load_dword v4, v3, s[16:19], s4 offen
    s_add_u32 s4, s5, 65536
    buffer_load_dword v4, v3, s[16:19], s4 offen
    s_add_u32 s4, s5, 262144
    buffer_load_dword v4, v3, s[16:19], s4 offen
    s_add_u32 s4, s5, 327680
    buffer_load_dword v4, v3, s[16:19], s4 offen
    s_add_u32 s4, s5, 524288
    buffer_load_dword v4, v3, s[16:19], s4 offen
    s_add_u32 s4, s5, 589824
    buffer_load_dword v4, v3, s[16:19], s4 offen
    s_add_u32 s4, s5, 786432
    buffer_load_dword v4, v3, s[16:19], s4 offen
    s_add_u32 s4, s5, 851968
    buffer_load_dword v4, v3, s[16:19], s4 offen
L_phase2:
    s_cmp_lg_u32 s63, 0
    s_cbranch_scc1 L_walld_54
L_wall_53:
    buffer_load_dword v2, v15, s[24:27], 0 offen offset:8 sc1
    s_waitcnt vmcnt(0)
    v_readfirstlane_b32 s4, v2
    s_nop 0
    s_cmp_ge_u32 s4, 256
    s_cbranch_scc1 L_walld_54
    s_sleep 16
    s_sub_u32 s65, s65, 1
    s_cmp_gt_i32 s65, 0
    s_cbranch_scc1 L_wall_53
L_walld_54:
    s_barrier
    s_and_b32 s80, s62, 31
    s_lshr_b32 s79, s62, 5
    s_lshl_b32 s79, s79, 2
L_phase2_next:
    s_add_u32 s79, s79, 1
    s_cmp_lg_u32 s79, 29
    s_cbranch_scc1 L_job_55
    s_mov_b32 s76, 0
    s_mov_b32 s77, 48
    s_mov_b32 s88, 4294967295
    s_mov_b32 s89, 2863311530
    s_mov_b32 s86, -1
    s_mov_b32 s87, 0
    s_branch L_B_d
L_job_55:
    s_cmp_lg_u32 s79, 30
    s_cbranch_scc1 L_job_56
    s_mov_b32 s76, 0
    s_mov_b32 s77, 0
    s_mov_b32 s88, 0
    s_mov_b32 s89, 0
    s_mov_b32 s86, 62
    s_mov_b32 s87, 1
    s_branch L_B_o
L_job_56:
    s_cmp_lg_u32 s79, 9
    s_cbranch_scc1 L_job_57
    s_mov_b32 s76, 32
    s_mov_b32 s77, 16
    s_mov_b32 s88, 0
    s_mov_b32 s89, 1431655765
    s_mov_b32 s86, -1
    s_mov_b32 s87, 0
    s_branch L_B_d
L_job_57:
    s_cmp_lg_u32 s79, 10
    s_cbranch_scc1 L_job_58
    s_mov_b32 s76, 0
    s_mov_b32 s77, 0
    s_mov_b32 s88, 0
    s_mov_b32 s89, 0
    s_mov_b32 s86, 62
    s_mov_b32 s87, 0
    s_branch L_B_o
L_job_58:
    s_cmp_lg_u32 s79, 13
    s_cbranch_scc1 L_job_59
    s_mov_b32 s76, 7
    s_mov_b32 s77, 14
    s_mov_b32 s88, 572662912
    s_mov_b32 s89, 35791394
    s_mov_b32 s86, 60
    s_mov_b32 s87, 1
    s_branch L_B_o
L_job_59:
    s_cmp_lg_u32 s79, 17
    s_cbranch_scc1 L_job_60
    s_mov_b32 s76, 4
    s_mov_b32 s77, 16
    s_mov_b32 s88, 286331472
    s_mov_b32 s89, 152113425
    s_mov_b32 s86, 60
    s_mov_b32 s87, 0
    s_branch L_B_o
L_job_60:
    s_cmp_lg_u32 s79, 21
    s_cbranch_scc1 L_job_61
    s_mov_b32 s76, 15
    s_mov_b32 s77, 11
    s_mov_b32 s88, 2290647040
    s_mov_b32 s89, 8947848
    s_mov_b32 s86, 58
    s_mov_b32 s87, 1
    s_branch L_B_o
L_job_61:
    s_cmp_lg_u32 s79, 25
    s_cbranch_scc1 L_job_62
    s_mov_b32 s76, 0
    s_mov_b32 s77, 18
    s_mov_b32 s88, 1145325871
    s_mov_b32 s89, 4473924
    s_mov_b32 s86, 58
    s_mov_b32 s87, 0
    s_branch L_B_o
L_job_62:
    s_endpgm
L_B_d:
    s_mov_b32 s16, s52
    s_and_b32 s17, s53, 0xffff
    s_mov_b32 s18, 7340032
    s_mov_b32 s19, 0x20000
    v_lshrrev_b32 v2, 2, v0
    v_and_b32 v3, 3, v0
    v_lshlrev_b32 v3, 4, v3
    v_lshl_add_u32 v8, v2, 11, v3
    s_mul_i32 s82, s63, 1835008
    s_lshl_b32 s4, s80, 6
    s_add_u32 s82, s82, s4
    s_lshl_b32 s70, s63, 15
    v_lshrrev_b32 v2, 5, v0
    v_bfe_u32 v3, v0, 2, 2
    v_lshl_add_u32 v2, v2, 2, v3
    v_lshlrev_b32 v2, 6, v2
    v_bfe_u32 v3, v0, 4, 1
    v_lshl_add_u32 v2, v3, 5, v2
    v_and_b32 v3, 3, v0
    v_lshl_add_u32 v2, v3, 3, v2
    v_add_u32 v9, s70, v2
    s_waitcnt vmcnt(0) lgkmcnt(0)
    s_barrier
    s_add_u32 m0, s70, 0
    s_add_u32 s4, s82, 0
    buffer_load_dwordx4 v8, s[16:19], s4 offen offset:0 lds
    s_add_u32 m0, s70, 1024
    s_add_u32 s4, s82, 32768
    buffer_load_dwordx4 v8, s[16:19], s4 offen offset:0 lds
    s_add_u32 m0, s70, 2048
    s_add_u32 s4, s82, 65536
    buffer_load_dwordx4 v8, s[16:19], s4 offen offset:0 lds
    s_add_u32 m0, s70, 3072
    s_add_u32 s4, s82, 98304
    buffer_load_dwordx4 v8, s[16:19], s4 offen offset:0 lds
    s_add_u32 m0, s70, 4096
    s_add_u32 s4, s82, 131072
    buffer_load_dwordx4 v8, s[16:19], s4 offen offset:0 lds
    s_add_u32 m0, s70, 5120
    s_add_u32 s4, s82, 163840
    buffer_load_dwordx4 v8, s[16:19], s4 offen offset:0 lds
    s_add_u32 m0, s70, 6144
    s_add_u32 s4, s82, 196608
    buffer_load_dwordx4 v8, s[16:19], s4 offen offset:0 lds
    s_add_u32 m0, s70, 7168
    s_add_u32 s4, s82, 229376
    buffer_load_dwordx4 v8, s[16:19], s4 offen offset:0 lds
    s_add_u32 m0, s70, 8192
    s_add_u32 s4, s82, 262144
    buffer_load_dwordx4 v8, s[16:19], s4 offen offset:0 lds
    s_add_u32 m0, s70, 9216
    s_add_u32 s4, s82, 294912
    buffer_load_dwordx4 v8, s[16:19], s4 offen offset:0 lds
    s_add_u32 m0, s70, 10240
    s_add_u32 s4, s82, 327680
    buffer_load_dwordx4 v8, s[16:19], s4 offen offset:0 lds
    s_add_u32 m0, s70, 11264
    s_add_u32 s4, s82, 360448
    buffer_load_dwordx4 v8, s[16:19], s4 offen offset:0 lds
    s_add_u32 m0, s70, 12288
    s_add_u32 s4, s82, 393216
    buffer_load_dwordx4 v8, s[16:19], s4 offen offset:0 lds
    s_add_u32 m0, s70, 13312
    s_add_u32 s4, s82, 425984
    buffer_load_dwordx4 v8, s[16:19], s4 offen offset:0 lds
    s_add_u32 m0, s70, 14336
    s_add_u32 s4, s82, 458752
    buffer_load_dwordx4 v8, s[16:19], s4 offen offset:0 lds
    s_add_u32 m0, s70, 15360
    s_add_u32 s4, s82, 491520
    buffer_load_dwordx4 v8, s[16:19], s4 offen offset:0 lds
    s_add_u32 m0, s70, 16384
    s_add_u32 s4, s82, 524288
    buffer_load_dwordx4 v8, s[16:19], s4 offen offset:0 lds
    s_add_u32 m0, s70, 17408
    s_add_u32 s4, s82, 557056
    buffer_load_dwordx4 v8, s[16:19], s4 offen offset:0 lds
    s_add_u32 m0, s70, 18432
    s_add_u32 s4, s82, 589824
    buffer_load_dwordx4 v8, s[16:19], s4 offen offset:0 lds
    s_add_u32 m0, s70, 19456
    s_add_u32 s4, s82, 622592
    buffer_load_dwordx4 v8, s[16:19], s4 offen offset:0 lds
    s_add_u32 m0, s70, 20480
    s_add_u32 s4, s82, 655360
    buffer_load_dwordx4 v8, s[16:19], s4 offen offset:0 lds
    s_add_u32 m0, s70, 21504
    s_add_u32 s4, s82, 688128
    buffer_load_dwordx4 v8, s[16:19], s4 offen offset:0 lds
    s_add_u32 m0, s70, 22528
    s_add_u32 s4, s82, 720896
    buffer_load_dwordx4 v8, s[16:19], s4 offen offset:0 lds
    s_add_u32 m0, s70, 23552
    s_add_u32 s4, s82, 753664
    buffer_load_dwordx4 v8, s[16:19], s4 offen offset:0 lds
    s_add_u32 m0, s70, 24576
    s_add_u32 s4, s82, 786432
    buffer_load_dwordx4 v8, s[16:19], s4 offen offset:0 lds
    s_add_u32 m0, s70, 25600
    s_add_u32 s4, s82, 819200
    buffer_load_dwordx4 v8, s[16:19], s4 offen offset:0 lds
    s_add_u32 m0, s70, 26624
    s_add_u32 s4, s82, 851968
    buffer_load_dwordx4 v8, s[16:19], s4 offen offset:0 lds
    s_add_u32 m0, s70, 27648
    s_add_u32 s4, s82, 884736
    buffer_load_dwordx4 v8, s[16:19], s4 offen offset:0 lds
    s_add_u32 m0, s70, 28672
    s_add_u32 s4, s82, 917504
    buffer_load_dwordx4 v8, s[16:19], s4 offen offset:0 lds
    s_add_u32 m0, s70, 29696
    s_add_u32 s4, s82, 950272
    buffer_load_dwordx4 v8, s[16:19], s4 offen offset:0 lds
    s_add_u32 m0, s70, 30720
    s_add_u32 s4, s82, 983040
    buffer_load_dwordx4 v8, s[16:19], s4 offen offset:0 lds
    s_add_u32 m0, s70, 31744
    s_add_u32 s4, s82, 1015808
    buffer_load_dwordx4 v8, s[16:19], s4 offen offset:0 lds
    s_waitcnt vmcnt(24)
    ds_read_b64_tr_b16 a[0:1], v9 offset:0
    ds_read_b64_tr_b16 a[2:3], v9 offset:512
    ds_read_b64_tr_b16 a[4:5], v9 offset:1024
    ds_read_b64_tr_b16 a[6:7], v9 offset:1536
    ds_read_b64_tr_b16 a[8:9], v9 offset:2048
    ds_read_b64_tr_b16 a[10:11], v9 offset:2560
    ds_read_b64_tr_b16 a[12:13], v9 offset:3072
    ds_read_b64_tr_b16 a[14:15], v9 offset:3584
    ds_read_b64_tr_b16 a[16:17], v9 offset:4096
    ds_read_b64_tr_b16 a[18:19], v9 offset:4608
    ds_read_b64_tr_b16 a[20:21], v9 offset:5120
    ds_read_b64_tr_b16 a[22:23], v9 offset:5632
    ds_read_b64_tr_b16 a[24:25], v9 offset:6144
    ds_read_b64_tr_b16 a[26:27], v9 offset:6656
    ds_read_b64_tr_b16 a[28:29], v9 offset:7168
    ds_read_b64_tr_b16 a[30:31], v9 offset:7680
    s_waitcnt lgkmcnt(0)
    s_add_u32 m0, s70, 0
    s_add_u32 s4, s82, 1048576
    buffer_load_dwordx4 v8, s[16:19], s4 offen offset:0 lds
    s_add_u32 m0, s70, 1024
    s_add_u32 s4, s82, 1081344
    buffer_load_dwordx4 v8, s[16:19], s4 offen offset:0 lds
    s_add_u32 m0, s70, 2048
    s_add_u32 s4, s82, 1114112
    buffer_load_dwordx4 v8, s[16:19], s4 offen offset:0 lds
    s_add_u32 m0, s70, 3072
    s_add_u32 s4, s82, 1146880
    buffer_load_dwordx4 v8, s[16:19], s4 offen offset:0 lds
    s_add_u32 m0, s70, 4096
    s_add_u32 s4, s82, 1179648
    buffer_load_dwordx4 v8, s[16:19], s4 offen offset:0 lds
    s_add_u32 m0, s70, 5120
    s_add_u32 s4, s82, 1212416
    buffer_load_dwordx4 v8, s[16:19], s4 offen offset:0 lds
    s_add_u32 m0, s70, 6144
    s_add_u32 s4, s82, 1245184
    buffer_load_dwordx4 v8, s[16:19], s4 offen offset:0 lds
    s_add_u32 m0, s70, 7168
    s_add_u32 s4, s82, 1277952
    buffer_load_dwordx4 v8, s[16:19], s4 offen offset:0 lds
    s_waitcnt vmcnt(24)
    ds_read_b64_tr_b16 a[32:33], v9 offset:8192
    ds_read_b64_tr_b16 a[34:35], v9 offset:8704
    ds_read_b64_tr_b16 a[36:37], v9 offset:9216
    ds_read_b64_tr_b16 a[38:39], v9 offset:9728
    ds_read_b64_tr_b16 a[40:41], v9 offset:10240
    ds_read_b64_tr_b16 a[42:43], v9 offset:10752
    ds_read_b64_tr_b16 a[44:45], v9 offset:11264
    ds_read_b64_tr_b16 a[46:47], v9 offset:11776
    ds_read_b64_tr_b16 a[48:49], v9 offset:12288
    ds_read_b64_tr_b16 a[50:51], v9 offset:12800
    ds_read_b64_tr_b16 a[52:53], v9 offset:13312
    ds_read_b64_tr_b16 a[54:55], v9 offset:13824
    ds_read_b64_tr_b16 a[56:57], v9 offset:14336
    ds_read_b64_tr_b16 a[58:59], v9 offset:14848
    ds_read_b64_tr_b16 a[60:61], v9 offset:15360
    ds_read_b64_tr_b16 a[62:63], v9 offset:15872
    s_waitcnt lgkmcnt(0)
    s_add_u32 m0, s70, 8192
    s_add_u32 s4, s82, 1310720
    buffer_load_dwordx4 v8, s[16:19], s4 offen offset:0 lds
    s_add_u32 m0, s70, 9216
    s_add_u32 s4, s82, 1343488
    buffer_load_dwordx4 v8, s[16:19], s4 offen offset:0 lds
    s_add_u32 m0, s70, 10240
    s_add_u32 s4, s82, 1376256
    buffer_load_dwordx4 v8, s[16:19], s4 offen offset:0 lds
    s_add_u32 m0, s70, 11264
    s_add_u32 s4, s82, 1409024
    buffer_load_dwordx4 v8, s[16:19], s4 offen offset:0 lds
    s_add_u32 m0, s70, 12288
    s_add_u32 s4, s82, 1441792
    buffer_load_dwordx4 v8, s[16:19], s4 offen offset:0 lds
    s_add_u32 m0, s70, 13312
    s_add_u32 s4, s82, 1474560
    buffer_load_dwordx4 v8, s[16:19], s4 offen offset:0 lds
    s_add_u32 m0, s70, 14336
    s_add_u32 s4, s82, 1507328
    buffer_load_dwordx4 v8, s[16:19], s4 offen offset:0 lds
    s_add_u32 m0, s70, 15360
    s_add_u32 s4, s82, 1540096
    buffer_load_dwordx4 v8, s[16:19], s4 offen offset:0 lds
    s_waitcnt vmcnt(24)
    ds_read_b64_tr_b16 a[64:65], v9 offset:16384
    ds_read_b64_tr_b16 a[66:67], v9 offset:16896
    ds_read_b64_tr_b16 a[68:69], v9 offset:17408
    ds_read_b64_tr_b16 a[70:71], v9 offset:17920
    ds_read_b64_tr_b16 a[72:73], v9 offset:18432
    ds_read_b64_tr_b16 a[74:75], v9 offset:18944
    ds_read_b64_tr_b16 a[76:77], v9 offset:19456
    ds_read_b64_tr_b16 a[78:79], v9 offset:19968
    ds_read_b64_tr_b16 a[80:81], v9 offset:20480
    ds_read_b64_tr_b16 a[82:83], v9 offset:20992
    ds_read_b64_tr_b16 a[84:85], v9 offset:21504
    ds_read_b64_tr_b16 a[86:87], v9 offset:22016
    ds_read_b64_tr_b16 a[88:89], v9 offset:22528
    ds_read_b64_tr_b16 a[90:91], v9 offset:23040
    ds_read_b64_tr_b16 a[92:93], v9 offset:23552
    ds_read_b64_tr_b16 a[94:95], v9 offset:24064
    s_waitcnt lgkmcnt(0)
    s_add_u32 m0, s70, 16384
    s_add_u32 s4, s82, 1572864
    buffer_load_dwordx4 v8, s[16:19], s4 offen offset:0 lds
    s_add_u32 m0, s70, 17408
    s_add_u32 s4, s82, 1605632
    buffer_load_dwordx4 v8, s[16:19], s4 offen offset:0 lds
    s_add_u32 m0, s70, 18432
    s_add_u32 s4, s82, 1638400
    buffer_load_dwordx4 v8, s[16:19], s4 offen offset:0 lds
    s_add_u32 m0, s70, 19456
    s_add_u32 s4, s82, 1671168
    buffer_load_dwordx4 v8, s[16:19], s4 offen offset:0 lds
    s_add_u32 m0, s70, 20480
    s_add_u32 s4, s82, 1703936
    buffer_load_dwordx4 v8, s[16:19], s4 offen offset:0 lds
    s_add_u32 m0, s70, 21504
    s_add_u32 s4, s82, 1736704
    buffer_load_dwordx4 v8, s[16:19], s4 offen offset:0 lds
    s_add_u32 m0, s70, 22528
    s_add_u32 s4, s82, 1769472
    buffer_load_dwordx4 v8, s[16:19], s4 offen offset:0 lds
    s_add_u32 m0, s70, 23552
    s_add_u32 s4, s82, 1802240
    buffer_load_dwordx4 v8, s[16:19], s4 offen offset:0 lds
    s_waitcnt vmcnt(24)
    ds_read_b64_tr_b16 a[96:97], v9 offset:24576
    ds_read_b64_tr_b16 a[98:99], v9 offset:25088
    ds_read_b64_tr_b16 a[100:101], v9 offset:25600
    ds_read_b64_tr_b16 a[102:103], v9 offset:26112
    ds_read_b64_tr_b16 a[104:105], v9 offset:26624
    ds_read_b64_tr_b16 a[106:107], v9 offset:27136
    ds_read_b64_tr_b16 a[108:109], v9 offset:27648
    ds_read_b64_tr_b16 a[110:111], v9 offset:28160
    ds_read_b64_tr_b16 a[112:113], v9 offset:28672
    ds_read_b64_tr_b16 a[114:115], v9 offset:29184
    ds_read_b64_tr_b16 a[116:117], v9 offset:29696
    ds_read_b64_tr_b16 a[118:119], v9 offset:30208
    ds_read_b64_tr_b16 a[120:121], v9 offset:30720
    ds_read_b64_tr_b16 a[122:123], v9 offset:31232
    ds_read_b64_tr_b16 a[124:125], v9 offset:31744
    ds_read_b64_tr_b16 a[126:127], v9 offset:32256
    s_waitcnt lgkmcnt(0)
    s_waitcnt vmcnt(16)
    ds_read_b64_tr_b16 a[128:129], v9 offset:0
    ds_read_b64_tr_b16 a[130:131], v9 offset:512
    ds_read_b64_tr_b16 a[132:133], v9 offset:1024
    ds_read_b64_tr_b16 a[134:135], v9 offset:1536
    ds_read_b64_tr_b16 a[136:137], v9 offset:2048
    ds_read_b64_tr_b16 a[138:139], v9 offset:2560
    ds_read_b64_tr_b16 a[140:141], v9 offset:3072
    ds_read_b64_tr_b16 a[142:143], v9 offset:3584
    ds_read_b64_tr_b16 a[144:145], v9 offset:4096
    ds_read_b64_tr_b16 a[146:147], v9 offset:4608
    ds_read_b64_tr_b16 a[148:149], v9 offset:5120
    ds_read_b64_tr_b16 a[150:151], v9 offset:5632
    ds_read_b64_tr_b16 a[152:153], v9 offset:6144
    ds_read_b64_tr_b16 a[154:155], v9 offset:6656
    ds_read_b64_tr_b16 a[156:157], v9 offset:7168
    ds_read_b64_tr_b16 a[158:159], v9 offset:7680
    s_waitcnt lgkmcnt(0)
    s_waitcnt vmcnt(8)
    ds_read_b64_tr_b16 a[160:161], v9 offset:8192
    ds_read_b64_tr_b16 a[162:163], v9 offset:8704
    ds_read_b64_tr_b16 a[164:165], v9 offset:9216
    ds_read_b64_tr_b16 a[166:167], v9 offset:9728
    ds_read_b64_tr_b16 a[168:169], v9 offset:10240
    ds_read_b64_tr_b16 a[170:171], v9 offset:10752
    ds_read_b64_tr_b16 a[172:173], v9 offset:11264
    ds_read_b64_tr_b16 a[174:175], v9 offset:11776
    ds_read_b64_tr_b16 a[176:177], v9 offset:12288
    ds_read_b64_tr_b16 a[178:179], v9 offset:12800
    ds_read_b64_tr_b16 a[180:181], v9 offset:13312
    ds_read_b64_tr_b16 a[182:183], v9 offset:13824
    ds_read_b64_tr_b16 a[184:185], v9 offset:14336
    ds_read_b64_tr_b16 a[186:187], v9 offset:14848
    ds_read_b64_tr_b16 a[188:189], v9 offset:15360
    ds_read_b64_tr_b16 a[190:191], v9 offset:15872
    s_waitcnt lgkmcnt(0)
    s_waitcnt vmcnt(0)
    ds_read_b64_tr_b16 a[192:193], v9 offset:16384
    ds_read_b64_tr_b16 a[194:195], v9 offset:16896
    ds_read_b64_tr_b16 a[196:197], v9 offset:17408
    ds_read_b64_tr_b16 a[198:199], v9 offset:17920
    ds_read_b64_tr_b16 a[200:201], v9 offset:18432
    ds_read_b64_tr_b16 a[202:203], v9 offset:18944
    ds_read_b64_tr_b16 a[204:205], v9 offset:19456
    ds_read_b64_tr_b16 a[206:207], v9 offset:19968
    ds_read_b64_tr_b16 a[208:209], v9 offset:20480
    ds_read_b64_tr_b16 a[210:211], v9 offset:20992
    ds_read_b64_tr_b16 a[212:213], v9 offset:21504
    ds_read_b64_tr_b16 a[214:215], v9 offset:22016
    ds_read_b64_tr_b16 a[216:217], v9 offset:22528
    ds_read_b64_tr_b16 a[218:219], v9 offset:23040
    ds_read_b64_tr_b16 a[220:221], v9 offset:23552
    ds_read_b64_tr_b16 a[222:223], v9 offset:24064
    s_waitcnt lgkmcnt(0)
    v_lshrrev_b32 v2, 2, v0
    v_min_u32 v2, 13, v2
    s_mul_i32 s4, s63, 14
    s_add_u32 s4, s4, 160
    v_add_u32 v2, s4, v2
    v_and_b32 v3, 3, v0
    v_lshlrev_b32 v3, 2, v3
    v_lshl_add_u32 v9, v2, 7, v3
    v_add_u32 v9, 104923136, v9
    s_lshl_b32 s4, s63, 12
    s_add_u32 s4, s4, 0x20000
    v_add_u32 v10, s4, v1
    v_lshrrev_b32 v2, 3, v0
    s_lshl_b32 s4, s63, 3
    v_add_u32 v2, s4, v2
    v_and_b32 v3, 7, v0
    v_lshlrev_b32 v4, 4, v2
    v_lshl_add_u32 v4, v3, 9, v4
    v_add_u32 v11, 0x20000, v4
    s_lshl_b32 s4, s63, 9
    v_lshl_add_u32 v12, v0, 3, s4
    v_lshlrev_b32 v13, 2, v2
    v_lshlrev_b32 v3, 3, v3
    s_lshl_b32 s4, s80, 6
    v_lshl_add_u32 v3, v2, 11, v3
    v_add_u32 v14, s4, v3
    v_mov_b32 v7, 0
    s_mov_b32 s85, 0
    s_mov_b32 s84, 104988672
    v_mov_b32 v6, 268435456
L_B_d_cold:
    buffer_load_dword v2, v9, s[8:11], 0 offen sc1
    s_waitcnt vmcnt(0)
    v_cmp_ge_u32 vcc, s76, v2
    s_cbranch_vccz L_cd_63
    s_sleep 2
    s_sub_u32 s65, s65, 1
    s_cmp_gt_i32 s65, 0
    s_cbranch_scc1 L_B_d_cold
L_cd_63:
    s_mul_i32 s81, s76, 229376
    s_mul_i32 s4, s63, 57344
    s_add_u32 s81, s81, s4
    s_add_u32 s81, s81, 83886080
    s_mul_i32 s4, s80, 1792
    s_add_u32 s4, s4, s81
    v_lshlrev_b32 v4, 1, v1
    buffer_load_dword v3, v4, s[8:11], s4 offen sc1
    s_add_u32 s5, s81, 0
    buffer_load_dwordx4 v[128:131], v1, s[8:11], s5 offen offset:0 sc1
    buffer_load_dwordx4 v[132:135], v1, s[8:11], s5 offen offset:1024 sc1
    buffer_load_dwordx4 v[136:139], v1, s[8:11], s5 offen offset:2048 sc1
    buffer_load_dwordx4 v[140:143], v1, s[8:11], s5 offen offset:3072 sc1
    s_add_u32 s5, s81, 4096
    buffer_load_dwordx4 v[144:147], v1, s[8:11], s5 offen offset:0 sc1
    buffer_load_dwordx4 v[148:151], v1, s[8:11], s5 offen offset:1024 sc1
    buffer_load_dwordx4 v[152:155], v1, s[8:11], s5 offen offset:2048 sc1
    buffer_load_dwordx4 v[156:159], v1, s[8:11], s5 offen offset:3072 sc1
    s_add_u32 s5, s81, 8192
    buffer_load_dwordx4 v[160:163], v1, s[8:11], s5 offen offset:0 sc1
    buffer_load_dwordx4 v[164:167], v1, s[8:11], s5 offen offset:1024 sc1
    buffer_load_dwordx4 v[168:171], v1, s[8:11], s5 offen offset:2048 sc1
    buffer_load_dwordx4 v[172:175], v1, s[8:11], s5 offen offset:3072 sc1
    s_add_u32 s5, s81, 12288
    buffer_load_dwordx4 v[176:179], v1, s[8:11], s5 offen offset:0 sc1
    buffer_load_dwordx4 v[180:183], v1, s[8:11], s5 offen offset:1024 sc1
    buffer_load_dwordx4 v[184:187], v1, s[8:11], s5 offen offset:2048 sc1
    buffer_load_dwordx4 v[188:191], v1, s[8:11], s5 offen offset:3072 sc1
    s_add_u32 s5, s81, 16384
    buffer_load_dwordx4 v[192:195], v1, s[8:11], s5 offen offset:0 sc1
    buffer_load_dwordx4 v[196:199], v1, s[8:11], s5 offen offset:1024 sc1
    buffer_load_dwordx4 v[200:203], v1, s[8:11], s5 offen offset:2048 sc1
    buffer_load_dwordx4 v[204:207], v1, s[8:11], s5 offen offset:3072 sc1
    s_add_u32 s5, s81, 20480
    buffer_load_dwordx4 v[208:211], v1, s[8:11], s5 offen offset:0 sc1
    buffer_load_dwordx4 v[212:215], v1, s[8:11], s5 offen offset:1024 sc1
    buffer_load_dwordx4 v[216:219], v1, s[8:11], s5 offen offset:2048 sc1
    buffer_load_dwordx4 v[220:223], v1, s[8:11], s5 offen offset:3072 sc1
    s_add_u32 s5, s81, 24576
    buffer_load_dwordx4 v[224:227], v1, s[8:11], s5 offen offset:0 sc1
    buffer_load_dwordx4 v[228:231], v1, s[8:11], s5 offen offset:1024 sc1
    buffer_load_dwordx4 v[232:235], v1, s[8:11], s5 offen offset:2048 sc1
    buffer_load_dwordx4 v[236:239], v1, s[8:11], s5 offen offset:3072 sc1
L_B_d_warm:
    s_lshl_b32 s6, s76, 5
    s_add_u32 s6, s6, s80
    s_lshl_b32 s7, s6, 2
    s_add_u32 s7, s7, s63
    s_lshl_b32 s7, s7, 2
    s_add_u32 s7, s7, 104988672
    s_lshl_b32 s6, s6, 11
    s_add_u32 s6, s6, 100663296
    s_bitset0_b64 s[88:89], s76
    s_ff1_i32_b64 s83, s[88:89]
    s_and_b32 s83, s83, 63
    buffer_load_dword v2, v9, s[8:11], 0 offen sc1
    s_waitcnt vmcnt(28)
    v_mfma_f32_32x32x16_bf16 v[16:31], a[0:3], v[128:131], 0
    s_add_u32 s5, s81, 28672
    buffer_load_dwordx4 v[128:131], v1, s[8:11], s5 offen offset:0 sc1
    s_waitcnt vmcnt(28)
    v_mfma_f32_32x32x16_bf16 v[16:31], a[4:7], v[132:135], v[16:31]
    buffer_load_dwordx4 v[132:135], v1, s[8:11], s5 offen offset:1024 sc1
    s_waitcnt vmcnt(28)
    v_mfma_f32_32x32x16_bf16 v[16:31], a[8:11], v[136:139], v[16:31]
    buffer_load_dwordx4 v[136:139], v1, s[8:11], s5 offen offset:2048 sc1
    s_waitcnt vmcnt(28)
    v_mfma_f32_32x32x16_bf16 v[16:31], a[12:15], v[140:143], v[16:31]
    buffer_load_dwordx4 v[140:143], v1, s[8:11], s5 offen offset:3072 sc1
    s_waitcnt vmcnt(28)
    v_mfma_f32_32x32x16_bf16 v[16:31], a[16:19], v[144:147], v[16:31]
    s_add_u32 s5, s81, 32768
    buffer_load_dwordx4 v[144:147], v1, s[8:11], s5 offen offset:0 sc1
    s_waitcnt vmcnt(28)
    v_mfma_f32_32x32x16_bf16 v[16:31], a[20:23], v[148:151], v[16:31]
    buffer_load_dwordx4 v[148:151], v1, s[8:11], s5 offen offset:1024 sc1
    s_waitcnt vmcnt(28)
    v_mfma_f32_32x32x16_bf16 v[16:31], a[24:27], v[152:155], v[16:31]
    buffer_load_dwordx4 v[152:155], v1, s[8:11], s5 offen offset:2048 sc1
    s_waitcnt vmcnt(28)
    v_mfma_f32_32x32x16_bf16 v[16:31], a[28:31], v[156:159], v[16:31]
    buffer_load_dwordx4 v[156:159], v1, s[8:11], s5 offen offset:3072 sc1
    s_waitcnt vmcnt(28)
    v_mfma_f32_32x32x16_bf16 v[16:31], a[32:35], v[160:163], v[16:31]
    s_add_u32 s5, s81, 36864
    buffer_load_dwordx4 v[160:163], v1, s[8:11], s5 offen offset:0 sc1
    s_waitcnt vmcnt(28)
    v_mfma_f32_32x32x16_bf16 v[16:31], a[36:39], v[164:167], v[16:31]
    buffer_load_dwordx4 v[164:167], v1, s[8:11], s5 offen offset:1024 sc1
    s_waitcnt vmcnt(28)
    v_mfma_f32_32x32x16_bf16 v[16:31], a[40:43], v[168:171], v[16:31]
    buffer_load_dwordx4 v[168:171], v1, s[8:11], s5 offen offset:2048 sc1
    s_waitcnt vmcnt(28)
    v_mfma_f32_32x32x16_bf16 v[16:31], a[44:47], v[172:175], v[16:31]
    buffer_load_dwordx4 v[172:175], v1, s[8:11], s5 offen offset:3072 sc1
    s_waitcnt vmcnt(28)
    v_mfma_f32_32x32x16_bf16 v[16:31], a[48:51], v[176:179], v[16:31]
    s_add_u32 s5, s81, 40960
    buffer_load_dwordx4 v[176:179], v1, s[8:11], s5 offen offset:0 sc1
    s_waitcnt vmcnt(28)
    v_mfma_f32_32x32x16_bf16 v[16:31], a[52:55], v[180:183], v[16:31]
    buffer_load_dwordx4 v[180:183], v1, s[8:11], s5 offen offset:1024 sc1
    s_waitcnt vmcnt(28)
    v_mfma_f32_32x32x16_bf16 v[16:31], a[56:59], v[184:187], v[16:31]
    buffer_load_dwordx4 v[184:187], v1, s[8:11], s5 offen offset:2048 sc1
    s_waitcnt vmcnt(28)
    v_mfma_f32_32x32x16_bf16 v[16:31], a[60:63], v[188:191], v[16:31]
    buffer_load_dwordx4 v[188:191], v1, s[8:11], s5 offen offset:3072 sc1
    s_waitcnt vmcnt(28)
    v_mfma_f32_32x32x16_bf16 v[16:31], a[64:67], v[192:195], v[16:31]
    s_add_u32 s5, s81, 45056
    buffer_load_dwordx4 v[192:195], v1, s[8:11], s5 offen offset:0 sc1
    s_waitcnt vmcnt(28)
    v_mfma_f32_32x32x16_bf16 v[16:31], a[68:71], v[196:199], v[16:31]
    buffer_load_dwordx4 v[196:199], v1, s[8:11], s5 offen offset:1024 sc1
    s_waitcnt vmcnt(28)
    v_mfma_f32_32x32x16_bf16 v[16:31], a[72:75], v[200:203], v[16:31]
    buffer_load_dwordx4 v[200:203], v1, s[8:11], s5 offen offset:2048 sc1
    s_waitcnt vmcnt(28)
    v_mfma_f32_32x32x16_bf16 v[16:31], a[76:79], v[204:207], v[16:31]
    buffer_load_dwordx4 v[204:207], v1, s[8:11], s5 offen offset:3072 sc1
    s_waitcnt vmcnt(28)
    v_mfma_f32_32x32x16_bf16 v[16:31], a[80:83], v[208:211], v[16:31]
    s_add_u32 s5, s81, 49152
    buffer_load_dwordx4 v[208:211], v1, s[8:11], s5 offen offset:0 sc1
    s_waitcnt vmcnt(28)
    v_mfma_f32_32x32x16_bf16 v[16:31], a[84:87], v[212:215], v[16:31]
    buffer_load_dwordx4 v[212:215], v1, s[8:11], s5 offen offset:1024 sc1
    s_waitcnt vmcnt(28)
    v_mfma_f32_32x32x16_bf16 v[16:31], a[88:91], v[216:219], v[16:31]
    buffer_load_dwordx4 v[216:219], v1, s[8:11], s5 offen offset:2048 sc1
    s_waitcnt vmcnt(28)
    v_mfma_f32_32x32x16_bf16 v[16:31], a[92:95], v[220:223], v[16:31]
    buffer_load_dwordx4 v[220:223], v1, s[8:11], s5 offen offset:3072 sc1
    s_waitcnt vmcnt(28)
    v_mfma_f32_32x32x16_bf16 v[16:31], a[96:99], v[224:227], v[16:31]
    s_add_u32 s5, s81, 53248
    buffer_load_dwordx4 v[224:227], v1, s[8:11], s5 offen offset:0 sc1
    s_waitcnt vmcnt(28)
    v_mfma_f32_32x32x16_bf16 v[16:31], a[100:103], v[228:231], v[16:31]
    buffer_load_dwordx4 v[228:231], v1, s[8:11], s5 offen offset:1024 sc1
    s_waitcnt vmcnt(28)
    v_mfma_f32_32x32x16_bf16 v[16:31], a[104:107], v[232:235], v[16:31]
    buffer_load_dwordx4 v[232:235], v1, s[8:11], s5 offen offset:2048 sc1
    s_waitcnt vmcnt(28)
    v_mfma_f32_32x32x16_bf16 v[16:31], a[108:111], v[236:239], v[16:31]
    buffer_load_dwordx4 v[236:239], v1, s[8:11], s5 offen offset:3072 sc1
    s_waitcnt vmcnt(28)
    v_mov_b32 v3, 1
    buffer_store_dword v3, v6, s[8:11], s84 offen sc1
    s_mov_b32 s84, s7
    s_mul_i32 s82, s83, 229376
    s_mul_i32 s4, s63, 57344
    s_add_u32 s82, s82, s4
    s_add_u32 s82, s82, 83886080
    s_cmp_le_u32 s77, 1
    s_cbranch_scc1 L_B_d_nopf
    v_cmp_ge_u32 vcc, s83, v2
    s_cbranch_vccnz L_B_d_nopf
    s_waitcnt vmcnt(28)
    v_mfma_f32_32x32x16_bf16 v[16:31], a[112:115], v[128:131], v[16:31]
    s_add_u32 s5, s82, 0
    buffer_load_dwordx4 v[128:131], v1, s[8:11], s5 offen offset:0 sc1
    s_waitcnt vmcnt(28)
    v_mfma_f32_32x32x16_bf16 v[16:31], a[116:119], v[132:135], v[16:31]
    buffer_load_dwordx4 v[132:135], v1, s[8:11], s5 offen offset:1024 sc1
    s_waitcnt vmcnt(28)
    v_mfma_f32_32x32x16_bf16 v[16:31], a[120:123], v[136:139], v[16:31]
    buffer_load_dwordx4 v[136:139], v1, s[8:11], s5 offen offset:2048 sc1
    s_waitcnt vmcnt(28)
    v_mfma_f32_32x32x16_bf16 v[16:31], a[124:127], v[140:143], v[16:31]
    buffer_load_dwordx4 v[140:143], v1, s[8:11], s5 offen offset:3072 sc1
    s_waitcnt vmcnt(28)
    v_mfma_f32_32x32x16_bf16 v[16:31], a[128:131], v[144:147], v[16:31]
    s_add_u32 s5, s82, 4096
    buffer_load_dwordx4 v[144:147], v1, s[8:11], s5 offen offset:0 sc1
    s_waitcnt vmcnt(28)
    v_mfma_f32_32x32x16_bf16 v[16:31], a[132:135], v[148:151], v[16:31]
    buffer_load_dwordx4 v[148:151], v1, s[8:11], s5 offen offset:1024 sc1
    s_waitcnt vmcnt(28)
    v_mfma_f32_32x32x16_bf16 v[16:31], a[136:139], v[152:155], v[16:31]
    buffer_load_dwordx4 v[152:155], v1, s[8:11], s5 offen offset:2048 sc1
    s_waitcnt vmcnt(28)
    v_mfma_f32_32x32x16_bf16 v[16:31], a[140:143], v[156:159], v[16:31]
    buffer_load_dwordx4 v[156:159], v1, s[8:11], s5 offen offset:3072 sc1
    s_waitcnt vmcnt(28)
    v_mfma_f32_32x32x16_bf16 v[16:31], a[144:147], v[160:163], v[16:31]
    s_add_u32 s5, s82, 8192
    buffer_load_dwordx4 v[160:163], v1, s[8:11], s5 offen offset:0 sc1
    s_waitcnt vmcnt(28)
    v_mfma_f32_32x32x16_bf16 v[16:31], a[148:151], v[164:167], v[16:31]
    buffer_load_dwordx4 v[164:167], v1, s[8:11], s5 offen offset:1024 sc1
    s_waitcnt vmcnt(28)
    v_mfma_f32_32x32x16_bf16 v[16:31], a[152:155], v[168:171], v[16:31]
    buffer_load_dwordx4 v[168:171], v1, s[8:11], s5 offen offset:2048 sc1
    s_waitcnt vmcnt(28)
    v_mfma_f32_32x32x16_bf16 v[16:31], a[156:159], v[172:175], v[16:31]
    buffer_load_dwordx4 v[172:175], v1, s[8:11], s5 offen offset:3072 sc1
    s_waitcnt vmcnt(28)
    v_mfma_f32_32x32x16_bf16 v[16:31], a[160:163], v[176:179], v[16:31]
    s_add_u32 s5, s82, 12288
    buffer_load_dwordx4 v[176:179], v1, s[8:11], s5 offen offset:0 sc1
    s_waitcnt vmcnt(28)
    v_mfma_f32_32x32x16_bf16 v[16:31], a[164:167], v[180:183], v[16:31]
    buffer_load_dwordx4 v[180:183], v1, s[8:11], s5 offen offset:1024 sc1
    s_waitcnt vmcnt(28)
    v_mfma_f32_32x32x16_bf16 v[16:31], a[168:171], v[184:187], v[16:31]
    buffer_load_dwordx4 v[184:187], v1, s[8:11], s5 offen offset:2048 sc1
    s_waitcnt vmcnt(28)
    v_mfma_f32_32x32x16_bf16 v[16:31], a[172:175], v[188:191], v[16:31]
    buffer_load_dwordx4 v[188:191], v1, s[8:11], s5 offen offset:3072 sc1
    s_waitcnt vmcnt(28)
    v_mfma_f32_32x32x16_bf16 v[16:31], a[176:179], v[192:195], v[16:31]
    s_add_u32 s5, s82, 16384
    buffer_load_dwordx4 v[192:195], v1, s[8:11], s5 offen offset:0 sc1
    s_waitcnt vmcnt(28)
    v_mfma_f32_32x32x16_bf16 v[16:31], a[180:183], v[196:199], v[16:31]
    buffer_load_dwordx4 v[196:199], v1, s[8:11], s5 offen offset:1024 sc1
    s_waitcnt vmcnt(28)
    v_mfma_f32_32x32x16_bf16 v[16:31], a[184:187], v[200:203], v[16:31]
    buffer_load_dwordx4 v[200:203], v1, s[8:11], s5 offen offset:2048 sc1
    s_waitcnt vmcnt(28)
    v_mfma_f32_32x32x16_bf16 v[16:31], a[188:191], v[204:207], v[16:31]
    buffer_load_dwordx4 v[204:207], v1, s[8:11], s5 offen offset:3072 sc1
    s_waitcnt vmcnt(28)
    v_mfma_f32_32x32x16_bf16 v[16:31], a[192:195], v[208:211], v[16:31]
    s_add_u32 s5, s82, 20480
    buffer_load_dwordx4 v[208:211], v1, s[8:11], s5 offen offset:0 sc1
    s_waitcnt vmcnt(28)
    v_mfma_f32_32x32x16_bf16 v[16:31], a[196:199], v[212:215], v[16:31]
    buffer_load_dwordx4 v[212:215], v1, s[8:11], s5 offen offset:1024 sc1
    s_waitcnt vmcnt(28)
    v_mfma_f32_32x32x16_bf16 v[16:31], a[200:203], v[216:219], v[16:31]
    buffer_load_dwordx4 v[216:219], v1, s[8:11], s5 offen offset:2048 sc1
    s_waitcnt vmcnt(28)
    v_mfma_f32_32x32x16_bf16 v[16:31], a[204:207], v[220:223], v[16:31]
    buffer_load_dwordx4 v[220:223], v1, s[8:11], s5 offen offset:3072 sc1
    s_waitcnt vmcnt(28)
    v_mfma_f32_32x32x16_bf16 v[16:31], a[208:211], v[224:227], v[16:31]
    s_add_u32 s5, s82, 24576
    buffer_load_dwordx4 v[224:227], v1, s[8:11], s5 offen offset:0 sc1
    s_waitcnt vmcnt(28)
    v_mfma_f32_32x32x16_bf16 v[16:31], a[212:215], v[228:231], v[16:31]
    buffer_load_dwordx4 v[228:231], v1, s[8:11], s5 offen offset:1024 sc1
    s_waitcnt vmcnt(28)
    v_mfma_f32_32x32x16_bf16 v[16:31], a[216:219], v[232:235], v[16:31]
    buffer_load_dwordx4 v[232:235], v1, s[8:11], s5 offen offset:2048 sc1
    s_waitcnt vmcnt(28)
    v_mfma_f32_32x32x16_bf16 v[16:31], a[220:223], v[236:239], v[16:31]
    buffer_load_dwordx4 v[236:239], v1, s[8:11], s5 offen offset:3072 sc1
    v_add_u32 v4, s85, v10
    v_add_u32 v5, s85, v11
    s_xor_b32 s85, s85, 0x4000
    s_nop 7
    ds_write_b128 v4, v[16:19] offset:0
    ds_write_b128 v4, v[20:23] offset:1024
    ds_write_b128 v4, v[24:27] offset:2048
    ds_write_b128 v4, v[28:31] offset:3072
    s_waitcnt lgkmcnt(0)
    s_barrier
    ds_read_b128 v[32:35], v5 offset:0
    ds_read_b128 v[36:39], v5 offset:4096
    ds_read_b128 v[40:43], v5 offset:8192
    ds_read_b128 v[44:47], v5 offset:12288
    s_waitcnt lgkmcnt(2)
    v_add_f32 v32, v32, v36
    v_add_f32 v33, v33, v37
    v_add_f32 v34, v34, v38
    v_add_f32 v35, v35, v39
    s_waitcnt lgkmcnt(0)
    v_add_f32 v40, v40, v44
    v_add_f32 v41, v41, v45
    v_add_f32 v42, v42, v46
    v_add_f32 v43, v43, v47
    v_add_f32 v32, v32, v40
    v_add_f32 v33, v33, v41
    v_add_f32 v34, v34, v42
    v_add_f32 v35, v35, v43
    v_cvt_pk_bf16_f32 v36, v32, v33
    v_cvt_pk_bf16_f32 v37, v34, v35
    buffer_store_dwordx2 v[36:37], v12, s[8:11], s6 offen sc1
    v_mov_b32 v6, v15
    s_mov_b32 s76, s83
    s_mov_b32 s81, s82
    s_sub_u32 s77, s77, 1
    s_branch L_B_d_warm
L_B_d_nopf:
    s_waitcnt vmcnt(28)
    v_mfma_f32_32x32x16_bf16 v[16:31], a[112:115], v[128:131], v[16:31]
    s_waitcnt vmcnt(27)
    v_mfma_f32_32x32x16_bf16 v[16:31], a[116:119], v[132:135], v[16:31]
    s_waitcnt vmcnt(26)
    v_mfma_f32_32x32x16_bf16 v[16:31], a[120:123], v[136:139], v[16:31]
    s_waitcnt vmcnt(25)
    v_mfma_f32_32x32x16_bf16 v[16:31], a[124:127], v[140:143], v[16:31]
    s_waitcnt vmcnt(24)
    v_mfma_f32_32x32x16_bf16 v[16:31], a[128:131], v[144:147], v[16:31]
    s_waitcnt vmcnt(23)
    v_mfma_f32_32x32x16_bf16 v[16:31], a[132:135], v[148:151], v[16:31]
    s_waitcnt vmcnt(22)
    v_mfma_f32_32x32x16_bf16 v[16:31], a[136:139], v[152:155], v[16:31]
    s_waitcnt vmcnt(21)
    v_mfma_f32_32x32x16_bf16 v[16:31], a[140:143], v[156:159], v[16:31]
    s_waitcnt vmcnt(20)
    v_mfma_f32_32x32x16_bf16 v[16:31], a[144:147], v[160:163], v[16:31]
    s_waitcnt vmcnt(19)
    v_mfma_f32_32x32x16_bf16 v[16:31], a[148:151], v[164:167], v[16:31]
    s_waitcnt vmcnt(18)
    v_mfma_f32_32x32x16_bf16 v[16:31], a[152:155], v[168:171], v[16:31]
    s_waitcnt vmcnt(17)
    v_mfma_f32_32x32x16_bf16 v[16:31], a[156:159], v[172:175], v[16:31]
    s_waitcnt vmcnt(16)
    v_mfma_f32_32x32x16_bf16 v[16:31], a[160:163], v[176:179], v[16:31]
    s_waitcnt vmcnt(15)
    v_mfma_f32_32x32x16_bf16 v[16:31], a[164:167], v[180:183], v[16:31]
    s_waitcnt vmcnt(14)
    v_mfma_f32_32x32x16_bf16 v[16:31], a[168:171], v[184:187], v[16:31]
    s_waitcnt vmcnt(13)
    v_mfma_f32_32x32x16_bf16 v[16:31], a[172:175], v[188:191], v[16:31]
    s_waitcnt vmcnt(12)
    v_mfma_f32_32x32x16_bf16 v[16:31], a[176:179], v[192:195], v[16:31]
    s_waitcnt vmcnt(11)
    v_mfma_f32_32x32x16_bf16 v[16:31], a[180:183], v[196:199], v[16:31]
    s_waitcnt vmcnt(10)
    v_mfma_f32_32x32x16_bf16 v[16:31], a[184:187], v[200:203], v[16:31]
    s_waitcnt vmcnt(9)
    v_mfma_f32_32x32x16_bf16 v[16:31], a[188:191], v[204:207], v[16:31]
    s_waitcnt vmcnt(8)
    v_mfma_f32_32x32x16_bf16 v[16:31], a[192:195], v[208:211], v[16:31]
    s_waitcnt vmcnt(7)
    v_mfma_f32_32x32x16_bf16 v[16:31], a[196:199], v[212:215], v[16:31]
    s_waitcnt vmcnt(6)
    v_mfma_f32_32x32x16_bf16 v[16:31], a[200:203], v[216:219], v[16:31]
    s_waitcnt vmcnt(5)
    v_mfma_f32_32x32x16_bf16 v[16:31], a[204:207], v[220:223], v[16:31]
    s_waitcnt vmcnt(4)
    v_mfma_f32_32x32x16_bf16 v[16:31], a[208:211], v[224:227], v[16:31]
    s_waitcnt vmcnt(3)
    v_mfma_f32_32x32x16_bf16 v[16:31], a[212:215], v[228:231], v[16:31]
    s_waitcnt vmcnt(2)
    v_mfma_f32_32x32x16_bf16 v[16:31], a[216:219], v[232:235], v[16:31]
    s_waitcnt vmcnt(1)
    v_mfma_f32_32x32x16_bf16 v[16:31], a[220:223], v[236:239], v[16:31]
    v_add_u32 v4, s85, v10
    v_add_u32 v5, s85, v11
    s_xor_b32 s85, s85, 0x4000
    s_nop 8
    ds_write_b128 v4, v[16:19] offset:0
    ds_write_b128 v4, v[20:23] offset:1024
    ds_write_b128 v4, v[24:27] offset:2048
    ds_write_b128 v4, v[28:31] offset:3072
    s_waitcnt lgkmcnt(0)
    s_barrier
    ds_read_b128 v[32:35], v5 offset:0
    ds_read_b128 v[36:39], v5 offset:4096
    ds_read_b128 v[40:43], v5 offset:8192
    ds_read_b128 v[44:47], v5 offset:12288
    s_waitcnt lgkmcnt(2)
    v_add_f32 v32, v32, v36
    v_add_f32 v33, v33, v37
    v_add_f32 v34, v34, v38
    v_add_f32 v35, v35, v39
    s_waitcnt lgkmcnt(0)
    v_add_f32 v40, v40, v44
    v_add_f32 v41, v41, v45
    v_add_f32 v42, v42, v46
    v_add_f32 v43, v43, v47
    v_add_f32 v32, v32, v40
    v_add_f32 v33, v33, v41
    v_add_f32 v34, v34, v42
    v_add_f32 v35, v35, v43
    v_cvt_pk_bf16_f32 v36, v32, v33
    v_cvt_pk_bf16_f32 v37, v34, v35
    buffer_store_dwordx2 v[36:37], v12, s[8:11], s6 offen sc1
    v_mov_b32 v6, v15
    s_mov_b32 s76, s83
    s_mov_b32 s81, s82
    s_sub_u32 s77, s77, 1
    s_waitcnt vmcnt(0)
    v_mov_b32 v3, 1
    buffer_store_dword v3, v15, s[8:11], s84 offen sc1
    s_cmp_lg_u32 s77, 0
    s_cbranch_scc1 L_B_d_cold
    s_branch L_phase2_next
L_B_o:
    s_mov_b32 s16, s42
    s_and_b32 s17, s43, 0xffff
    s_mov_b32 s18, 8388608
    s_mov_b32 s19, 0x20000
    v_lshrrev_b32 v2, 2, v0
    v_and_b32 v3, 3, v0
    v_lshlrev_b32 v3, 4, v3
    v_lshrrev_b32 v4, 3, v2
    v_and_b32 v2, 7, v2
    v_lshl_add_u32 v2, v4, 6, v2
    v_lshl_add_u32 v8, v2, 11, v3
    s_mul_i32 s82, s63, 2097152
    s_lshl_b32 s4, s80, 6
    s_add_u32 s82, s82, s4
    s_lshl_b32 s70, s63, 15
    v_lshrrev_b32 v2, 5, v0
    v_bfe_u32 v3, v0, 2, 2
    v_lshl_add_u32 v2, v2, 2, v3
    v_lshlrev_b32 v2, 6, v2
    v_bfe_u32 v3, v0, 4, 1
    v_lshl_add_u32 v2, v3, 5, v2
    v_and_b32 v3, 3, v0
    v_lshl_add_u32 v2, v3, 3, v2
    v_add_u32 v9, s70, v2
    s_waitcnt vmcnt(0) lgkmcnt(0)
    s_barrier
    s_add_u32 m0, s70, 0
    s_add_u32 s4, s82, 0
    buffer_load_dwordx4 v8, s[16:19], s4 offen offset:0 lds
    s_add_u32 m0, s70, 1024
    s_add_u32 s4, s82, 16384
    buffer_load_dwordx4 v8, s[16:19], s4 offen offset:0 lds
    s_add_u32 m0, s70, 2048
    s_add_u32 s4, s82, 32768
    buffer_load_dwordx4 v8, s[16:19], s4 offen offset:0 lds
    s_add_u32 m0, s70, 3072
    s_add_u32 s4, s82, 49152
    buffer_load_dwordx4 v8, s[16:19], s4 offen offset:0 lds
    s_add_u32 m0, s70, 4096
    s_add_u32 s4, s82, 65536
    buffer_load_dwordx4 v8, s[16:19], s4 offen offset:0 lds
    s_add_u32 m0, s70, 5120
    s_add_u32 s4, s82, 81920
    buffer_load_dwordx4 v8, s[16:19], s4 offen offset:0 lds
    s_add_u32 m0, s70, 6144
    s_add_u32 s4, s82, 98304
    buffer_load_dwordx4 v8, s[16:19], s4 offen offset:0 lds
    s_add_u32 m0, s70, 7168
    s_add_u32 s4, s82, 114688
    buffer_load_dwordx4 v8, s[16:19], s4 offen offset:0 lds
    s_add_u32 m0, s70, 8192
    s_add_u32 s4, s82, 262144
    buffer_load_dwordx4 v8, s[16:19], s4 offen offset:0 lds
    s_add_u32 m0, s70, 9216
    s_add_u32 s4, s82, 278528
    buffer_load_dwordx4 v8, s[16:19], s4 offen offset:0 lds
    s_add_u32 m0, s70, 10240
    s_add_u32 s4, s82, 294912
    buffer_load_dwordx4 v8, s[16:19], s4 offen offset:0 lds
    s_add_u32 m0, s70, 11264
    s_add_u32 s4, s82, 311296
    buffer_load_dwordx4 v8, s[16:19], s4 offen offset:0 lds
    s_add_u32 m0, s70, 12288
    s_add_u32 s4, s82, 327680
    buffer_load_dwordx4 v8, s[16:19], s4 offen offset:0 lds
    s_add_u32 m0, s70, 13312
    s_add_u32 s4, s82, 344064
    buffer_load_dwordx4 v8, s[16:19], s4 offen offset:0 lds
    s_add_u32 m0, s70, 14336
    s_add_u32 s4, s82, 360448
    buffer_load_dwordx4 v8, s[16:19], s4 offen offset:0 lds
    s_add_u32 m0, s70, 15360
    s_add_u32 s4, s82, 376832
    buffer_load_dwordx4 v8, s[16:19], s4 offen offset:0 lds
    s_add_u32 m0, s70, 16384
    s_add_u32 s4, s82, 524288
    buffer_load_dwordx4 v8, s[16:19], s4 offen offset:0 lds
    s_add_u32 m0, s70, 17408
    s_add_u32 s4, s82, 540672
    buffer_load_dwordx4 v8, s[16:19], s4 offen offset:0 lds
    s_add_u32 m0, s70, 18432
    s_add_u32 s4, s82, 557056
    buffer_load_dwordx4 v8, s[16:19], s4 offen offset:0 lds
    s_add_u32 m0, s70, 19456
    s_add_u32 s4, s82, 573440
    buffer_load_dwordx4 v8, s[16:19], s4 offen offset:0 lds
    s_add_u32 m0, s70, 20480
    s_add_u32 s4, s82, 589824
    buffer_load_dwordx4 v8, s[16:19], s4 offen offset:0 lds
    s_add_u32 m0, s70, 21504
    s_add_u32 s4, s82, 606208
    buffer_load_dwordx4 v8, s[16:19], s4 offen offset:0 lds
    s_add_u32 m0, s70, 22528
    s_add_u32 s4, s82, 622592
    buffer_load_dwordx4 v8, s[16:19], s4 offen offset:0 lds
    s_add_u32 m0, s70, 23552
    s_add_u32 s4, s82, 638976
    buffer_load_dwordx4 v8, s[16:19], s4 offen offset:0 lds
    s_add_u32 m0, s70, 24576
    s_add_u32 s4, s82, 786432
    buffer_load_dwordx4 v8, s[16:19], s4 offen offset:0 lds
    s_add_u32 m0, s70, 25600
    s_add_u32 s4, s82, 802816
    buffer_load_dwordx4 v8, s[16:19], s4 offen offset:0 lds
    s_add_u32 m0, s70, 26624
    s_add_u32 s4, s82, 819200
    buffer_load_dwordx4 v8, s[16:19], s4 offen offset:0 lds
    s_add_u32 m0, s70, 27648
    s_add_u32 s4, s82, 835584
    buffer_load_dwordx4 v8, s[16:19], s4 offen offset:0 lds
    s_add_u32 m0, s70, 28672
    s_add_u32 s4, s82, 851968
    buffer_load_dwordx4 v8, s[16:19], s4 offen offset:0 lds
    s_add_u32 m0, s70, 29696
    s_add_u32 s4, s82, 868352
    buffer_load_dwordx4 v8, s[16:19], s4 offen offset:0 lds
    s_add_u32 m0, s70, 30720
    s_add_u32 s4, s82, 884736
    buffer_load_dwordx4 v8, s[16:19], s4 offen offset:0 lds
    s_add_u32 m0, s70, 31744
    s_add_u32 s4, s82, 901120
    buffer_load_dwordx4 v8, s[16:19], s4 offen offset:0 lds
    s_waitcnt vmcnt(24)
    ds_read_b64_tr_b16 a[0:1], v9 offset:0
    ds_read_b64_tr_b16 a[2:3], v9 offset:512
    ds_read_b64_tr_b16 a[4:5], v9 offset:1024
    ds_read_b64_tr_b16 a[6:7], v9 offset:1536
    ds_read_b64_tr_b16 a[8:9], v9 offset:2048
    ds_read_b64_tr_b16 a[10:11], v9 offset:2560
    ds_read_b64_tr_b16 a[12:13], v9 offset:3072
    ds_read_b64_tr_b16 a[14:15], v9 offset:3584
    ds_read_b64_tr_b16 a[16:17], v9 offset:4096
    ds_read_b64_tr_b16 a[18:19], v9 offset:4608
    ds_read_b64_tr_b16 a[20:21], v9 offset:5120
    ds_read_b64_tr_b16 a[22:23], v9 offset:5632
    ds_read_b64_tr_b16 a[24:25], v9 offset:6144
    ds_read_b64_tr_b16 a[26:27], v9 offset:6656
    ds_read_b64_tr_b16 a[28:29], v9 offset:7168
    ds_read_b64_tr_b16 a[30:31], v9 offset:7680
    s_waitcnt lgkmcnt(0)
    s_add_u32 m0, s70, 0
    s_add_u32 s4, s82, 1048576
    buffer_load_dwordx4 v8, s[16:19], s4 offen offset:0 lds
    s_add_u32 m0, s70, 1024
    s_add_u32 s4, s82, 1064960
    buffer_load_dwordx4 v8, s[16:19], s4 offen offset:0 lds
    s_add_u32 m0, s70, 2048
    s_add_u32 s4, s82, 1081344
    buffer_load_dwordx4 v8, s[16:19], s4 offen offset:0 lds
    s_add_u32 m0, s70, 3072
    s_add_u32 s4, s82, 1097728
    buffer_load_dwordx4 v8, s[16:19], s4 offen offset:0 lds
    s_add_u32 m0, s70, 4096
    s_add_u32 s4, s82, 1114112
    buffer_load_dwordx4 v8, s[16:19], s4 offen offset:0 lds
    s_add_u32 m0, s70, 5120
    s_add_u32 s4, s82, 1130496
    buffer_load_dwordx4 v8, s[16:19], s4 offen offset:0 lds
    s_add_u32 m0, s70, 6144
    s_add_u32 s4, s82, 1146880
    buffer_load_dwordx4 v8, s[16:19], s4 offen offset:0 lds
    s_add_u32 m0, s70, 7168
    s_add_u32 s4, s82, 1163264
    buffer_load_dwordx4 v8, s[16:19], s4 offen offset:0 lds
    s_waitcnt vmcnt(24)
    ds_read_b64_tr_b16 a[32:33], v9 offset:8192
    ds_read_b64_tr_b16 a[34:35], v9 offset:8704
    ds_read_b64_tr_b16 a[36:37], v9 offset:9216
    ds_read_b64_tr_b16 a[38:39], v9 offset:9728
    ds_read_b64_tr_b16 a[40:41], v9 offset:10240
    ds_read_b64_tr_b16 a[42:43], v9 offset:10752
    ds_read_b64_tr_b16 a[44:45], v9 offset:11264
    ds_read_b64_tr_b16 a[46:47], v9 offset:11776
    ds_read_b64_tr_b16 a[48:49], v9 offset:12288
    ds_read_b64_tr_b16 a[50:51], v9 offset:12800
    ds_read_b64_tr_b16 a[52:53], v9 offset:13312
    ds_read_b64_tr_b16 a[54:55], v9 offset:13824
    ds_read_b64_tr_b16 a[56:57], v9 offset:14336
    ds_read_b64_tr_b16 a[58:59], v9 offset:14848
    ds_read_b64_tr_b16 a[60:61], v9 offset:15360
    ds_read_b64_tr_b16 a[62:63], v9 offset:15872
    s_waitcnt lgkmcnt(0)
    s_add_u32 m0, s70, 8192
    s_add_u32 s4, s82, 1310720
    buffer_load_dwordx4 v8, s[16:19], s4 offen offset:0 lds
    s_add_u32 m0, s70, 9216
    s_add_u32 s4, s82, 1327104
    buffer_load_dwordx4 v8, s[16:19], s4 offen offset:0 lds
    s_add_u32 m0, s70, 10240
    s_add_u32 s4, s82, 1343488
    buffer_load_dwordx4 v8, s[16:19], s4 offen offset:0 lds
    s_add_u32 m0, s70, 11264
    s_add_u32 s4, s82, 1359872
    buffer_load_dwordx4 v8, s[16:19], s4 offen offset:0 lds
    s_add_u32 m0, s70, 12288
    s_add_u32 s4, s82, 1376256
    buffer_load_dwordx4 v8, s[16:19], s4 offen offset:0 lds
    s_add_u32 m0, s70, 13312
    s_add_u32 s4, s82, 1392640
    buffer_load_dwordx4 v8, s[16:19], s4 offen offset:0 lds
    s_add_u32 m0, s70, 14336
    s_add_u32 s4, s82, 1409024
    buffer_load_dwordx4 v8, s[16:19], s4 offen offset:0 lds
    s_add_u32 m0, s70, 15360
    s_add_u32 s4, s82, 1425408
    buffer_load_dwordx4 v8, s[16:19], s4 offen offset:0 lds
    s_waitcnt vmcnt(24)
    ds_read_b64_tr_b16 a[64:65], v9 offset:16384
    ds_read_b64_tr_b16 a[66:67], v9 offset:16896
    ds_read_b64_tr_b16 a[68:69], v9 offset:17408
    ds_read_b64_tr_b16 a[70:71], v9 offset:17920
    ds_read_b64_tr_b16 a[72:73], v9 offset:18432
    ds_read_b64_tr_b16 a[74:75], v9 offset:18944
    ds_read_b64_tr_b16 a[76:77], v9 offset:19456
    ds_read_b64_tr_b16 a[78:79], v9 offset:19968
    ds_read_b64_tr_b16 a[80:81], v9 offset:20480
    ds_read_b64_tr_b16 a[82:83], v9 offset:20992
    ds_read_b64_tr_b16 a[84:85], v9 offset:21504
    ds_read_b64_tr_b16 a[86:87], v9 offset:22016
    ds_read_b64_tr_b16 a[88:89], v9 offset:22528
    ds_read_b64_tr_b16 a[90:91], v9 offset:23040
    ds_read_b64_tr_b16 a[92:93], v9 offset:23552
    ds_read_b64_tr_b16 a[94:95], v9 offset:24064
    s_waitcnt lgkmcnt(0)
    s_add_u32 m0, s70, 16384
    s_add_u32 s4, s82, 1572864
    buffer_load_dwordx4 v8, s[16:19], s4 offen offset:0 lds
    s_add_u32 m0, s70, 17408
    s_add_u32 s4, s82, 1589248
    buffer_load_dwordx4 v8, s[16:19], s4 offen offset:0 lds
    s_add_u32 m0, s70, 18432
    s_add_u32 s4, s82, 1605632
    buffer_load_dwordx4 v8, s[16:19], s4 offen offset:0 lds
    s_add_u32 m0, s70, 19456
    s_add_u32 s4, s82, 1622016
    buffer_load_dwordx4 v8, s[16:19], s4 offen offset:0 lds
    s_add_u32 m0, s70, 20480
    s_add_u32 s4, s82, 1638400
    buffer_load_dwordx4 v8, s[16:19], s4 offen offset:0 lds
    s_add_u32 m0, s70, 21504
    s_add_u32 s4, s82, 1654784
    buffer_load_dwordx4 v8, s[16:19], s4 offen offset:0 lds
    s_add_u32 m0, s70, 22528
    s_add_u32 s4, s82, 1671168
    buffer_load_dwordx4 v8, s[16:19], s4 offen offset:0 lds
    s_add_u32 m0, s70, 23552
    s_add_u32 s4, s82, 1687552
    buffer_load_dwordx4 v8, s[16:19], s4 offen offset:0 lds
    s_waitcnt vmcnt(24)
    ds_read_b64_tr_b16 a[96:97], v9 offset:24576
    ds_read_b64_tr_b16 a[98:99], v9 offset:25088
    ds_read_b64_tr_b16 a[100:101], v9 offset:25600
    ds_read_b64_tr_b16 a[102:103], v9 offset:26112
    ds_read_b64_tr_b16 a[104:105], v9 offset:26624
    ds_read_b64_tr_b16 a[106:107], v9 offset:27136
    ds_read_b64_tr_b16 a[108:109], v9 offset:27648
    ds_read_b64_tr_b16 a[110:111], v9 offset:28160
    ds_read_b64_tr_b16 a[112:113], v9 offset:28672
    ds_read_b64_tr_b16 a[114:115], v9 offset:29184
    ds_read_b64_tr_b16 a[116:117], v9 offset:29696
    ds_read_b64_tr_b16 a[118:119], v9 offset:30208
    ds_read_b64_tr_b16 a[120:121], v9 offset:30720
    ds_read_b64_tr_b16 a[122:123], v9 offset:31232
    ds_read_b64_tr_b16 a[124:125], v9 offset:31744
    ds_read_b64_tr_b16 a[126:127], v9 offset:32256
    s_waitcnt lgkmcnt(0)
    s_add_u32 m0, s70, 24576
    s_add_u32 s4, s82, 1835008
    buffer_load_dwordx4 v8, s[16:19], s4 offen offset:0 lds
    s_add_u32 m0, s70, 25600
    s_add_u32 s4, s82, 1851392
    buffer_load_dwordx4 v8, s[16:19], s4 offen offset:0 lds
    s_add_u32 m0, s70, 26624
    s_add_u32 s4, s82, 1867776
    buffer_load_dwordx4 v8, s[16:19], s4 offen offset:0 lds
    s_add_u32 m0, s70, 27648
    s_add_u32 s4, s82, 1884160
    buffer_load_dwordx4 v8, s[16:19], s4 offen offset:0 lds
    s_add_u32 m0, s70, 28672
    s_add_u32 s4, s82, 1900544
    buffer_load_dwordx4 v8, s[16:19], s4 offen offset:0 lds
    s_add_u32 m0, s70, 29696
    s_add_u32 s4, s82, 1916928
    buffer_load_dwordx4 v8, s[16:19], s4 offen offset:0 lds
    s_add_u32 m0, s70, 30720
    s_add_u32 s4, s82, 1933312
    buffer_load_dwordx4 v8, s[16:19], s4 offen offset:0 lds
    s_add_u32 m0, s70, 31744
    s_add_u32 s4, s82, 1949696
    buffer_load_dwordx4 v8, s[16:19], s4 offen offset:0 lds
    s_waitcnt vmcnt(24)
    ds_read_b64_tr_b16 a[128:129], v9 offset:0
    ds_read_b64_tr_b16 a[130:131], v9 offset:512
    ds_read_b64_tr_b16 a[132:133], v9 offset:1024
    ds_read_b64_tr_b16 a[134:135], v9 offset:1536
    ds_read_b64_tr_b16 a[136:137], v9 offset:2048
    ds_read_b64_tr_b16 a[138:139], v9 offset:2560
    ds_read_b64_tr_b16 a[140:141], v9 offset:3072
    ds_read_b64_tr_b16 a[142:143], v9 offset:3584
    ds_read_b64_tr_b16 a[144:145], v9 offset:4096
    ds_read_b64_tr_b16 a[146:147], v9 offset:4608
    ds_read_b64_tr_b16 a[148:149], v9 offset:5120
    ds_read_b64_tr_b16 a[150:151], v9 offset:5632
    ds_read_b64_tr_b16 a[152:153], v9 offset:6144
    ds_read_b64_tr_b16 a[154:155], v9 offset:6656
    ds_read_b64_tr_b16 a[156:157], v9 offset:7168
    ds_read_b64_tr_b16 a[158:159], v9 offset:7680
    s_waitcnt lgkmcnt(0)
    s_waitcnt vmcnt(16)
    ds_read_b64_tr_b16 a[160:161], v9 offset:8192
    ds_read_b64_tr_b16 a[162:163], v9 offset:8704
    ds_read_b64_tr_b16 a[164:165], v9 offset:9216
    ds_read_b64_tr_b16 a[166:167], v9 offset:9728
    ds_read_b64_tr_b16 a[168:169], v9 offset:10240
    ds_read_b64_tr_b16 a[170:171], v9 offset:10752
    ds_read_b64_tr_b16 a[172:173], v9 offset:11264
    ds_read_b64_tr_b16 a[174:175], v9 offset:11776
    ds_read_b64_tr_b16 a[176:177], v9 offset:12288
    ds_read_b64_tr_b16 a[178:179], v9 offset:12800
    ds_read_b64_tr_b16 a[180:181], v9 offset:13312
    ds_read_b64_tr_b16 a[182:183], v9 offset:13824
    ds_read_b64_tr_b16 a[184:185], v9 offset:14336
    ds_read_b64_tr_b16 a[186:187], v9 offset:14848
    ds_read_b64_tr_b16 a[188:189], v9 offset:15360
    ds_read_b64_tr_b16 a[190:191], v9 offset:15872
    s_waitcnt lgkmcnt(0)
    s_waitcnt vmcnt(8)
    ds_read_b64_tr_b16 a[192:193], v9 offset:16384
    ds_read_b64_tr_b16 a[194:195], v9 offset:16896
    ds_read_b64_tr_b16 a[196:197], v9 offset:17408
    ds_read_b64_tr_b16 a[198:199], v9 offset:17920
    ds_read_b64_tr_b16 a[200:201], v9 offset:18432
    ds_read_b64_tr_b16 a[202:203], v9 offset:18944
    ds_read_b64_tr_b16 a[204:205], v9 offset:19456
    ds_read_b64_tr_b16 a[206:207], v9 offset:19968
    ds_read_b64_tr_b16 a[208:209], v9 offset:20480
    ds_read_b64_tr_b16 a[210:211], v9 offset:20992
    ds_read_b64_tr_b16 a[212:213], v9 offset:21504
    ds_read_b64_tr_b16 a[214:215], v9 offset:22016
    ds_read_b64_tr_b16 a[216:217], v9 offset:22528
    ds_read_b64_tr_b16 a[218:219], v9 offset:23040
    ds_read_b64_tr_b16 a[220:221], v9 offset:23552
    ds_read_b64_tr_b16 a[222:223], v9 offset:24064
    s_waitcnt lgkmcnt(0)
    s_waitcnt vmcnt(0)
    ds_read_b64_tr_b16 a[224:225], v9 offset:24576
    ds_read_b64_tr_b16 a[226:227], v9 offset:25088
    ds_read_b64_tr_b16 a[228:229], v9 offset:25600
    ds_read_b64_tr_b16 a[230:231], v9 offset:26112
    ds_read_b64_tr_b16 a[232:233], v9 offset:26624
    ds_read_b64_tr_b16 a[234:235], v9 offset:27136
    ds_read_b64_tr_b16 a[236:237], v9 offset:27648
    ds_read_b64_tr_b16 a[238:239], v9 offset:28160
    ds_read_b64_tr_b16 a[240:241], v9 offset:28672
    ds_read_b64_tr_b16 a[242:243], v9 offset:29184
    ds_read_b64_tr_b16 a[244:245], v9 offset:29696
    ds_read_b64_tr_b16 a[246:247], v9 offset:30208
    ds_read_b64_tr_b16 a[248:249], v9 offset:30720
    ds_read_b64_tr_b16 a[250:251], v9 offset:31232
    ds_read_b64_tr_b16 a[252:253], v9 offset:31744
    ds_read_b64_tr_b16 a[254:255], v9 offset:32256
    s_waitcnt lgkmcnt(0)
    v_bfe_u32 v2, v0, 2, 3
    s_lshl_b32 s4, s63, 3
    s_lshr_b32 s5, s63, 1
    s_lshl_b32 s5, s5, 4
    s_add_u32 s4, s4, s5
    v_add_u32 v2, s4, v2
    v_and_b32 v3, 3, v0
    v_lshlrev_b32 v3, 2, v3
    v_lshl_add_u32 v9, v2, 7, v3
    v_add_u32 v9, 104923136, v9
    s_lshl_b32 s4, s63, 12
    s_add_u32 s4, s4, 0x20000
    v_add_u32 v10, s4, v1
    v_lshrrev_b32 v2, 3, v0
    s_lshl_b32 s4, s63, 3
    v_add_u32 v2, s4, v2
    v_and_b32 v3, 7, v0
    v_lshlrev_b32 v4, 4, v2
    v_lshl_add_u32 v4, v3, 9, v4
    v_add_u32 v11, 0x20000, v4
    s_lshl_b32 s4, s63, 9
    v_lshl_add_u32 v12, v0, 3, s4
    v_lshlrev_b32 v13, 2, v2
    v_lshlrev_b32 v3, 3, v3
    s_lshl_b32 s4, s80, 6
    v_lshl_add_u32 v3, v2, 11, v3
    v_add_u32 v14, s4, v3
    v_mov_b32 v7, 0
    s_mov_b32 s85, 0
    s_mov_b32 s84, 104988672
    v_bfe_u32 v2, v0, 2, 3
    v_and_b32 v3, 3, v0
    v_lshlrev_b32 v3, 2, v3
    v_lshl_add_u32 v3, v2, 7, v3
    s_mov_b32 s5, 104950784
L_gw_64:
    buffer_load_dword v2, v3, s[8:11], s5 offen sc1
    s_waitcnt vmcnt(0)
    v_cmp_gt_u32 vcc, 64, v2
    s_cbranch_vccz L_gwd_65
    s_sleep 4
    s_sub_u32 s65, s65, 1
    s_cmp_gt_i32 s65, 0
    s_cbranch_scc1 L_gw_64
L_gwd_65:
    s_cmp_eq_u32 s77, 0
    s_cbranch_scc1 L_B_o_end
L_B_o_cold:
    buffer_load_dword v2, v9, s[8:11], 0 offen sc1
    s_waitcnt vmcnt(0)
    v_cmp_ge_u32 vcc, s76, v2
    s_cbranch_vccz L_cd_66
    s_sleep 2
    s_sub_u32 s65, s65, 1
    s_cmp_gt_i32 s65, 0
    s_cbranch_scc1 L_B_o_cold
L_cd_66:
    s_mul_i32 s81, s76, 262144
    s_mul_i32 s4, s63, 65536
    s_add_u32 s81, s81, s4
    s_add_u32 s81, s81, 67108864
    s_mul_i32 s4, s80, 2048
    s_add_u32 s4, s4, s81
    v_lshlrev_b32 v4, 1, v1
    buffer_load_dword v3, v4, s[8:11], s4 offen sc1
    s_add_u32 s5, s81, 0
    buffer_load_dwordx4 v[128:131], v1, s[8:11], s5 offen offset:0 sc1
    buffer_load_dwordx4 v[132:135], v1, s[8:11], s5 offen offset:1024 sc1
    buffer_load_dwordx4 v[136:139], v1, s[8:11], s5 offen offset:2048 sc1
    buffer_load_dwordx4 v[140:143], v1, s[8:11], s5 offen offset:3072 sc1
    s_add_u32 s5, s81, 4096
    buffer_load_dwordx4 v[144:147], v1, s[8:11], s5 offen offset:0 sc1
    buffer_load_dwordx4 v[148:151], v1, s[8:11], s5 offen offset:1024 sc1
    buffer_load_dwordx4 v[152:155], v1, s[8:11], s5 offen offset:2048 sc1
    buffer_load_dwordx4 v[156:159], v1, s[8:11], s5 offen offset:3072 sc1
    s_add_u32 s5, s81, 8192
    buffer_load_dwordx4 v[160:163], v1, s[8:11], s5 offen offset:0 sc1
    buffer_load_dwordx4 v[164:167], v1, s[8:11], s5 offen offset:1024 sc1
    buffer_load_dwordx4 v[168:171], v1, s[8:11], s5 offen offset:2048 sc1
    buffer_load_dwordx4 v[172:175], v1, s[8:11], s5 offen offset:3072 sc1
    s_add_u32 s5, s81, 12288
    buffer_load_dwordx4 v[176:179], v1, s[8:11], s5 offen offset:0 sc1
    buffer_load_dwordx4 v[180:183], v1, s[8:11], s5 offen offset:1024 sc1
    buffer_load_dwordx4 v[184:187], v1, s[8:11], s5 offen offset:2048 sc1
    buffer_load_dwordx4 v[188:191], v1, s[8:11], s5 offen offset:3072 sc1
    s_add_u32 s5, s81, 16384
    buffer_load_dwordx4 v[192:195], v1, s[8:11], s5 offen offset:0 sc1
    buffer_load_dwordx4 v[196:199], v1, s[8:11], s5 offen offset:1024 sc1
    buffer_load_dwordx4 v[200:203], v1, s[8:11], s5 offen offset:2048 sc1
    buffer_load_dwordx4 v[204:207], v1, s[8:11], s5 offen offset:3072 sc1
    s_add_u32 s5, s81, 20480
    buffer_load_dwordx4 v[208:211], v1, s[8:11], s5 offen offset:0 sc1
    buffer_load_dwordx4 v[212:215], v1, s[8:11], s5 offen offset:1024 sc1
    buffer_load_dwordx4 v[216:219], v1, s[8:11], s5 offen offset:2048 sc1
    buffer_load_dwordx4 v[220:223], v1, s[8:11], s5 offen offset:3072 sc1
    s_add_u32 s5, s81, 24576
    buffer_load_dwordx4 v[224:227], v1, s[8:11], s5 offen offset:0 sc1
    buffer_load_dwordx4 v[228:231], v1, s[8:11], s5 offen offset:1024 sc1
    buffer_load_dwordx4 v[232:235], v1, s[8:11], s5 offen offset:2048 sc1
    buffer_load_dwordx4 v[236:239], v1, s[8:11], s5 offen offset:3072 sc1
    s_add_u32 s5, s81, 28672
    buffer_load_dwordx4 v[240:243], v1, s[8:11], s5 offen offset:0 sc1
    buffer_load_dwordx4 v[244:247], v1, s[8:11], s5 offen offset:1024 sc1
    buffer_load_dwordx4 v[248:251], v1, s[8:11], s5 offen offset:2048 sc1
    buffer_load_dwordx4 v[252:255], v1, s[8:11], s5 offen offset:3072 sc1
L_B_o_warm:
    s_lshl_b32 s6, s76, 5
    s_add_u32 s6, s6, s80
    s_lshl_b32 s7, s6, 2
    s_add_u32 s7, s7, s63
    s_lshl_b32 s7, s7, 2
    s_add_u32 s7, s7, 104988672
    s_lshl_b32 s6, s6, 11
    s_add_u32 s6, s6, 100663296
    s_bitset0_b64 s[88:89], s76
    s_ff1_i32_b64 s83, s[88:89]
    s_and_b32 s83, s83, 63
    buffer_load_dword v2, v9, s[8:11], 0 offen sc1
    buffer_load_dword v3, v7, s[8:11], s7 offen sc1
    s_waitcnt vmcnt(33)
    v_mfma_f32_32x32x16_bf16 v[16:31], a[0:3], v[128:131], 0
    s_add_u32 s5, s81, 32768
    buffer_load_dwordx4 v[128:131], v1, s[8:11], s5 offen offset:0 sc1
    s_waitcnt vmcnt(33)
    v_mfma_f32_32x32x16_bf16 v[16:31], a[4:7], v[132:135], v[16:31]
    buffer_load_dwordx4 v[132:135], v1, s[8:11], s5 offen offset:1024 sc1
    s_waitcnt vmcnt(33)
    v_mfma_f32_32x32x16_bf16 v[16:31], a[8:11], v[136:139], v[16:31]
    buffer_load_dwordx4 v[136:139], v1, s[8:11], s5 offen offset:2048 sc1
    s_waitcnt vmcnt(33)
    v_mfma_f32_32x32x16_bf16 v[16:31], a[12:15], v[140:143], v[16:31]
    buffer_load_dwordx4 v[140:143], v1, s[8:11], s5 offen offset:3072 sc1
    s_waitcnt vmcnt(33)
    v_mfma_f32_32x32x16_bf16 v[16:31], a[16:19], v[144:147], v[16:31]
    s_add_u32 s5, s81, 36864
    buffer_load_dwordx4 v[144:147], v1, s[8:11], s5 offen offset:0 sc1
    s_waitcnt vmcnt(33)
    v_mfma_f32_32x32x16_bf16 v[16:31], a[20:23], v[148:151], v[16:31]
    buffer_load_dwordx4 v[148:151], v1, s[8:11], s5 offen offset:1024 sc1
    s_waitcnt vmcnt(33)
    v_mfma_f32_32x32x16_bf16 v[16:31], a[24:27], v[152:155], v[16:31]
    buffer_load_dwordx4 v[152:155], v1, s[8:11], s5 offen offset:2048 sc1
    s_waitcnt vmcnt(33)
    v_mfma_f32_32x32x16_bf16 v[16:31], a[28:31], v[156:159], v[16:31]
    buffer_load_dwordx4 v[156:159], v1, s[8:11], s5 offen offset:3072 sc1
    s_waitcnt vmcnt(33)
    v_mfma_f32_32x32x16_bf16 v[16:31], a[32:35], v[160:163], v[16:31]
    s_add_u32 s5, s81, 40960
    buffer_load_dwordx4 v[160:163], v1, s[8:11], s5 offen offset:0 sc1
    s_waitcnt vmcnt(33)
    v_mfma_f32_32x32x16_bf16 v[16:31], a[36:39], v[164:167], v[16:31]
    buffer_load_dwordx4 v[164:167], v1, s[8:11], s5 offen offset:1024 sc1
    s_waitcnt vmcnt(33)
    v_mfma_f32_32x32x16_bf16 v[16:31], a[40:43], v[168:171], v[16:31]
    buffer_load_dwordx4 v[168:171], v1, s[8:11], s5 offen offset:2048 sc1
    s_waitcnt vmcnt(33)
    v_mfma_f32_32x32x16_bf16 v[16:31], a[44:47], v[172:175], v[16:31]
    buffer_load_dwordx4 v[172:175], v1, s[8:11], s5 offen offset:3072 sc1
    s_waitcnt vmcnt(33)
    v_mfma_f32_32x32x16_bf16 v[16:31], a[48:51], v[176:179], v[16:31]
    s_add_u32 s5, s81, 45056
    buffer_load_dwordx4 v[176:179], v1, s[8:11], s5 offen offset:0 sc1
    s_waitcnt vmcnt(33)
    v_mfma_f32_32x32x16_bf16 v[16:31], a[52:55], v[180:183], v[16:31]
    buffer_load_dwordx4 v[180:183], v1, s[8:11], s5 offen offset:1024 sc1
    s_waitcnt vmcnt(33)
    v_mfma_f32_32x32x16_bf16 v[16:31], a[56:59], v[184:187], v[16:31]
    buffer_load_dwordx4 v[184:187], v1, s[8:11], s5 offen offset:2048 sc1
    s_waitcnt vmcnt(33)
    v_mfma_f32_32x32x16_bf16 v[16:31], a[60:63], v[188:191], v[16:31]
    buffer_load_dwordx4 v[188:191], v1, s[8:11], s5 offen offset:3072 sc1
    s_waitcnt vmcnt(33)
    v_mfma_f32_32x32x16_bf16 v[16:31], a[64:67], v[192:195], v[16:31]
    s_add_u32 s5, s81, 49152
    buffer_load_dwordx4 v[192:195], v1, s[8:11], s5 offen offset:0 sc1
    s_waitcnt vmcnt(33)
    v_mfma_f32_32x32x16_bf16 v[16:31], a[68:71], v[196:199], v[16:31]
    buffer_load_dwordx4 v[196:199], v1, s[8:11], s5 offen offset:1024 sc1
    s_waitcnt vmcnt(33)
    v_mfma_f32_32x32x16_bf16 v[16:31], a[72:75], v[200:203], v[16:31]
    buffer_load_dwordx4 v[200:203], v1, s[8:11], s5 offen offset:2048 sc1
    s_waitcnt vmcnt(33)
    v_mfma_f32_32x32x16_bf16 v[16:31], a[76:79], v[204:207], v[16:31]
    buffer_load_dwordx4 v[204:207], v1, s[8:11], s5 offen offset:3072 sc1
    s_waitcnt vmcnt(33)
    v_mfma_f32_32x32x16_bf16 v[16:31], a[80:83], v[208:211], v[16:31]
    s_add_u32 s5, s81, 53248
    buffer_load_dwordx4 v[208:211], v1, s[8:11], s5 offen offset:0 sc1
    s_waitcnt vmcnt(33)
    v_mfma_f32_32x32x16_bf16 v[16:31], a[84:87], v[212:215], v[16:31]
    buffer_load_dwordx4 v[212:215], v1, s[8:11], s5 offen offset:1024 sc1
    s_waitcnt vmcnt(33)
    v_mfma_f32_32x32x16_bf16 v[16:31], a[88:91], v[216:219], v[16:31]
    buffer_load_dwordx4 v[216:219], v1, s[8:11], s5 offen offset:2048 sc1
    s_waitcnt vmcnt(33)
    v_mfma_f32_32x32x16_bf16 v[16:31], a[92:95], v[220:223], v[16:31]
    buffer_load_dwordx4 v[220:223], v1, s[8:11], s5 offen offset:3072 sc1
    s_waitcnt vmcnt(33)
    v_mfma_f32_32x32x16_bf16 v[16:31], a[96:99], v[224:227], v[16:31]
    s_add_u32 s5, s81, 57344
    buffer_load_dwordx4 v[224:227], v1, s[8:11], s5 offen offset:0 sc1
    s_waitcnt vmcnt(33)
    v_mfma_f32_32x32x16_bf16 v[16:31], a[100:103], v[228:231], v[16:31]
    buffer_load_dwordx4 v[228:231], v1, s[8:11], s5 offen offset:1024 sc1
    s_waitcnt vmcnt(33)
    v_mfma_f32_32x32x16_bf16 v[16:31], a[104:107], v[232:235], v[16:31]
    buffer_load_dwordx4 v[232:235], v1, s[8:11], s5 offen offset:2048 sc1
    s_waitcnt vmcnt(33)
    v_mfma_f32_32x32x16_bf16 v[16:31], a[108:111], v[236:239], v[16:31]
    buffer_load_dwordx4 v[236:239], v1, s[8:11], s5 offen offset:3072 sc1
    s_waitcnt vmcnt(33)
    v_mfma_f32_32x32x16_bf16 v[16:31], a[112:115], v[240:243], v[16:31]
    s_add_u32 s5, s81, 61440
    buffer_load_dwordx4 v[240:243], v1, s[8:11], s5 offen offset:0 sc1
    s_waitcnt vmcnt(33)
    v_mfma_f32_32x32x16_bf16 v[16:31], a[116:119], v[244:247], v[16:31]
    buffer_load_dwordx4 v[244:247], v1, s[8:11], s5 offen offset:1024 sc1
    s_waitcnt vmcnt(33)
    v_mfma_f32_32x32x16_bf16 v[16:31], a[120:123], v[248:251], v[16:31]
    buffer_load_dwordx4 v[248:251], v1, s[8:11], s5 offen offset:2048 sc1
    s_waitcnt vmcnt(33)
    v_mfma_f32_32x32x16_bf16 v[16:31], a[124:127], v[252:255], v[16:31]
    buffer_load_dwordx4 v[252:255], v1, s[8:11], s5 offen offset:3072 sc1
    s_waitcnt vmcnt(32)
L_bw_67:
    v_cmp_eq_u32 vcc, 0, v3
    s_cbranch_vccz L_bwd_68
    s_sleep 2
    buffer_load_dword v3, v7, s[8:11], s7 offen sc1
    s_waitcnt vmcnt(0)
    s_sub_u32 s65, s65, 1
    s_cmp_gt_i32 s65, 0
    s_cbranch_scc1 L_bw_67
L_bwd_68:
    s_lshl_b32 s4, s76, 7
    s_add_u32 s4, s4, 104857600
    buffer_load_dwordx2 v[48:49], v12, s[8:11], s6 offen sc1
    buffer_load_dword v50, v13, s[8:11], s4 offen sc1
    s_mul_i32 s82, s83, 262144
    s_mul_i32 s4, s63, 65536
    s_add_u32 s82, s82, s4
    s_add_u32 s82, s82, 67108864
    s_cmp_le_u32 s77, 1
    s_cbranch_scc1 L_B_o_nopf
    v_cmp_ge_u32 vcc, s83, v2
    s_cbranch_vccnz L_B_o_nopf
    s_waitcnt vmcnt(33)
    v_mfma_f32_32x32x16_bf16 v[16:31], a[128:131], v[128:131], v[16:31]
    s_add_u32 s5, s82, 0
    buffer_load_dwordx4 v[128:131], v1, s[8:11], s5 offen offset:0 sc1
    s_waitcnt vmcnt(33)
    v_mfma_f32_32x32x16_bf16 v[16:31], a[132:135], v[132:135], v[16:31]
    buffer_load_dwordx4 v[132:135], v1, s[8:11], s5 offen offset:1024 sc1
    s_waitcnt vmcnt(33)
    v_mfma_f32_32x32x16_bf16 v[16:31], a[136:139], v[136:139], v[16:31]
    buffer_load_dwordx4 v[136:139], v1, s[8:11], s5 offen offset:2048 sc1
    s_waitcnt vmcnt(33)
    v_mfma_f32_32x32x16_bf16 v[16:31], a[140:143], v[140:143], v[16:31]
    buffer_load_dwordx4 v[140:143], v1, s[8:11], s5 offen offset:3072 sc1
    s_waitcnt vmcnt(33)
    v_mfma_f32_32x32x16_bf16 v[16:31], a[144:147], v[144:147], v[16:31]
    s_add_u32 s5, s82, 4096
    buffer_load_dwordx4 v[144:147], v1, s[8:11], s5 offen offset:0 sc1
    s_waitcnt vmcnt(33)
    v_mfma_f32_32x32x16_bf16 v[16:31], a[148:151], v[148:151], v[16:31]
    buffer_load_dwordx4 v[148:151], v1, s[8:11], s5 offen offset:1024 sc1
    s_waitcnt vmcnt(33)
    v_mfma_f32_32x32x16_bf16 v[16:31], a[152:155], v[152:155], v[16:31]
    buffer_load_dwordx4 v[152:155], v1, s[8:11], s5 offen offset:2048 sc1
    s_waitcnt vmcnt(33)
    v_mfma_f32_32x32x16_bf16 v[16:31], a[156:159], v[156:159], v[16:31]
    buffer_load_dwordx4 v[156:159], v1, s[8:11], s5 offen offset:3072 sc1
    s_waitcnt vmcnt(33)
    v_mfma_f32_32x32x16_bf16 v[16:31], a[160:163], v[160:163], v[16:31]
    s_add_u32 s5, s82, 8192
    buffer_load_dwordx4 v[160:163], v1, s[8:11], s5 offen offset:0 sc1
    s_waitcnt vmcnt(33)
    v_mfma_f32_32x32x16_bf16 v[16:31], a[164:167], v[164:167], v[16:31]
    buffer_load_dwordx4 v[164:167], v1, s[8:11], s5 offen offset:1024 sc1
    s_waitcnt vmcnt(33)
    v_mfma_f32_32x32x16_bf16 v[16:31], a[168:171], v[168:171], v[16:31]
    buffer_load_dwordx4 v[168:171], v1, s[8:11], s5 offen offset:2048 sc1
    s_waitcnt vmcnt(33)
    v_mfma_f32_32x32x16_bf16 v[16:31], a[172:175], v[172:175], v[16:31]
    buffer_load_dwordx4 v[172:175], v1, s[8:11], s5 offen offset:3072 sc1
    s_waitcnt vmcnt(33)
    v_mfma_f32_32x32x16_bf16 v[16:31], a[176:179], v[176:179], v[16:31]
    s_add_u32 s5, s82, 12288
    buffer_load_dwordx4 v[176:179], v1, s[8:11], s5 offen offset:0 sc1
    s_waitcnt vmcnt(33)
    v_mfma_f32_32x32x16_bf16 v[16:31], a[180:183], v[180:183], v[16:31]
    buffer_load_dwordx4 v[180:183], v1, s[8:11], s5 offen offset:1024 sc1
    s_waitcnt vmcnt(33)
    v_mfma_f32_32x32x16_bf16 v[16:31], a[184:187], v[184:187], v[16:31]
    buffer_load_dwordx4 v[184:187], v1, s[8:11], s5 offen offset:2048 sc1
    s_waitcnt vmcnt(33)
    v_mfma_f32_32x32x16_bf16 v[16:31], a[188:191], v[188:191], v[16:31]
    buffer_load_dwordx4 v[188:191], v1, s[8:11], s5 offen offset:3072 sc1
    s_waitcnt vmcnt(33)
    v_mfma_f32_32x32x16_bf16 v[16:31], a[192:195], v[192:195], v[16:31]
    s_add_u32 s5, s82, 16384
    buffer_load_dwordx4 v[192:195], v1, s[8:11], s5 offen offset:0 sc1
    s_waitcnt vmcnt(33)
    v_mfma_f32_32x32x16_bf16 v[16:31], a[196:199], v[196:199], v[16:31]
    buffer_load_dwordx4 v[196:199], v1, s[8:11], s5 offen offset:1024 sc1
    s_waitcnt vmcnt(33)
    v_mfma_f32_32x32x16_bf16 v[16:31], a[200:203], v[200:203], v[16:31]
    buffer_load_dwordx4 v[200:203], v1, s[8:11], s5 offen offset:2048 sc1
    s_waitcnt vmcnt(33)
    v_mfma_f32_32x32x16_bf16 v[16:31], a[204:207], v[204:207], v[16:31]
    buffer_load_dwordx4 v[204:207], v1, s[8:11], s5 offen offset:3072 sc1
    s_waitcnt vmcnt(33)
    v_mfma_f32_32x32x16_bf16 v[16:31], a[208:211], v[208:211], v[16:31]
    s_add_u32 s5, s82, 20480
    buffer_load_dwordx4 v[208:211], v1, s[8:11], s5 offen offset:0 sc1
    s_waitcnt vmcnt(33)
    v_mfma_f32_32x32x16_bf16 v[16:31], a[212:215], v[212:215], v[16:31]
    buffer_load_dwordx4 v[212:215], v1, s[8:11], s5 offen offset:1024 sc1
    s_waitcnt vmcnt(33)
    v_mfma_f32_32x32x16_bf16 v[16:31], a[216:219], v[216:219], v[16:31]
    buffer_load_dwordx4 v[216:219], v1, s[8:11], s5 offen offset:2048 sc1
    s_waitcnt vmcnt(33)
    v_mfma_f32_32x32x16_bf16 v[16:31], a[220:223], v[220:223], v[16:31]
    buffer_load_dwordx4 v[220:223], v1, s[8:11], s5 offen offset:3072 sc1
    s_waitcnt vmcnt(33)
    v_mfma_f32_32x32x16_bf16 v[16:31], a[224:227], v[224:227], v[16:31]
    s_add_u32 s5, s82, 24576
    buffer_load_dwordx4 v[224:227], v1, s[8:11], s5 offen offset:0 sc1
    s_waitcnt vmcnt(33)
    v_mfma_f32_32x32x16_bf16 v[16:31], a[228:231], v[228:231], v[16:31]
    buffer_load_dwordx4 v[228:231], v1, s[8:11], s5 offen offset:1024 sc1
    s_waitcnt vmcnt(33)
    v_mfma_f32_32x32x16_bf16 v[16:31], a[232:235], v[232:235], v[16:31]
    buffer_load_dwordx4 v[232:235], v1, s[8:11], s5 offen offset:2048 sc1
    s_waitcnt vmcnt(33)
    v_mfma_f32_32x32x16_bf16 v[16:31], a[236:239], v[236:239], v[16:31]
    buffer_load_dwordx4 v[236:239], v1, s[8:11], s5 offen offset:3072 sc1
    s_waitcnt vmcnt(33)
    v_mfma_f32_32x32x16_bf16 v[16:31], a[240:243], v[240:243], v[16:31]
    s_add_u32 s5, s82, 28672
    buffer_load_dwordx4 v[240:243], v1, s[8:11], s5 offen offset:0 sc1
    s_waitcnt vmcnt(33)
    v_mfma_f32_32x32x16_bf16 v[16:31], a[244:247], v[244:247], v[16:31]
    buffer_load_dwordx4 v[244:247], v1, s[8:11], s5 offen offset:1024 sc1
    s_waitcnt vmcnt(33)
    v_mfma_f32_32x32x16_bf16 v[16:31], a[248:251], v[248:251], v[16:31]
    buffer_load_dwordx4 v[248:251], v1, s[8:11], s5 offen offset:2048 sc1
    s_waitcnt vmcnt(33)
    v_mfma_f32_32x32x16_bf16 v[16:31], a[252:255], v[252:255], v[16:31]
    buffer_load_dwordx4 v[252:255], v1, s[8:11], s5 offen offset:3072 sc1
    v_add_u32 v4, s85, v10
    v_add_u32 v5, s85, v11
    s_xor_b32 s85, s85, 0x4000
    s_nop 7
    ds_write_b128 v4, v[16:19] offset:0
    ds_write_b128 v4, v[20:23] offset:1024
    ds_write_b128 v4, v[24:27] offset:2048
    ds_write_b128 v4, v[28:31] offset:3072
    s_waitcnt lgkmcnt(0)
    s_barrier
    ds_read_b128 v[32:35], v5 offset:0
    ds_read_b128 v[36:39], v5 offset:4096
    ds_read_b128 v[40:43], v5 offset:8192
    ds_read_b128 v[44:47], v5 offset:12288
    s_waitcnt vmcnt(32)
    v_sub_f32 v51, 1.0, v50
    v_cvt_pk_bf16_f32 v51, v51, v51
    v_and_b32 v51, 0xffff0000, v51
    v_lshlrev_b32 v52, 16, v48
    v_and_b32 v53, 0xffff0000, v48
    v_lshlrev_b32 v54, 16, v49
    v_and_b32 v55, 0xffff0000, v49
    v_mul_f32 v52, v52, v51
    v_mul_f32 v53, v53, v51
    v_mul_f32 v54, v54, v51
    v_mul_f32 v55, v55, v51
    s_lshl_b32 s4, s76, 16
    s_waitcnt lgkmcnt(2)
    v_add_f32 v32, v32, v36
    v_add_f32 v33, v33, v37
    v_add_f32 v34, v34, v38
    v_add_f32 v35, v35, v39
    s_waitcnt lgkmcnt(0)
    v_add_f32 v40, v40, v44
    v_add_f32 v41, v41, v45
    v_add_f32 v42, v42, v46
    v_add_f32 v43, v43, v47
    v_add_f32 v32, v32, v40
    v_add_f32 v33, v33, v41
    v_add_f32 v34, v34, v42
    v_add_f32 v35, v35, v43
    v_fma_f32 v32, v32, v50, v52
    v_fma_f32 v33, v33, v50, v53
    v_fma_f32 v34, v34, v50, v54
    v_fma_f32 v35, v35, v50, v55
    v_cvt_pk_bf16_f32 v36, v32, v33
    v_cvt_pk_bf16_f32 v37, v34, v35
    buffer_store_dwordx2 v[36:37], v14, s[20:23], s4 offen
    s_mov_b32 s76, s83
    s_mov_b32 s81, s82
    s_sub_u32 s77, s77, 1
    s_branch L_B_o_warm
L_B_o_nopf:
    s_waitcnt vmcnt(33)
    v_mfma_f32_32x32x16_bf16 v[16:31], a[128:131], v[128:131], v[16:31]
    s_waitcnt vmcnt(32)
    v_mfma_f32_32x32x16_bf16 v[16:31], a[132:135], v[132:135], v[16:31]
    s_waitcnt vmcnt(31)
    v_mfma_f32_32x32x16_bf16 v[16:31], a[136:139], v[136:139], v[16:31]
    s_waitcnt vmcnt(30)
    v_mfma_f32_32x32x16_bf16 v[16:31], a[140:143], v[140:143], v[16:31]
    s_waitcnt vmcnt(29)
    v_mfma_f32_32x32x16_bf16 v[16:31], a[144:147], v[144:147], v[16:31]
    s_waitcnt vmcnt(28)
    v_mfma_f32_32x32x16_bf16 v[16:31], a[148:151], v[148:151], v[16:31]
    s_waitcnt vmcnt(27)
    v_mfma_f32_32x32x16_bf16 v[16:31], a[152:155], v[152:155], v[16:31]
    s_waitcnt vmcnt(26)
    v_mfma_f32_32x32x16_bf16 v[16:31], a[156:159], v[156:159], v[16:31]
    s_waitcnt vmcnt(25)
    v_mfma_f32_32x32x16_bf16 v[16:31], a[160:163], v[160:163], v[16:31]
    s_waitcnt vmcnt(24)
    v_mfma_f32_32x32x16_bf16 v[16:31], a[164:167], v[164:167], v[16:31]
    s_waitcnt vmcnt(23)
    v_mfma_f32_32x32x16_bf16 v[16:31], a[168:171], v[168:171], v[16:31]
    s_waitcnt vmcnt(22)
    v_mfma_f32_32x32x16_bf16 v[16:31], a[172:175], v[172:175], v[16:31]
    s_waitcnt vmcnt(21)
    v_mfma_f32_32x32x16_bf16 v[16:31], a[176:179], v[176:179], v[16:31]
    s_waitcnt vmcnt(20)
    v_mfma_f32_32x32x16_bf16 v[16:31], a[180:183], v[180:183], v[16:31]
    s_waitcnt vmcnt(19)
    v_mfma_f32_32x32x16_bf16 v[16:31], a[184:187], v[184:187], v[16:31]
    s_waitcnt vmcnt(18)
    v_mfma_f32_32x32x16_bf16 v[16:31], a[188:191], v[188:191], v[16:31]
    s_waitcnt vmcnt(17)
    v_mfma_f32_32x32x16_bf16 v[16:31], a[192:195], v[192:195], v[16:31]
    s_waitcnt vmcnt(16)
    v_mfma_f32_32x32x16_bf16 v[16:31], a[196:199], v[196:199], v[16:31]
    s_waitcnt vmcnt(15)
    v_mfma_f32_32x32x16_bf16 v[16:31], a[200:203], v[200:203], v[16:31]
    s_waitcnt vmcnt(14)
    v_mfma_f32_32x32x16_bf16 v[16:31], a[204:207], v[204:207], v[16:31]
    s_waitcnt vmcnt(13)
    v_mfma_f32_32x32x16_bf16 v[16:31], a[208:211], v[208:211], v[16:31]
    s_waitcnt vmcnt(12)
    v_mfma_f32_32x32x16_bf16 v[16:31], a[212:215], v[212:215], v[16:31]
    s_waitcnt vmcnt(11)
    v_mfma_f32_32x32x16_bf16 v[16:31], a[216:219], v[216:219], v[16:31]
    s_waitcnt vmcnt(10)
    v_mfma_f32_32x32x16_bf16 v[16:31], a[220:223], v[220:223], v[16:31]
    s_waitcnt vmcnt(9)
    v_mfma_f32_32x32x16_bf16 v[16:31], a[224:227], v[224:227], v[16:31]
    s_waitcnt vmcnt(8)
    v_mfma_f32_32x32x16_bf16 v[16:31], a[228:231], v[228:231], v[16:31]
    s_waitcnt vmcnt(7)
    v_mfma_f32_32x32x16_bf16 v[16:31], a[232:235], v[232:235], v[16:31]
    s_waitcnt vmcnt(6)
    v_mfma_f32_32x32x16_bf16 v[16:31], a[236:239], v[236:239], v[16:31]
    s_waitcnt vmcnt(5)
    v_mfma_f32_32x32x16_bf16 v[16:31], a[240:243], v[240:243], v[16:31]
    s_waitcnt vmcnt(4)
    v_mfma_f32_32x32x16_bf16 v[16:31], a[244:247], v[244:247], v[16:31]
    s_waitcnt vmcnt(3)
    v_mfma_f32_32x32x16_bf16 v[16:31], a[248:251], v[248:251], v[16:31]
    s_waitcnt vmcnt(2)
    v_mfma_f32_32x32x16_bf16 v[16:31], a[252:255], v[252:255], v[16:31]
    v_add_u32 v4, s85, v10
    v_add_u32 v5, s85, v11
    s_xor_b32 s85, s85, 0x4000
    s_nop 8
    ds_write_b128 v4, v[16:19] offset:0
    ds_write_b128 v4, v[20:23] offset:1024
    ds_write_b128 v4, v[24:27] offset:2048
    ds_write_b128 v4, v[28:31] offset:3072
    s_waitcnt lgkmcnt(0)
    s_barrier
    ds_read_b128 v[32:35], v5 offset:0
    ds_read_b128 v[36:39], v5 offset:4096
    ds_read_b128 v[40:43], v5 offset:8192
    ds_read_b128 v[44:47], v5 offset:12288
    s_waitcnt vmcnt(0)
    v_sub_f32 v51, 1.0, v50
    v_cvt_pk_bf16_f32 v51, v51, v51
    v_and_b32 v51, 0xffff0000, v51
    v_lshlrev_b32 v52, 16, v48
    v_and_b32 v53, 0xffff0000, v48
    v_lshlrev_b32 v54, 16, v49
    v_and_b32 v55, 0xffff0000, v49
    v_mul_f32 v52, v52, v51
    v_mul_f32 v53, v53, v51
    v_mul_f32 v54, v54, v51
    v_mul_f32 v55, v55, v51
    s_lshl_b32 s4, s76, 16
    s_waitcnt lgkmcnt(2)
    v_add_f32 v32, v32, v36
    v_add_f32 v33, v33, v37
    v_add_f32 v34, v34, v38
    v_add_f32 v35, v35, v39
    s_waitcnt lgkmcnt(0)
    v_add_f32 v40, v40, v44
    v_add_f32 v41, v41, v45
    v_add_f32 v42, v42, v46
    v_add_f32 v43, v43, v47
    v_add_f32 v32, v32, v40
    v_add_f32 v33, v33, v41
    v_add_f32 v34, v34, v42
    v_add_f32 v35, v35, v43
    v_fma_f32 v32, v32, v50, v52
    v_fma_f32 v33, v33, v50, v53
    v_fma_f32 v34, v34, v50, v54
    v_fma_f32 v35, v35, v50, v55
    v_cvt_pk_bf16_f32 v36, v32, v33
    v_cvt_pk_bf16_f32 v37, v34, v35
    buffer_store_dwordx2 v[36:37], v14, s[20:23], s4 offen
    s_mov_b32 s76, s83
    s_mov_b32 s81, s82
    s_sub_u32 s77, s77, 1
    s_cmp_lg_u32 s77, 0
    s_cbranch_scc1 L_B_o_cold
L_B_o_end:
    s_cmp_lt_i32 s86, 0
    s_cbranch_scc1 L_phase2_next
    s_mov_b32 s76, s86
    s_lshl_b32 s6, s76, 5
    s_add_u32 s6, s6, s80
    s_lshl_b32 s7, s6, 2
    s_add_u32 s7, s7, s63
    s_lshl_b32 s7, s7, 2
    s_add_u32 s7, s7, 104988672
    s_lshl_b32 s6, s6, 11
    s_add_u32 s6, s6, 100663296
    v_mov_b32 v3, 0
L_bw_71:
    v_cmp_eq_u32 vcc, 0, v3
    s_cbranch_vccz L_bwd_72
    s_sleep 2
    buffer_load_dword v3, v7, s[8:11], s7 offen sc1
    s_waitcnt vmcnt(0)
    s_sub_u32 s65, s65, 1
    s_cmp_gt_i32 s65, 0
    s_cbranch_scc1 L_bw_71
L_bwd_72:
    s_lshl_b32 s4, s76, 7
    s_add_u32 s4, s4, 104857600
    buffer_load_dwordx2 v[48:49], v12, s[8:11], s6 offen sc1
    buffer_load_dword v50, v13, s[8:11], s4 offen sc1
    s_mul_i32 s81, s76, 262144
    s_mul_i32 s4, s63, 65536
    s_add_u32 s81, s81, s4
    s_add_u32 s81, s81, 67108864
    s_lshl_b32 s82, s80, 11
    s_add_u32 s82, s82, s81
    s_lshr_b32 s4, s63, 1
    s_cmp_eq_u32 s4, s87
    s_cselect_b32 s4, 0, 268435456
    v_or_b32 v14, s4, v14
    v_and_b32 v4, 256, v1
    v_cmp_eq_u32 s[90:91], 0, v4
    v_mul_u32_u24 v4, 3, v4
    s_lshl_b32 s4, s87, 8
    v_add3_u32 v8, v1, v4, s4
L_hw_69:
    buffer_load_dword v2, v9, s[8:11], 0 offen sc1
    s_waitcnt vmcnt(0)
    v_cmp_ge_u32 vcc, s76, v2
    s_cbranch_vccz L_hwd_70
    s_sleep 2
    s_sub_u32 s65, s65, 1
    s_cmp_gt_i32 s65, 0
    s_cbranch_scc1 L_hw_69
L_hwd_70:
    buffer_load_dword v3, v8, s[8:11], s82 offen sc1
    s_add_u32 s5, s81, 0
    buffer_load_dwordx4 v[128:131], v8, s[8:11], s5 offen offset:0 sc1
    buffer_load_dwordx4 v[132:135], v8, s[8:11], s5 offen offset:2048 sc1
    s_add_u32 s5, s81, 4096
    buffer_load_dwordx4 v[136:139], v8, s[8:11], s5 offen offset:0 sc1
    buffer_load_dwordx4 v[140:143], v8, s[8:11], s5 offen offset:2048 sc1
    s_add_u32 s5, s81, 8192
    buffer_load_dwordx4 v[144:147], v8, s[8:11], s5 offen offset:0 sc1
    buffer_load_dwordx4 v[148:151], v8, s[8:11], s5 offen offset:2048 sc1
    s_add_u32 s5, s81, 12288
    buffer_load_dwordx4 v[152:155], v8, s[8:11], s5 offen offset:0 sc1
    buffer_load_dwordx4 v[156:159], v8, s[8:11], s5 offen offset:2048 sc1
    s_add_u32 s5, s81, 16384
    buffer_load_dwordx4 v[160:163], v8, s[8:11], s5 offen offset:0 sc1
    buffer_load_dwordx4 v[164:167], v8, s[8:11], s5 offen offset:2048 sc1
    s_waitcnt vmcnt(9)
    v_mfma_f32_32x32x16_bf16 v[16:31], a[0:3], v[128:131], 0
    s_add_u32 s5, s81, 20480
    buffer_load_dwordx4 v[168:171], v8, s[8:11], s5 offen offset:0 sc1
    v_mfma_f32_32x32x16_bf16 v[64:79], a[4:7], v[128:131], 0
    s_waitcnt vmcnt(9)
    v_mfma_f32_32x32x16_bf16 v[16:31], a[8:11], v[132:135], v[16:31]
    buffer_load_dwordx4 v[172:175], v8, s[8:11], s5 offen offset:2048 sc1
    v_mfma_f32_32x32x16_bf16 v[64:79], a[12:15], v[132:135], v[64:79]
    s_waitcnt vmcnt(9)
    v_mfma_f32_32x32x16_bf16 v[16:31], a[16:19], v[136:139], v[16:31]
    s_add_u32 s5, s81, 24576
    buffer_load_dwordx4 v[176:179], v8, s[8:11], s5 offen offset:0 sc1
    v_mfma_f32_32x32x16_bf16 v[64:79], a[20:23], v[136:139], v[64:79]
    s_waitcnt vmcnt(9)
    v_mfma_f32_32x32x16_bf16 v[16:31], a[24:27], v[140:143], v[16:31]
    buffer_load_dwordx4 v[180:183], v8, s[8:11], s5 offen offset:2048 sc1
    v_mfma_f32_32x32x16_bf16 v[64:79], a[28:31], v[140:143], v[64:79]
    s_waitcnt vmcnt(9)
    v_mfma_f32_32x32x16_bf16 v[16:31], a[32:35], v[144:147], v[16:31]
    s_add_u32 s5, s81, 28672
    buffer_load_dwordx4 v[184:187], v8, s[8:11], s5 offen offset:0 sc1
    v_mfma_f32_32x32x16_bf16 v[64:79], a[36:39], v[144:147], v[64:79]
    s_waitcnt vmcnt(9)
    v_mfma_f32_32x32x16_bf16 v[16:31], a[40:43], v[148:151], v[16:31]
    buffer_load_dwordx4 v[188:191], v8, s[8:11], s5 offen offset:2048 sc1
    v_mfma_f32_32x32x16_bf16 v[64:79], a[44:47], v[148:151], v[64:79]
    s_waitcnt vmcnt(9)
    v_mfma_f32_32x32x16_bf16 v[16:31], a[48:51], v[152:155], v[16:31]
    s_add_u32 s5, s81, 32768
    buffer_load_dwordx4 v[192:195], v8, s[8:11], s5 offen offset:0 sc1
    v_mfma_f32_32x32x16_bf16 v[64:79], a[52:55], v[152:155], v[64:79]
    s_waitcnt vmcnt(9)
    v_mfma_f32_32x32x16_bf16 v[16:31], a[56:59], v[156:159], v[16:31]
    buffer_load_dwordx4 v[196:199], v8, s[8:11], s5 offen offset:2048 sc1
    v_mfma_f32_32x32x16_bf16 v[64:79], a[60:63], v[156:159], v[64:79]
    s_waitcnt vmcnt(9)
    v_mfma_f32_32x32x16_bf16 v[16:31], a[64:67], v[160:163], v[16:31]
    s_add_u32 s5, s81, 36864
    buffer_load_dwordx4 v[200:203], v8, s[8:11], s5 offen offset:0 sc1
    v_mfma_f32_32x32x16_bf16 v[64:79], a[68:71], v[160:163], v[64:79]
    s_waitcnt vmcnt(9)
    v_mfma_f32_32x32x16_bf16 v[16:31], a[72:75], v[164:167], v[16:31]
    buffer_load_dwordx4 v[204:207], v8, s[8:11], s5 offen offset:2048 sc1
    v_mfma_f32_32x32x16_bf16 v[64:79], a[76:79], v[164:167], v[64:79]
    s_waitcnt vmcnt(9)
    v_mfma_f32_32x32x16_bf16 v[16:31], a[80:83], v[168:171], v[16:31]
    s_add_u32 s5, s81, 40960
    buffer_load_dwordx4 v[208:211], v8, s[8:11], s5 offen offset:0 sc1
    v_mfma_f32_32x32x16_bf16 v[64:79], a[84:87], v[168:171], v[64:79]
    s_waitcnt vmcnt(9)
    v_mfma_f32_32x32x16_bf16 v[16:31], a[88:91], v[172:175], v[16:31]
    buffer_load_dwordx4 v[212:215], v8, s[8:11], s5 offen offset:2048 sc1
    v_mfma_f32_32x32x16_bf16 v[64:79], a[92:95], v[172:175], v[64:79]
    s_waitcnt vmcnt(9)
    v_mfma_f32_32x32x16_bf16 v[16:31], a[96:99], v[176:179], v[16:31]
    s_add_u32 s5, s81, 45056
    buffer_load_dwordx4 v[216:219], v8, s[8:11], s5 offen offset:0 sc1
    v_mfma_f32_32x32x16_bf16 v[64:79], a[100:103], v[176:179], v[64:79]
    s_waitcnt vmcnt(9)
    v_mfma_f32_32x32x16_bf16 v[16:31], a[104:107], v[180:183], v[16:31]
    buffer_load_dwordx4 v[220:223], v8, s[8:11], s5 offen offset:2048 sc1
    v_mfma_f32_32x32x16_bf16 v[64:79], a[108:111], v[180:183], v[64:79]
    s_waitcnt vmcnt(9)
    v_mfma_f32_32x32x16_bf16 v[16:31], a[112:115], v[184:187], v[16:31]
    s_add_u32 s5, s81, 49152
    buffer_load_dwordx4 v[224:227], v8, s[8:11], s5 offen offset:0 sc1
    v_mfma_f32_32x32x16_bf16 v[64:79], a[116:119], v[184:187], v[64:79]
    s_waitcnt vmcnt(9)
    v_mfma_f32_32x32x16_bf16 v[16:31], a[120:123], v[188:191], v[16:31]
    buffer_load_dwordx4 v[228:231], v8, s[8:11], s5 offen offset:2048 sc1
    v_mfma_f32_32x32x16_bf16 v[64:79], a[124:127], v[188:191], v[64:79]
    s_waitcnt vmcnt(9)
    v_mfma_f32_32x32x16_bf16 v[16:31], a[128:131], v[192:195], v[16:31]
    s_add_u32 s5, s81, 53248
    buffer_load_dwordx4 v[232:235], v8, s[8:11], s5 offen offset:0 sc1
    v_mfma_f32_32x32x16_bf16 v[64:79], a[132:135], v[192:195], v[64:79]
    s_waitcnt vmcnt(9)
    v_mfma_f32_32x32x16_bf16 v[16:31], a[136:139], v[196:199], v[16:31]
    buffer_load_dwordx4 v[236:239], v8, s[8:11], s5 offen offset:2048 sc1
    v_mfma_f32_32x32x16_bf16 v[64:79], a[140:143], v[196:199], v[64:79]
    s_waitcnt vmcnt(9)
    v_mfma_f32_32x32x16_bf16 v[16:31], a[144:147], v[200:203], v[16:31]
    s_add_u32 s5, s81, 57344
    buffer_load_dwordx4 v[240:243], v8, s[8:11], s5 offen offset:0 sc1
    v_mfma_f32_32x32x16_bf16 v[64:79], a[148:151], v[200:203], v[64:79]
    s_waitcnt vmcnt(9)
    v_mfma_f32_32x32x16_bf16 v[16:31], a[152:155], v[204:207], v[16:31]
    buffer_load_dwordx4 v[244:247], v8, s[8:11], s5 offen offset:2048 sc1
    v_mfma_f32_32x32x16_bf16 v[64:79], a[156:159], v[204:207], v[64:79]
    s_waitcnt vmcnt(9)
    v_mfma_f32_32x32x16_bf16 v[16:31], a[160:163], v[208:211], v[16:31]
    s_add_u32 s5, s81, 61440
    buffer_load_dwordx4 v[248:251], v8, s[8:11], s5 offen offset:0 sc1
    v_mfma_f32_32x32x16_bf16 v[64:79], a[164:167], v[208:211], v[64:79]
    s_waitcnt vmcnt(9)
    v_mfma_f32_32x32x16_bf16 v[16:31], a[168:171], v[212:215], v[16:31]
    buffer_load_dwordx4 v[252:255], v8, s[8:11], s5 offen offset:2048 sc1
    v_mfma_f32_32x32x16_bf16 v[64:79], a[172:175], v[212:215], v[64:79]
    s_waitcnt vmcnt(9)
    v_mfma_f32_32x32x16_bf16 v[16:31], a[176:179], v[216:219], v[16:31]
    v_mfma_f32_32x32x16_bf16 v[64:79], a[180:183], v[216:219], v[64:79]
    s_waitcnt vmcnt(8)
    v_mfma_f32_32x32x16_bf16 v[16:31], a[184:187], v[220:223], v[16:31]
    v_mfma_f32_32x32x16_bf16 v[64:79], a[188:191], v[220:223], v[64:79]
    s_waitcnt vmcnt(7)
    v_mfma_f32_32x32x16_bf16 v[16:31], a[192:195], v[224:227], v[16:31]
    v_mfma_f32_32x32x16_bf16 v[64:79], a[196:199], v[224:227], v[64:79]
    s_waitcnt vmcnt(6)
    v_mfma_f32_32x32x16_bf16 v[16:31], a[200:203], v[228:231], v[16:31]
    v_mfma_f32_32x32x16_bf16 v[64:79], a[204:207], v[228:231], v[64:79]
    s_waitcnt vmcnt(5)
    v_mfma_f32_32x32x16_bf16 v[16:31], a[208:211], v[232:235], v[16:31]
    v_mfma_f32_32x32x16_bf16 v[64:79], a[212:215], v[232:235], v[64:79]
    s_waitcnt vmcnt(4)
    v_mfma_f32_32x32x16_bf16 v[16:31], a[216:219], v[236:239], v[16:31]
    v_mfma_f32_32x32x16_bf16 v[64:79], a[220:223], v[236:239], v[64:79]
    s_waitcnt vmcnt(3)
    v_mfma_f32_32x32x16_bf16 v[16:31], a[224:227], v[240:243], v[16:31]
    v_mfma_f32_32x32x16_bf16 v[64:79], a[228:231], v[240:243], v[64:79]
    s_waitcnt vmcnt(2)
    v_mfma_f32_32x32x16_bf16 v[16:31], a[232:235], v[244:247], v[16:31]
    v_mfma_f32_32x32x16_bf16 v[64:79], a[236:239], v[244:247], v[64:79]
    s_waitcnt vmcnt(1)
    v_mfma_f32_32x32x16_bf16 v[16:31], a[240:243], v[248:251], v[16:31]
    v_mfma_f32_32x32x16_bf16 v[64:79], a[244:247], v[248:251], v[64:79]
    s_waitcnt vmcnt(0)
    v_mfma_f32_32x32x16_bf16 v[16:31], a[248:251], v[252:255], v[16:31]
    v_mfma_f32_32x32x16_bf16 v[64:79], a[252:255], v[252:255], v[64:79]
    s_nop 11
    v_cndmask_b32 v16, v64, v16, s[90:91]
    v_cndmask_b32 v17, v65, v17, s[90:91]
    v_cndmask_b32 v18, v66, v18, s[90:91]
    v_cndmask_b32 v19, v67, v19, s[90:91]
    v_cndmask_b32 v20, v68, v20, s[90:91]
    v_cndmask_b32 v21, v69, v21, s[90:91]
    v_cndmask_b32 v22, v70, v22, s[90:91]
    v_cndmask_b32 v23, v71, v23, s[90:91]
    v_cndmask_b32 v24, v72, v24, s[90:91]
    v_cndmask_b32 v25, v73, v25, s[90:91]
    v_cndmask_b32 v26, v74, v26, s[90:91]
    v_cndmask_b32 v27, v75, v27, s[90:91]
    v_cndmask_b32 v28, v76, v28, s[90:91]
    v_cndmask_b32 v29, v77, v29, s[90:91]
    v_cndmask_b32 v30, v78, v30, s[90:91]
    v_cndmask_b32 v31, v79, v31, s[90:91]
    v_add_u32 v4, s85, v10
    v_add_u32 v5, s85, v11
    s_xor_b32 s85, s85, 0x4000
    ds_write_b128 v4, v[16:19] offset:0
    ds_write_b128 v4, v[20:23] offset:1024
    ds_write_b128 v4, v[24:27] offset:2048
    ds_write_b128 v4, v[28:31] offset:3072
    s_waitcnt lgkmcnt(0)
    s_barrier
    v_xor_b32 v4, 256, v5
    ds_read_b128 v[80:83], v4 offset:0
    ds_read_b128 v[84:87], v4 offset:4096
    ds_read_b128 v[88:91], v4 offset:8192
    ds_read_b128 v[92:95], v4 offset:12288
    ds_read_b128 v[32:35], v5 offset:0
    ds_read_b128 v[36:39], v5 offset:4096
    ds_read_b128 v[40:43], v5 offset:8192
    ds_read_b128 v[44:47], v5 offset:12288
    s_waitcnt vmcnt(0)
    v_sub_f32 v51, 1.0, v50
    v_cvt_pk_bf16_f32 v51, v51, v51
    v_and_b32 v51, 0xffff0000, v51
    v_lshlrev_b32 v52, 16, v48
    v_and_b32 v53, 0xffff0000, v48
    v_lshlrev_b32 v54, 16, v49
    v_and_b32 v55, 0xffff0000, v49
    v_mul_f32 v52, v52, v51
    v_mul_f32 v53, v53, v51
    v_mul_f32 v54, v54, v51
    v_mul_f32 v55, v55, v51
    s_lshl_b32 s4, s76, 16
    s_waitcnt lgkmcnt(0)
    v_pk_add_f32 v[32:33], v[32:33], v[80:81]
    v_pk_add_f32 v[34:35], v[34:35], v[82:83]
    v_pk_add_f32 v[36:37], v[36:37], v[84:85]
    v_pk_add_f32 v[38:39], v[38:39], v[86:87]
    v_pk_add_f32 v[40:41], v[40:41], v[88:89]
    v_pk_add_f32 v[42:43], v[42:43], v[90:91]
    v_pk_add_f32 v[44:45], v[44:45], v[92:93]
    v_pk_add_f32 v[46:47], v[46:47], v[94:95]
    s_waitcnt lgkmcnt(2)
    v_add_f32 v32, v32, v36
    v_add_f32 v33, v33, v37
    v_add_f32 v34, v34, v38
    v_add_f32 v35, v35, v39
    s_waitcnt lgkmcnt(0)
    v_add_f32 v40, v40, v44
    v_add_f32 v41, v41, v45
    v_add_f32 v42, v42, v46
    v_add_f32 v43, v43, v47
    v_add_f32 v32, v32, v40
    v_add_f32 v33, v33, v41
    v_add_f32 v34, v34, v42
    v_add_f32 v35, v35, v43
    v_fma_f32 v32, v32, v50, v52
    v_fma_f32 v33, v33, v50, v53
    v_fma_f32 v34, v34, v50, v54
    v_fma_f32 v35, v35, v50, v55
    v_cvt_pk_bf16_f32 v36, v32, v33
    v_cvt_pk_bf16_f32 v37, v34, v35
    buffer_store_dwordx2 v[36:37], v14, s[20:23], s4 offen
    s_mov_b32 s76, s83
    s_mov_b32 s81, s82
    s_sub_u32 s77, s77, 1
    s_add_u32 s86, s86, 3
    s_cmp_lt_u32 s86, 64
    s_cbranch_scc1 L_B_o_end
    s_branch L_phase2_next
L_end:
    s_endpgm
.section .rodata,"a"
.p2align 6
.amdhsa_kernel gated_mix__memory_aug_recurrent_mem_tr__geglu_ffn__prompt_kernel
  .amdhsa_next_free_vgpr 512
  .amdhsa_next_free_sgpr 102
  .amdhsa_accum_offset 256
  .amdhsa_group_segment_fixed_size 0
  .amdhsa_kernarg_size 120
  .amdhsa_user_sgpr_count 2
  .amdhsa_user_sgpr_kernarg_segment_ptr 1
  .amdhsa_system_sgpr_workgroup_id_x 1
  .amdhsa_float_denorm_mode_32 3
.end_amdhsa_kernel
```
